```python
import torch

def _softmax(x, axis=-1):
    return torch.softmax(x, dim=axis)

def _gelu(x):
    return torch.nn.functional.gelu(x, approximate='tanh')

def _silu(x):
    return torch.nn.functional.silu(x)

def _sigmoid(x):
    return torch.sigmoid(x)

def _layernorm(x, axis=-1, eps=1e-05):
    m = x.mean(dim=axis, keepdim=True)
    v = x.var(dim=axis, keepdim=True, unbiased=False)
    return (x - m) / torch.sqrt(v + eps)

def _scatter_add(tgt, idx, src, axis=0):
    return tgt.clone().index_add_(axis, idx, src)

def _segment_sum(src, seg, n):
    out = torch.zeros((n,) + src.shape[1:], dtype=src.dtype)
    return out.index_add_(0, seg, src)

def _pad(x, pw):
    flat = tuple((v for pair in reversed(pw) for v in pair))
    return torch.nn.functional.pad(x, flat)
kernel_name = 'parallel_sum__sliding_block__mixer_gmlp__prompt'

def setup_inputs():

    _w = lambda a: (lambda t: t.to(torch.bfloat16) if t.is_floating_point() else t)(torch.as_tensor(a))

    def _A_setup():
        B, S, D = (1, 2048, 512)
        return {'x': _w((lambda *s: torch.randn(*s, dtype=torch.bfloat16) * 0.05)(B, S, D)), 'wqkv': _w((lambda *s: torch.randn(*s, dtype=torch.bfloat16) * 0.1)(D, 3 * D)), 'wo': _w((lambda *s: torch.randn(*s, dtype=torch.bfloat16) * 0.05)(D, D))}
    _A_in = _A_setup()

    def _B_setup():
        B, S, D, F = (1, 2048, 512, 1792)
        Fh = F // 2
        return {'x': _w((lambda *s: torch.randn(*s, dtype=torch.bfloat16) * 0.05)(B, S, D)), 'w_in': _w((lambda *s: torch.randn(*s, dtype=torch.bfloat16) * 0.4)(D, 2 * Fh)), 'w_sp': _w(0.01 * (lambda *s: torch.randn(*s, dtype=torch.bfloat16) * 0.4)(S, S)), 'b_sp': _w(1.0 + 0.01 * (lambda *s: torch.randn(*s, dtype=torch.bfloat16) * 0.05)(S)), 'w_out': _w((lambda *s: torch.randn(*s, dtype=torch.bfloat16) * 0.05)(Fh, D))}
    _B_in = _B_setup()
    return {'A_x': _A_in['x'], 'A_wqkv': _A_in['wqkv'], 'A_wo': _A_in['wo'], 'B_x': _B_in['x'], 'B_w_in': _B_in['w_in'], 'B_w_sp': _B_in['w_sp'], 'B_b_sp': _B_in['b_sp'], 'B_w_out': _B_in['w_out']}

def reference(A_x, A_wqkv, A_wo, B_x, B_w_in, B_w_sp, B_b_sp, B_w_out):

    def _A_ref(x, wqkv, wo):
        B, S, D = x.shape
        H = 32
        Dh = D // H
        W = 256
        qkv = (lambda x, *d: x.permute(*d))((x @ wqkv).reshape(B, S, 3, H, Dh), 2, 0, 3, 1, 4)
        q, k, v = (qkv[0], qkv[1], qkv[2])
        scores = torch.einsum('bhqd,bhkd->bhqk', q, k) * Dh ** (-0.5)
        idx = torch.arange(S)
        mask = (idx[:, None] - idx[None, :] >= 0) & (idx[:, None] - idx[None, :] < W)
        scores = torch.where(mask[None, None], scores, -1000000000.0)
        p = _softmax(scores, axis=-1)
        o = torch.einsum('bhqk,bhkd->bhqd', p, v)
        return (lambda x, *d: x.permute(*d))(o, 0, 2, 1, 3).reshape(B, S, D) @ wo

    def _B_ref(x, w_in, w_sp, b_sp, w_out):
        B, S, D = x.shape
        F = w_in.shape[-1]
        Fh = F // 2
        z = _gelu(torch.einsum('bsd,df->bsf', x, w_in))
        z1 = z[..., :Fh].clone()
        z2 = _layernorm(z[..., Fh:], axis=-1)
        g = torch.einsum('ts,bsf->btf', w_sp, z2) + b_sp[None, :, None]
        return torch.einsum('bsf,fd->bsd', z1 * g, w_out)
    x = A_x
    xn = _layernorm(x, axis=-1)
    return x + _A_ref(xn, A_wqkv, A_wo) + _B_ref(xn, B_w_in, B_w_sp, B_b_sp, B_w_out)
```

```asm
; @launch grid=(256,1,1) block=(256,1,1) lds=163840
.amdgcn_target "amdgcn-amd-amdhsa--gfx950"
.text
.globl parallel_sum__sliding_block__mixer_gmlp__prompt_kernel
.p2align 8
.type parallel_sum__sliding_block__mixer_gmlp__prompt_kernel,@function
parallel_sum__sliding_block__mixer_gmlp__prompt_kernel:
  s_load_dwordx2 s[4:5], s[0:1], 0
  s_cmp_ge_u32 s2, 256
  s_cbranch_scc1 L_end
  s_load_dwordx2 s[8:9], s[0:1], 8
  s_load_dwordx2 s[36:37], s[0:1], 80
  s_load_dwordx2 s[12:13], s[0:1], 32
  s_load_dwordx2 s[16:17], s[0:1], 40
  s_load_dwordx2 s[20:21], s[0:1], 16
  s_load_dwordx2 s[28:29], s[0:1], 48
  s_load_dwordx2 s[24:25], s[0:1], 56
  s_load_dwordx2 s[32:33], s[0:1], 64
  v_lshrrev_b32 v16, 6, v0
  v_and_b32 v17, 63, v0
  v_readfirstlane_b32 s43, v16
  s_lshr_b32 s3, s2, 5
  s_add_u32 s3, s3, 7
  s_and_b32 s3, s3, 7
  s_cmp_lt_u32 s2, 32
  s_cbranch_scc1 L_cpf
L_nocpf:
  s_bfe_u32 s40, s2, 131073
  s_lshl_b32 s40, s40, 2
  s_bfe_u32 s47, s2, 131075
  s_add_u32 s40, s40, s47
  s_lshl_b32 s46, s40, 2
  s_add_u32 s46, s46, s43
  s_mov_b32 s6, 2097152
  s_mov_b32 s7, 0x20000
  v_lshrrev_b32 v18, 4, v17
  v_and_b32 v19, 15, v17
  v_xor_b32 v19, v18, v19
  v_lshlrev_b32 v19, 4, v19
  v_lshl_add_u32 v20, v18, 10, v19
  v_xor_b32 v21, 64, v20
  v_add_u32 v21, 3072, v21
  v_xor_b32 v22, 128, v20
  v_add_u32 v22, 6144, v22
  v_xor_b32 v23, 192, v20
  v_add_u32 v23, 9216, v23
  s_add_u32 s47, s47, s3
  s_lshr_b32 s77, s3, 2
  s_lshl_b32 s61, s46, 1
  s_add_u32 s61, s61, s77
  s_lshl_b32 s61, s61, 14
  s_lshl_b32 s62, s43, 3
  s_add_u32 s62, s62, s77
  s_lshl_b32 s62, s62, 12
  s_and_b32 s84, s47, 3
  s_and_b32 s42, s2, 1
  s_waitcnt lgkmcnt(0)
  s_cmp_eq_u32 s3, 7
  s_cbranch_scc1 L_touch
L_notouch:
  s_lshl_b32 s77, s84, 8
  s_add_u32 s65, s61, s77
  s_add_u32 m0, s62, 0
  s_nop 0
  buffer_load_dwordx4 v20, s[4:7], s65 offen lds
  buffer_load_dwordx4 v21, s[4:7], s65 offen offset:1024 lds
  buffer_load_dwordx4 v22, s[4:7], s65 offen offset:2048 lds
  buffer_load_dwordx4 v23, s[4:7], s65 offen offset:3072 lds
  s_xor_b32 s65, s65, 16384
  s_xor_b32 m0, m0, 4096
  s_nop 0
  buffer_load_dwordx4 v20, s[4:7], s65 offen lds
  buffer_load_dwordx4 v21, s[4:7], s65 offen offset:1024 lds
  buffer_load_dwordx4 v22, s[4:7], s65 offen offset:2048 lds
  buffer_load_dwordx4 v23, s[4:7], s65 offen offset:3072 lds
  s_load_dword s44, s[36:37], 0
  v_cmp_ne_u32 vcc, 0, v0
  v_bfrev_b32 v18, 1
  v_lshlrev_b32 v0, 4, v17
  v_cndmask_b32 v9, 0, v18, vcc
  s_add_u32 s77, s47, 1
  s_and_b32 s85, s77, 3
  s_add_u32 s77, s47, 2
  s_and_b32 s86, s77, 3
  s_add_u32 s77, s47, 3
  s_and_b32 s87, s77, 3
  s_mov_b32 s10, 1572864
  s_mov_b32 s11, 0x20000
  s_mov_b32 s14, 1835008
  s_mov_b32 s15, 0x20000
  s_mov_b32 s18, 8388608
  s_mov_b32 s19, 0x20000
  s_mov_b32 s22, 524288
  s_mov_b32 s23, 0x20000
  s_mov_b32 s26, 917504
  s_mov_b32 s27, 0x20000
  s_mov_b32 s30, 4096
  s_mov_b32 s31, 0x20000
  s_mov_b32 s34, 2097152
  s_mov_b32 s35, 0x20000
  s_mov_b32 s38, 268435456
  s_mov_b32 s39, 0x20000
  s_lshl_b32 s41, s3, 1
  s_or_b32 s41, s41, s42
  s_lshl_b32 s45, s42, 3
  s_add_u32 s45, s45, s3
  s_mov_b32 s49, 27648
  s_mov_b32 s50, 55296
  s_mov_b32 s51, 82944
  s_mov_b32 s53, 23552
  s_mov_b32 s54, 47104
  s_mov_b32 s55, 70656
  s_mov_b32 s57, 7168
  s_mov_b32 s58, 14336
  s_mov_b32 s59, 21504
  s_lshl_b32 s63, s43, 12
  s_add_u32 s63, s63, 98304
  v_bfe_u32 v32, v17, 2, 3
  s_lshl_b32 s77, s43, 5
  v_add_u32 v32, s77, v32
  v_lshrrev_b32 v33, 5, v17
  v_and_b32 v34, 3, v17
  v_lshlrev_b32 v34, 4, v34
  v_mul_u32_u24 v35, 3072, v32
  v_add_u32 v35, v35, v34
  s_lshl_b32 s77, s45, 6
  v_add_u32 v43, s77, v35
  v_lshl_add_u32 v46, v33, 10, v43
  v_add_u32 v46, 1024, v46
  v_mul_u32_u24 v35, 3584, v32
  v_add_u32 v35, v35, v34
  v_lshl_add_u32 v35, v33, 6, v35
  s_lshl_b32 s77, s41, 7
  v_add_u32 v47, s77, v35
  v_add_u32 v45, 1792, v47
  v_and_b32 v18, 31, v17
  v_lshrrev_b32 v19, 5, v17
  s_lshl_b32 s79, s43, 15
  v_and_b32 v36, 15, v17
  v_xor_b32 v36, v36, v19
  v_lshlrev_b32 v36, 4, v36
  v_lshl_add_u32 v36, v18, 8, v36
  v_add_u32 v24, s79, v36
  v_xor_b32 v25, 32, v24
  v_xor_b32 v26, 64, v24
  v_xor_b32 v27, 96, v24
  v_xor_b32 v28, 128, v24
  v_xor_b32 v29, 160, v24
  v_xor_b32 v30, 192, v24
  v_xor_b32 v31, 224, v24
  v_bfe_u32 v36, v17, 2, 2
  v_lshlrev_b32 v36, 6, v36
  v_lshl_add_u32 v36, v19, 10, v36
  v_bfe_u32 v37, v17, 4, 1
  v_lshl_add_u32 v36, v37, 5, v36
  v_and_b32 v37, 3, v17
  v_lshl_add_u32 v36, v37, 3, v36
  v_add_u32 v1, 98304, v36
  s_mul_i32 s64, s43, 12288
  s_add_u32 s64, s64, 49152
  s_lshl_b32 s0, s46, 17
  s_lshl_b32 s77, s42, 11
  s_add_u32 s0, s0, s77
  s_and_b32 s77, s40, 3
  s_lshl_b32 s1, s77, 9
  v_lshrrev_b32 v36, 4, v17
  v_and_b32 v37, 7, v17
  v_lshrrev_b32 v38, 3, v17
  v_xor_b32 v36, v36, v37
  v_lshlrev_b32 v36, 4, v36
  v_lshl_add_u32 v3, v38, 12, v36
  v_xor_b32 v4, 64, v3
  v_add_u32 v4, 31744, v4
  v_bfe_u32 v36, v17, 1, 3
  v_xor_b32 v36, v36, v19
  v_lshlrev_b32 v36, 4, v36
  v_lshl_add_u32 v36, v18, 7, v36
  v_add_u32 v5, s64, v36
  v_xor_b32 v6, 32, v5
  v_xor_b32 v7, 64, v5
  v_xor_b32 v8, 96, v5
  s_mov_b32 s70, 0x3f80
  s_mov_b32 s71, 0x3f800000
  s_mov_b32 s72, 0x3f803f80
  s_lshl_b32 s77, s40, 4
  s_add_u32 s77, s77, s41
  s_lshl_b32 s77, s77, 8
  s_add_u32 s48, s77, 4096
  s_waitcnt lgkmcnt(0)
  s_add_u32 s44, s44, 1
  v_mov_b32 v36, 0
  v_mov_b32 v37, 0
  v_mov_b32 v38, 0
  v_mov_b32 v39, 0
  s_lshl_b32 s77, s85, 8
  s_add_u32 s65, s61, s77
  s_add_u32 m0, s62, 8192
  s_nop 0
  buffer_load_dwordx4 v20, s[4:7], s65 offen lds
  buffer_load_dwordx4 v21, s[4:7], s65 offen offset:1024 lds
  buffer_load_dwordx4 v22, s[4:7], s65 offen offset:2048 lds
  buffer_load_dwordx4 v23, s[4:7], s65 offen offset:3072 lds
  s_xor_b32 s65, s65, 16384
  s_xor_b32 m0, m0, 4096
  s_nop 0
  buffer_load_dwordx4 v20, s[4:7], s65 offen lds
  buffer_load_dwordx4 v21, s[4:7], s65 offen offset:1024 lds
  buffer_load_dwordx4 v22, s[4:7], s65 offen offset:2048 lds
  buffer_load_dwordx4 v23, s[4:7], s65 offen offset:3072 lds
  s_waitcnt vmcnt(8)
  ds_read_b128 v[128:131], v24
  ds_read_b128 v[132:135], v25
  ds_read_b128 v[136:139], v26
  ds_read_b128 v[140:143], v27
  ds_read_b128 v[144:147], v28
  ds_read_b128 v[148:151], v29
  ds_read_b128 v[152:155], v30
  ds_read_b128 v[156:159], v31
  s_lshl_b32 s77, s86, 8
  s_add_u32 s65, s61, s77
  s_add_u32 m0, s62, 16384
  s_waitcnt lgkmcnt(7)
  v_dot2c_f32_bf16 v36, s72, v128
  v_dot2c_f32_bf16 v38, v128, v128
  v_dot2c_f32_bf16 v37, s72, v129
  v_dot2c_f32_bf16 v39, v129, v129
  v_dot2c_f32_bf16 v36, s72, v130
  v_dot2c_f32_bf16 v38, v130, v130
  v_dot2c_f32_bf16 v37, s72, v131
  buffer_load_dwordx4 v20, s[4:7], s65 offen lds
  v_dot2c_f32_bf16 v39, v131, v131
  s_waitcnt lgkmcnt(6)
  v_dot2c_f32_bf16 v36, s72, v132
  v_dot2c_f32_bf16 v38, v132, v132
  v_dot2c_f32_bf16 v37, s72, v133
  v_dot2c_f32_bf16 v39, v133, v133
  v_dot2c_f32_bf16 v36, s72, v134
  buffer_load_dwordx4 v21, s[4:7], s65 offen offset:1024 lds
  v_dot2c_f32_bf16 v38, v134, v134
  v_dot2c_f32_bf16 v37, s72, v135
  v_dot2c_f32_bf16 v39, v135, v135
  s_waitcnt lgkmcnt(5)
  v_dot2c_f32_bf16 v36, s72, v136
  v_dot2c_f32_bf16 v38, v136, v136
  v_dot2c_f32_bf16 v37, s72, v137
  buffer_load_dwordx4 v22, s[4:7], s65 offen offset:2048 lds
  v_dot2c_f32_bf16 v39, v137, v137
  v_dot2c_f32_bf16 v36, s72, v138
  v_dot2c_f32_bf16 v38, v138, v138
  v_dot2c_f32_bf16 v37, s72, v139
  v_dot2c_f32_bf16 v39, v139, v139
  s_waitcnt lgkmcnt(4)
  v_dot2c_f32_bf16 v36, s72, v140
  buffer_load_dwordx4 v23, s[4:7], s65 offen offset:3072 lds
  v_dot2c_f32_bf16 v38, v140, v140
  v_dot2c_f32_bf16 v37, s72, v141
  v_dot2c_f32_bf16 v39, v141, v141
  v_dot2c_f32_bf16 v36, s72, v142
  v_dot2c_f32_bf16 v38, v142, v142
  v_dot2c_f32_bf16 v37, s72, v143
  v_dot2c_f32_bf16 v39, v143, v143
  s_xor_b32 s65, s65, 16384
  s_xor_b32 m0, m0, 4096
  s_waitcnt lgkmcnt(3)
  v_dot2c_f32_bf16 v36, s72, v144
  v_dot2c_f32_bf16 v38, v144, v144
  v_dot2c_f32_bf16 v37, s72, v145
  v_dot2c_f32_bf16 v39, v145, v145
  v_dot2c_f32_bf16 v36, s72, v146
  v_dot2c_f32_bf16 v38, v146, v146
  v_dot2c_f32_bf16 v37, s72, v147
  buffer_load_dwordx4 v20, s[4:7], s65 offen lds
  v_dot2c_f32_bf16 v39, v147, v147
  s_waitcnt lgkmcnt(2)
  v_dot2c_f32_bf16 v36, s72, v148
  v_dot2c_f32_bf16 v38, v148, v148
  v_dot2c_f32_bf16 v37, s72, v149
  v_dot2c_f32_bf16 v39, v149, v149
  v_dot2c_f32_bf16 v36, s72, v150
  buffer_load_dwordx4 v21, s[4:7], s65 offen offset:1024 lds
  v_dot2c_f32_bf16 v38, v150, v150
  v_dot2c_f32_bf16 v37, s72, v151
  v_dot2c_f32_bf16 v39, v151, v151
  s_waitcnt lgkmcnt(1)
  v_dot2c_f32_bf16 v36, s72, v152
  v_dot2c_f32_bf16 v38, v152, v152
  v_dot2c_f32_bf16 v37, s72, v153
  buffer_load_dwordx4 v22, s[4:7], s65 offen offset:2048 lds
  v_dot2c_f32_bf16 v39, v153, v153
  v_dot2c_f32_bf16 v36, s72, v154
  v_dot2c_f32_bf16 v38, v154, v154
  v_dot2c_f32_bf16 v37, s72, v155
  v_dot2c_f32_bf16 v39, v155, v155
  s_waitcnt lgkmcnt(0)
  v_dot2c_f32_bf16 v36, s72, v156
  buffer_load_dwordx4 v23, s[4:7], s65 offen offset:3072 lds
  v_dot2c_f32_bf16 v38, v156, v156
  v_dot2c_f32_bf16 v37, s72, v157
  v_dot2c_f32_bf16 v39, v157, v157
  v_dot2c_f32_bf16 v36, s72, v158
  v_dot2c_f32_bf16 v38, v158, v158
  v_dot2c_f32_bf16 v37, s72, v159
  v_dot2c_f32_bf16 v39, v159, v159
  s_waitcnt vmcnt(8)
  ds_read_b128 v[160:163], v24 offset:8192
  ds_read_b128 v[164:167], v25 offset:8192
  ds_read_b128 v[168:171], v26 offset:8192
  ds_read_b128 v[172:175], v27 offset:8192
  ds_read_b128 v[176:179], v28 offset:8192
  ds_read_b128 v[180:183], v29 offset:8192
  ds_read_b128 v[184:187], v30 offset:8192
  ds_read_b128 v[188:191], v31 offset:8192
  s_lshl_b32 s77, s87, 8
  s_add_u32 s65, s61, s77
  s_add_u32 m0, s62, 24576
  s_waitcnt lgkmcnt(7)
  v_dot2c_f32_bf16 v36, s72, v160
  v_dot2c_f32_bf16 v38, v160, v160
  v_dot2c_f32_bf16 v37, s72, v161
  v_dot2c_f32_bf16 v39, v161, v161
  v_dot2c_f32_bf16 v36, s72, v162
  v_dot2c_f32_bf16 v38, v162, v162
  v_dot2c_f32_bf16 v37, s72, v163
  buffer_load_dwordx4 v20, s[4:7], s65 offen lds
  v_dot2c_f32_bf16 v39, v163, v163
  s_waitcnt lgkmcnt(6)
  v_dot2c_f32_bf16 v36, s72, v164
  v_dot2c_f32_bf16 v38, v164, v164
  v_dot2c_f32_bf16 v37, s72, v165
  v_dot2c_f32_bf16 v39, v165, v165
  v_dot2c_f32_bf16 v36, s72, v166
  buffer_load_dwordx4 v21, s[4:7], s65 offen offset:1024 lds
  v_dot2c_f32_bf16 v38, v166, v166
  v_dot2c_f32_bf16 v37, s72, v167
  v_dot2c_f32_bf16 v39, v167, v167
  s_waitcnt lgkmcnt(5)
  v_dot2c_f32_bf16 v36, s72, v168
  v_dot2c_f32_bf16 v38, v168, v168
  v_dot2c_f32_bf16 v37, s72, v169
  buffer_load_dwordx4 v22, s[4:7], s65 offen offset:2048 lds
  v_dot2c_f32_bf16 v39, v169, v169
  v_dot2c_f32_bf16 v36, s72, v170
  v_dot2c_f32_bf16 v38, v170, v170
  v_dot2c_f32_bf16 v37, s72, v171
  v_dot2c_f32_bf16 v39, v171, v171
  s_waitcnt lgkmcnt(4)
  v_dot2c_f32_bf16 v36, s72, v172
  buffer_load_dwordx4 v23, s[4:7], s65 offen offset:3072 lds
  v_dot2c_f32_bf16 v38, v172, v172
  v_dot2c_f32_bf16 v37, s72, v173
  v_dot2c_f32_bf16 v39, v173, v173
  v_dot2c_f32_bf16 v36, s72, v174
  v_dot2c_f32_bf16 v38, v174, v174
  v_dot2c_f32_bf16 v37, s72, v175
  v_dot2c_f32_bf16 v39, v175, v175
  s_xor_b32 s65, s65, 16384
  s_xor_b32 m0, m0, 4096
  s_waitcnt lgkmcnt(3)
  v_dot2c_f32_bf16 v36, s72, v176
  v_dot2c_f32_bf16 v38, v176, v176
  v_dot2c_f32_bf16 v37, s72, v177
  v_dot2c_f32_bf16 v39, v177, v177
  v_dot2c_f32_bf16 v36, s72, v178
  v_dot2c_f32_bf16 v38, v178, v178
  v_dot2c_f32_bf16 v37, s72, v179
  buffer_load_dwordx4 v20, s[4:7], s65 offen lds
  v_dot2c_f32_bf16 v39, v179, v179
  s_waitcnt lgkmcnt(2)
  v_dot2c_f32_bf16 v36, s72, v180
  v_dot2c_f32_bf16 v38, v180, v180
  v_dot2c_f32_bf16 v37, s72, v181
  v_dot2c_f32_bf16 v39, v181, v181
  v_dot2c_f32_bf16 v36, s72, v182
  buffer_load_dwordx4 v21, s[4:7], s65 offen offset:1024 lds
  v_dot2c_f32_bf16 v38, v182, v182
  v_dot2c_f32_bf16 v37, s72, v183
  v_dot2c_f32_bf16 v39, v183, v183
  s_waitcnt lgkmcnt(1)
  v_dot2c_f32_bf16 v36, s72, v184
  v_dot2c_f32_bf16 v38, v184, v184
  v_dot2c_f32_bf16 v37, s72, v185
  buffer_load_dwordx4 v22, s[4:7], s65 offen offset:2048 lds
  v_dot2c_f32_bf16 v39, v185, v185
  v_dot2c_f32_bf16 v36, s72, v186
  v_dot2c_f32_bf16 v38, v186, v186
  v_dot2c_f32_bf16 v37, s72, v187
  v_dot2c_f32_bf16 v39, v187, v187
  s_waitcnt lgkmcnt(0)
  v_dot2c_f32_bf16 v36, s72, v188
  buffer_load_dwordx4 v23, s[4:7], s65 offen offset:3072 lds
  v_dot2c_f32_bf16 v38, v188, v188
  v_dot2c_f32_bf16 v37, s72, v189
  v_dot2c_f32_bf16 v39, v189, v189
  v_dot2c_f32_bf16 v36, s72, v190
  v_dot2c_f32_bf16 v38, v190, v190
  v_dot2c_f32_bf16 v37, s72, v191
  v_dot2c_f32_bf16 v39, v191, v191
  s_cmp_ge_u32 s41, 14
  s_cbranch_scc1 L_light
  s_waitcnt vmcnt(8)
  ds_read_b128 v[192:195], v24 offset:16384
  ds_read_b128 v[196:199], v25 offset:16384
  ds_read_b128 v[200:203], v26 offset:16384
  ds_read_b128 v[204:207], v27 offset:16384
  ds_read_b128 v[208:211], v28 offset:16384
  ds_read_b128 v[212:215], v29 offset:16384
  ds_read_b128 v[216:219], v30 offset:16384
  ds_read_b128 v[220:223], v31 offset:16384
  s_mul_i32 s80, s84, 458752
  s_waitcnt lgkmcnt(7)
  v_dot2c_f32_bf16 v36, s72, v192
  v_dot2c_f32_bf16 v38, v192, v192
  v_dot2c_f32_bf16 v37, s72, v193
  s_mul_i32 s84, s84, 393216
  v_dot2c_f32_bf16 v39, v193, v193
  v_dot2c_f32_bf16 v36, s72, v194
  v_dot2c_f32_bf16 v38, v194, v194
  s_mul_i32 s81, s85, 458752
  v_dot2c_f32_bf16 v37, s72, v195
  v_dot2c_f32_bf16 v39, v195, v195
  s_waitcnt lgkmcnt(6)
  s_mul_i32 s85, s85, 393216
  v_dot2c_f32_bf16 v36, s72, v196
  v_dot2c_f32_bf16 v38, v196, v196
  v_dot2c_f32_bf16 v37, s72, v197
  s_mul_i32 s82, s86, 458752
  v_dot2c_f32_bf16 v39, v197, v197
  v_dot2c_f32_bf16 v36, s72, v198
  v_dot2c_f32_bf16 v38, v198, v198
  s_mul_i32 s86, s86, 393216
  v_dot2c_f32_bf16 v37, s72, v199
  v_dot2c_f32_bf16 v39, v199, v199
  s_waitcnt lgkmcnt(5)
  s_mul_i32 s83, s87, 458752
  v_dot2c_f32_bf16 v36, s72, v200
  v_dot2c_f32_bf16 v38, v200, v200
  v_dot2c_f32_bf16 v37, s72, v201
  s_mul_i32 s87, s87, 393216
  v_dot2c_f32_bf16 v39, v201, v201
  v_dot2c_f32_bf16 v36, s72, v202
  v_dot2c_f32_bf16 v38, v202, v202
  v_dot2c_f32_bf16 v37, s72, v203
  v_cmp_lt_u32 vcc, 511, v0
  v_dot2c_f32_bf16 v39, v203, v203
  s_waitcnt lgkmcnt(4)
  v_dot2c_f32_bf16 v36, s72, v204
  v_mov_b32 v32, s85
  v_dot2c_f32_bf16 v38, v204, v204
  v_dot2c_f32_bf16 v37, s72, v205
  v_dot2c_f32_bf16 v39, v205, v205
  v_mov_b32 v33, s87
  v_dot2c_f32_bf16 v36, s72, v206
  v_dot2c_f32_bf16 v38, v206, v206
  v_dot2c_f32_bf16 v37, s72, v207
  v_cndmask_b32 v32, v32, v33, vcc
  v_dot2c_f32_bf16 v39, v207, v207
  s_waitcnt lgkmcnt(3)
  v_dot2c_f32_bf16 v36, s72, v208
  v_add_u32 v44, v32, v43
  v_dot2c_f32_bf16 v38, v208, v208
  v_dot2c_f32_bf16 v37, s72, v209
  v_dot2c_f32_bf16 v39, v209, v209
  v_mov_b32 v32, s84
  v_dot2c_f32_bf16 v36, s72, v210
  v_dot2c_f32_bf16 v38, v210, v210
  v_dot2c_f32_bf16 v37, s72, v211
  v_mov_b32 v33, s86
  v_dot2c_f32_bf16 v39, v211, v211
  s_waitcnt lgkmcnt(2)
  v_dot2c_f32_bf16 v36, s72, v212
  v_cndmask_b32 v32, v32, v33, vcc
  v_dot2c_f32_bf16 v38, v212, v212
  v_dot2c_f32_bf16 v37, s72, v213
  v_dot2c_f32_bf16 v39, v213, v213
  v_dot2c_f32_bf16 v36, s72, v214
  v_add_u32 v43, v32, v43
  v_dot2c_f32_bf16 v38, v214, v214
  v_dot2c_f32_bf16 v37, s72, v215
  v_dot2c_f32_bf16 v39, v215, v215
  s_add_u32 m0, s63, 32768
  s_waitcnt lgkmcnt(1)
  v_dot2c_f32_bf16 v36, s72, v216
  v_dot2c_f32_bf16 v38, v216, v216
  v_add_u32 v2, s80, v45
  v_dot2c_f32_bf16 v37, s72, v217
  v_dot2c_f32_bf16 v39, v217, v217
  v_dot2c_f32_bf16 v36, s72, v218
  buffer_load_dwordx4 v2, s[12:15], 0 offen lds
  v_dot2c_f32_bf16 v38, v218, v218
  v_dot2c_f32_bf16 v37, s72, v219
  v_dot2c_f32_bf16 v39, v219, v219
  buffer_load_dwordx4 v2, s[12:15], s49 offen offset:1024 lds
  s_waitcnt lgkmcnt(0)
  v_dot2c_f32_bf16 v36, s72, v220
  v_dot2c_f32_bf16 v38, v220, v220
  buffer_load_dwordx4 v2, s[12:15], s50 offen offset:2048 lds
  v_dot2c_f32_bf16 v37, s72, v221
  v_dot2c_f32_bf16 v39, v221, v221
  v_dot2c_f32_bf16 v36, s72, v222
  buffer_load_dwordx4 v2, s[12:15], s51 offen offset:3072 lds
  v_dot2c_f32_bf16 v38, v222, v222
  v_dot2c_f32_bf16 v37, s72, v223
  v_dot2c_f32_bf16 v39, v223, v223
  s_waitcnt vmcnt(4)
  ds_read_b128 v[224:227], v24 offset:24576
  ds_read_b128 v[228:231], v25 offset:24576
  ds_read_b128 v[232:235], v26 offset:24576
  ds_read_b128 v[236:239], v27 offset:24576
  ds_read_b128 v[240:243], v28 offset:24576
  ds_read_b128 v[244:247], v29 offset:24576
  ds_read_b128 v[248:251], v30 offset:24576
  ds_read_b128 v[252:255], v31 offset:24576
  s_add_u32 m0, s63, 49152
  s_waitcnt lgkmcnt(7)
  v_dot2c_f32_bf16 v36, s72, v224
  v_dot2c_f32_bf16 v38, v224, v224
  v_dot2c_f32_bf16 v37, s72, v225
  v_dot2c_f32_bf16 v39, v225, v225
  v_dot2c_f32_bf16 v36, s72, v226
  v_dot2c_f32_bf16 v38, v226, v226
  v_dot2c_f32_bf16 v37, s72, v227
  v_dot2c_f32_bf16 v39, v227, v227
  s_waitcnt lgkmcnt(6)
  v_dot2c_f32_bf16 v36, s72, v228
  v_dot2c_f32_bf16 v38, v228, v228
  v_add_u32 v2, s81, v45
  v_dot2c_f32_bf16 v37, s72, v229
  v_dot2c_f32_bf16 v39, v229, v229
  v_dot2c_f32_bf16 v36, s72, v230
  v_dot2c_f32_bf16 v38, v230, v230
  v_dot2c_f32_bf16 v37, s72, v231
  v_dot2c_f32_bf16 v39, v231, v231
  s_waitcnt lgkmcnt(5)
  v_dot2c_f32_bf16 v36, s72, v232
  v_dot2c_f32_bf16 v38, v232, v232
  v_dot2c_f32_bf16 v37, s72, v233
  v_dot2c_f32_bf16 v39, v233, v233
  v_dot2c_f32_bf16 v36, s72, v234
  buffer_load_dwordx4 v2, s[12:15], 0 offen lds
  v_dot2c_f32_bf16 v38, v234, v234
  v_dot2c_f32_bf16 v37, s72, v235
  v_dot2c_f32_bf16 v39, v235, v235
  s_waitcnt lgkmcnt(4)
  v_dot2c_f32_bf16 v36, s72, v236
  v_dot2c_f32_bf16 v38, v236, v236
  v_dot2c_f32_bf16 v37, s72, v237
  v_dot2c_f32_bf16 v39, v237, v237
  v_dot2c_f32_bf16 v36, s72, v238
  v_dot2c_f32_bf16 v38, v238, v238
  v_dot2c_f32_bf16 v37, s72, v239
  v_dot2c_f32_bf16 v39, v239, v239
  buffer_load_dwordx4 v2, s[12:15], s49 offen offset:1024 lds
  s_waitcnt lgkmcnt(3)
  v_dot2c_f32_bf16 v36, s72, v240
  v_dot2c_f32_bf16 v38, v240, v240
  v_dot2c_f32_bf16 v37, s72, v241
  v_dot2c_f32_bf16 v39, v241, v241
  v_dot2c_f32_bf16 v36, s72, v242
  v_dot2c_f32_bf16 v38, v242, v242
  v_dot2c_f32_bf16 v37, s72, v243
  v_dot2c_f32_bf16 v39, v243, v243
  s_waitcnt lgkmcnt(2)
  v_dot2c_f32_bf16 v36, s72, v244
  v_dot2c_f32_bf16 v38, v244, v244
  buffer_load_dwordx4 v2, s[12:15], s50 offen offset:2048 lds
  v_dot2c_f32_bf16 v37, s72, v245
  v_dot2c_f32_bf16 v39, v245, v245
  v_dot2c_f32_bf16 v36, s72, v246
  v_dot2c_f32_bf16 v38, v246, v246
  v_dot2c_f32_bf16 v37, s72, v247
  v_dot2c_f32_bf16 v39, v247, v247
  s_waitcnt lgkmcnt(1)
  v_dot2c_f32_bf16 v36, s72, v248
  v_dot2c_f32_bf16 v38, v248, v248
  v_dot2c_f32_bf16 v37, s72, v249
  v_dot2c_f32_bf16 v39, v249, v249
  v_dot2c_f32_bf16 v36, s72, v250
  buffer_load_dwordx4 v2, s[12:15], s51 offen offset:3072 lds
  v_dot2c_f32_bf16 v38, v250, v250
  v_dot2c_f32_bf16 v37, s72, v251
  v_dot2c_f32_bf16 v39, v251, v251
  s_waitcnt lgkmcnt(0)
  v_dot2c_f32_bf16 v36, s72, v252
  v_dot2c_f32_bf16 v38, v252, v252
  v_dot2c_f32_bf16 v37, s72, v253
  v_dot2c_f32_bf16 v39, v253, v253
  v_dot2c_f32_bf16 v36, s72, v254
  v_dot2c_f32_bf16 v38, v254, v254
  v_dot2c_f32_bf16 v37, s72, v255
  v_dot2c_f32_bf16 v39, v255, v255
  s_barrier
  s_nop 0
  v_add_f32 v36, v36, v37
  v_add_f32 v38, v38, v39
  v_mov_b32 v37, v36
  s_nop 1
  v_permlane32_swap_b32 v36, v37
  v_add_f32 v36, v36, v37
  v_mov_b32 v39, v38
  s_nop 1
  v_permlane32_swap_b32 v38, v39
  v_add_f32 v38, v38, v39
  v_mul_f32 v36, 0x3b000000, v36
  v_mul_f32 v38, 0x3b000000, v38
  v_fma_f32 v38, -v36, v36, v38
  v_max_f32 v38, 0, v38
  v_cvt_pk_bf16_f32 v36, v36, v36
  v_and_b32 v36, 0xffff0000, v36
  v_cvt_pk_bf16_f32 v38, v38, v38
  v_and_b32 v38, 0xffff0000, v38
  v_add_f32 v38, 0x3727c5ac, v38
  v_cvt_pk_bf16_f32 v38, v38, v38
  v_and_b32 v38, 0xffff0000, v38
  v_sqrt_f32 v38, v38
  v_xor_b32 v36, 0x80000000, v36
  v_cvt_pk_bf16_f32 v13, v38, v38
  v_and_b32 v13, 0xffff0000, v13
  v_rcp_f32 v10, v13
  s_nop 0
  v_mul_f32 v12, 0xc0135761, v10
  v_mul_f32 v37, v10, v10
  v_mul_f32 v37, 0x3d372713, v37
  v_mul_f32 v11, v37, v12
  s_add_u32 m0, s63, 0
  v_dot2_f32_bf16 v16, v128, s70, v36
  v_dot2_f32_bf16 v17, v128, s71, v36
  v_dot2_f32_bf16 v18, v129, s70, v36
  v_dot2_f32_bf16 v19, v129, s71, v36
  v_dot2_f32_bf16 v20, v130, s70, v36
  v_dot2_f32_bf16 v21, v130, s71, v36
  v_dot2_f32_bf16 v22, v131, s70, v36
  v_dot2_f32_bf16 v23, v131, s71, v36
  v_cvt_pk_bf16_f32 v128, v16, v17
  v_cvt_pk_bf16_f32 v129, v18, v19
  v_cvt_pk_bf16_f32 v130, v20, v21
  v_cvt_pk_bf16_f32 v131, v22, v23
  v_dot2_f32_bf16 v16, v132, s70, v36
  v_dot2_f32_bf16 v17, v132, s71, v36
  v_dot2_f32_bf16 v18, v133, s70, v36
  v_dot2_f32_bf16 v19, v133, s71, v36
  v_dot2_f32_bf16 v20, v134, s70, v36
  v_dot2_f32_bf16 v21, v134, s71, v36
  v_dot2_f32_bf16 v22, v135, s70, v36
  v_dot2_f32_bf16 v23, v135, s71, v36
  v_cvt_pk_bf16_f32 v132, v16, v17
  v_cvt_pk_bf16_f32 v133, v18, v19
  v_cvt_pk_bf16_f32 v134, v20, v21
  v_cvt_pk_bf16_f32 v135, v22, v23
  v_dot2_f32_bf16 v16, v136, s70, v36
  v_dot2_f32_bf16 v17, v136, s71, v36
  v_dot2_f32_bf16 v18, v137, s70, v36
  v_dot2_f32_bf16 v19, v137, s71, v36
  v_dot2_f32_bf16 v20, v138, s70, v36
  v_dot2_f32_bf16 v21, v138, s71, v36
  v_dot2_f32_bf16 v22, v139, s70, v36
  v_dot2_f32_bf16 v23, v139, s71, v36
  v_add_u32 v2, s82, v45
  v_cvt_pk_bf16_f32 v136, v16, v17
  v_cvt_pk_bf16_f32 v137, v18, v19
  v_cvt_pk_bf16_f32 v138, v20, v21
  v_cvt_pk_bf16_f32 v139, v22, v23
  v_dot2_f32_bf16 v16, v140, s70, v36
  v_dot2_f32_bf16 v17, v140, s71, v36
  v_dot2_f32_bf16 v18, v141, s70, v36
  v_dot2_f32_bf16 v19, v141, s71, v36
  v_dot2_f32_bf16 v20, v142, s70, v36
  v_dot2_f32_bf16 v21, v142, s71, v36
  v_dot2_f32_bf16 v22, v143, s70, v36
  v_dot2_f32_bf16 v23, v143, s71, v36
  v_cvt_pk_bf16_f32 v140, v16, v17
  v_cvt_pk_bf16_f32 v141, v18, v19
  v_cvt_pk_bf16_f32 v142, v20, v21
  v_cvt_pk_bf16_f32 v143, v22, v23
  v_dot2_f32_bf16 v16, v144, s70, v36
  v_dot2_f32_bf16 v17, v144, s71, v36
  v_dot2_f32_bf16 v18, v145, s70, v36
  v_dot2_f32_bf16 v19, v145, s71, v36
  v_dot2_f32_bf16 v20, v146, s70, v36
  v_dot2_f32_bf16 v21, v146, s71, v36
  v_dot2_f32_bf16 v22, v147, s70, v36
  v_dot2_f32_bf16 v23, v147, s71, v36
  v_cvt_pk_bf16_f32 v144, v16, v17
  v_cvt_pk_bf16_f32 v145, v18, v19
  v_cvt_pk_bf16_f32 v146, v20, v21
  v_cvt_pk_bf16_f32 v147, v22, v23
  v_dot2_f32_bf16 v16, v148, s70, v36
  v_dot2_f32_bf16 v17, v148, s71, v36
  v_dot2_f32_bf16 v18, v149, s70, v36
  v_dot2_f32_bf16 v19, v149, s71, v36
  buffer_load_dwordx4 v2, s[12:15], 0 offen lds
  v_dot2_f32_bf16 v20, v150, s70, v36
  v_dot2_f32_bf16 v21, v150, s71, v36
  v_dot2_f32_bf16 v22, v151, s70, v36
  v_dot2_f32_bf16 v23, v151, s71, v36
  v_cvt_pk_bf16_f32 v148, v16, v17
  v_cvt_pk_bf16_f32 v149, v18, v19
  v_cvt_pk_bf16_f32 v150, v20, v21
  v_cvt_pk_bf16_f32 v151, v22, v23
  v_dot2_f32_bf16 v16, v152, s70, v36
  v_dot2_f32_bf16 v17, v152, s71, v36
  v_dot2_f32_bf16 v18, v153, s70, v36
  v_dot2_f32_bf16 v19, v153, s71, v36
  v_dot2_f32_bf16 v20, v154, s70, v36
  v_dot2_f32_bf16 v21, v154, s71, v36
  v_dot2_f32_bf16 v22, v155, s70, v36
  v_dot2_f32_bf16 v23, v155, s71, v36
  v_cvt_pk_bf16_f32 v152, v16, v17
  v_cvt_pk_bf16_f32 v153, v18, v19
  v_cvt_pk_bf16_f32 v154, v20, v21
  v_cvt_pk_bf16_f32 v155, v22, v23
  v_dot2_f32_bf16 v16, v156, s70, v36
  v_dot2_f32_bf16 v17, v156, s71, v36
  v_dot2_f32_bf16 v18, v157, s70, v36
  v_dot2_f32_bf16 v19, v157, s71, v36
  v_dot2_f32_bf16 v20, v158, s70, v36
  v_dot2_f32_bf16 v21, v158, s71, v36
  v_dot2_f32_bf16 v22, v159, s70, v36
  v_dot2_f32_bf16 v23, v159, s71, v36
  v_cvt_pk_bf16_f32 v156, v16, v17
  v_cvt_pk_bf16_f32 v157, v18, v19
  v_cvt_pk_bf16_f32 v158, v20, v21
  v_cvt_pk_bf16_f32 v159, v22, v23
  buffer_load_dwordx4 v2, s[12:15], s49 offen offset:1024 lds
  v_dot2_f32_bf16 v16, v160, s70, v36
  v_dot2_f32_bf16 v17, v160, s71, v36
  v_dot2_f32_bf16 v18, v161, s70, v36
  v_dot2_f32_bf16 v19, v161, s71, v36
  v_dot2_f32_bf16 v20, v162, s70, v36
  v_dot2_f32_bf16 v21, v162, s71, v36
  v_dot2_f32_bf16 v22, v163, s70, v36
  v_dot2_f32_bf16 v23, v163, s71, v36
  v_cvt_pk_bf16_f32 v160, v16, v17
  v_cvt_pk_bf16_f32 v161, v18, v19
  v_cvt_pk_bf16_f32 v162, v20, v21
  v_cvt_pk_bf16_f32 v163, v22, v23
  v_dot2_f32_bf16 v16, v164, s70, v36
  v_dot2_f32_bf16 v17, v164, s71, v36
  v_dot2_f32_bf16 v18, v165, s70, v36
  v_dot2_f32_bf16 v19, v165, s71, v36
  v_dot2_f32_bf16 v20, v166, s70, v36
  v_dot2_f32_bf16 v21, v166, s71, v36
  v_dot2_f32_bf16 v22, v167, s70, v36
  v_dot2_f32_bf16 v23, v167, s71, v36
  v_cvt_pk_bf16_f32 v164, v16, v17
  v_cvt_pk_bf16_f32 v165, v18, v19
  v_cvt_pk_bf16_f32 v166, v20, v21
  v_cvt_pk_bf16_f32 v167, v22, v23
  v_dot2_f32_bf16 v16, v168, s70, v36
  v_dot2_f32_bf16 v17, v168, s71, v36
  v_dot2_f32_bf16 v18, v169, s70, v36
  v_dot2_f32_bf16 v19, v169, s71, v36
  v_dot2_f32_bf16 v20, v170, s70, v36
  v_dot2_f32_bf16 v21, v170, s71, v36
  v_dot2_f32_bf16 v22, v171, s70, v36
  v_dot2_f32_bf16 v23, v171, s71, v36
  buffer_load_dwordx4 v2, s[12:15], s50 offen offset:2048 lds
  v_cvt_pk_bf16_f32 v168, v16, v17
  v_cvt_pk_bf16_f32 v169, v18, v19
  v_cvt_pk_bf16_f32 v170, v20, v21
  v_cvt_pk_bf16_f32 v171, v22, v23
  v_dot2_f32_bf16 v16, v172, s70, v36
  v_dot2_f32_bf16 v17, v172, s71, v36
  v_dot2_f32_bf16 v18, v173, s70, v36
  v_dot2_f32_bf16 v19, v173, s71, v36
  v_dot2_f32_bf16 v20, v174, s70, v36
  v_dot2_f32_bf16 v21, v174, s71, v36
  v_dot2_f32_bf16 v22, v175, s70, v36
  v_dot2_f32_bf16 v23, v175, s71, v36
  v_cvt_pk_bf16_f32 v172, v16, v17
  v_cvt_pk_bf16_f32 v173, v18, v19
  v_cvt_pk_bf16_f32 v174, v20, v21
  v_cvt_pk_bf16_f32 v175, v22, v23
  v_dot2_f32_bf16 v16, v176, s70, v36
  v_dot2_f32_bf16 v17, v176, s71, v36
  v_dot2_f32_bf16 v18, v177, s70, v36
  v_dot2_f32_bf16 v19, v177, s71, v36
  v_dot2_f32_bf16 v20, v178, s70, v36
  v_dot2_f32_bf16 v21, v178, s71, v36
  v_dot2_f32_bf16 v22, v179, s70, v36
  v_dot2_f32_bf16 v23, v179, s71, v36
  v_cvt_pk_bf16_f32 v176, v16, v17
  v_cvt_pk_bf16_f32 v177, v18, v19
  v_cvt_pk_bf16_f32 v178, v20, v21
  v_cvt_pk_bf16_f32 v179, v22, v23
  v_dot2_f32_bf16 v16, v180, s70, v36
  v_dot2_f32_bf16 v17, v180, s71, v36
  v_dot2_f32_bf16 v18, v181, s70, v36
  v_dot2_f32_bf16 v19, v181, s71, v36
  buffer_load_dwordx4 v2, s[12:15], s51 offen offset:3072 lds
  v_dot2_f32_bf16 v20, v182, s70, v36
  v_dot2_f32_bf16 v21, v182, s71, v36
  v_dot2_f32_bf16 v22, v183, s70, v36
  v_dot2_f32_bf16 v23, v183, s71, v36
  v_cvt_pk_bf16_f32 v180, v16, v17
  v_cvt_pk_bf16_f32 v181, v18, v19
  v_cvt_pk_bf16_f32 v182, v20, v21
  v_cvt_pk_bf16_f32 v183, v22, v23
  v_dot2_f32_bf16 v16, v184, s70, v36
  v_dot2_f32_bf16 v17, v184, s71, v36
  v_dot2_f32_bf16 v18, v185, s70, v36
  v_dot2_f32_bf16 v19, v185, s71, v36
  v_dot2_f32_bf16 v20, v186, s70, v36
  v_dot2_f32_bf16 v21, v186, s71, v36
  v_dot2_f32_bf16 v22, v187, s70, v36
  v_dot2_f32_bf16 v23, v187, s71, v36
  v_cvt_pk_bf16_f32 v184, v16, v17
  v_cvt_pk_bf16_f32 v185, v18, v19
  v_cvt_pk_bf16_f32 v186, v20, v21
  v_cvt_pk_bf16_f32 v187, v22, v23
  v_dot2_f32_bf16 v16, v188, s70, v36
  v_dot2_f32_bf16 v17, v188, s71, v36
  v_dot2_f32_bf16 v18, v189, s70, v36
  v_dot2_f32_bf16 v19, v189, s71, v36
  v_dot2_f32_bf16 v20, v190, s70, v36
  v_dot2_f32_bf16 v21, v190, s71, v36
  v_dot2_f32_bf16 v22, v191, s70, v36
  v_dot2_f32_bf16 v23, v191, s71, v36
  v_cvt_pk_bf16_f32 v188, v16, v17
  v_cvt_pk_bf16_f32 v189, v18, v19
  v_cvt_pk_bf16_f32 v190, v20, v21
  v_cvt_pk_bf16_f32 v191, v22, v23
  s_add_u32 m0, s63, 16384
  v_dot2_f32_bf16 v16, v192, s70, v36
  v_dot2_f32_bf16 v17, v192, s71, v36
  v_dot2_f32_bf16 v18, v193, s70, v36
  v_dot2_f32_bf16 v19, v193, s71, v36
  v_dot2_f32_bf16 v20, v194, s70, v36
  v_dot2_f32_bf16 v21, v194, s71, v36
  v_dot2_f32_bf16 v22, v195, s70, v36
  v_dot2_f32_bf16 v23, v195, s71, v36
  v_cvt_pk_bf16_f32 v192, v16, v17
  v_cvt_pk_bf16_f32 v193, v18, v19
  v_cvt_pk_bf16_f32 v194, v20, v21
  v_cvt_pk_bf16_f32 v195, v22, v23
  v_dot2_f32_bf16 v16, v196, s70, v36
  v_dot2_f32_bf16 v17, v196, s71, v36
  v_dot2_f32_bf16 v18, v197, s70, v36
  v_dot2_f32_bf16 v19, v197, s71, v36
  v_dot2_f32_bf16 v20, v198, s70, v36
  v_dot2_f32_bf16 v21, v198, s71, v36
  v_dot2_f32_bf16 v22, v199, s70, v36
  v_dot2_f32_bf16 v23, v199, s71, v36
  v_cvt_pk_bf16_f32 v196, v16, v17
  v_cvt_pk_bf16_f32 v197, v18, v19
  v_cvt_pk_bf16_f32 v198, v20, v21
  v_cvt_pk_bf16_f32 v199, v22, v23
  v_dot2_f32_bf16 v16, v200, s70, v36
  v_dot2_f32_bf16 v17, v200, s71, v36
  v_dot2_f32_bf16 v18, v201, s70, v36
  v_dot2_f32_bf16 v19, v201, s71, v36
  v_dot2_f32_bf16 v20, v202, s70, v36
  v_dot2_f32_bf16 v21, v202, s71, v36
  v_dot2_f32_bf16 v22, v203, s70, v36
  v_dot2_f32_bf16 v23, v203, s71, v36
  v_add_u32 v2, s83, v45
  v_cvt_pk_bf16_f32 v200, v16, v17
  v_cvt_pk_bf16_f32 v201, v18, v19
  v_cvt_pk_bf16_f32 v202, v20, v21
  v_cvt_pk_bf16_f32 v203, v22, v23
  v_dot2_f32_bf16 v16, v204, s70, v36
  v_dot2_f32_bf16 v17, v204, s71, v36
  v_dot2_f32_bf16 v18, v205, s70, v36
  v_dot2_f32_bf16 v19, v205, s71, v36
  v_dot2_f32_bf16 v20, v206, s70, v36
  v_dot2_f32_bf16 v21, v206, s71, v36
  v_dot2_f32_bf16 v22, v207, s70, v36
  v_dot2_f32_bf16 v23, v207, s71, v36
  v_cvt_pk_bf16_f32 v204, v16, v17
  v_cvt_pk_bf16_f32 v205, v18, v19
  v_cvt_pk_bf16_f32 v206, v20, v21
  v_cvt_pk_bf16_f32 v207, v22, v23
  v_dot2_f32_bf16 v16, v208, s70, v36
  v_dot2_f32_bf16 v17, v208, s71, v36
  v_dot2_f32_bf16 v18, v209, s70, v36
  v_dot2_f32_bf16 v19, v209, s71, v36
  v_dot2_f32_bf16 v20, v210, s70, v36
  v_dot2_f32_bf16 v21, v210, s71, v36
  v_dot2_f32_bf16 v22, v211, s70, v36
  v_dot2_f32_bf16 v23, v211, s71, v36
  v_cvt_pk_bf16_f32 v208, v16, v17
  v_cvt_pk_bf16_f32 v209, v18, v19
  v_cvt_pk_bf16_f32 v210, v20, v21
  v_cvt_pk_bf16_f32 v211, v22, v23
  v_dot2_f32_bf16 v16, v212, s70, v36
  v_dot2_f32_bf16 v17, v212, s71, v36
  v_dot2_f32_bf16 v18, v213, s70, v36
  v_dot2_f32_bf16 v19, v213, s71, v36
  buffer_load_dwordx4 v2, s[12:15], 0 offen lds
  v_dot2_f32_bf16 v20, v214, s70, v36
  v_dot2_f32_bf16 v21, v214, s71, v36
  v_dot2_f32_bf16 v22, v215, s70, v36
  v_dot2_f32_bf16 v23, v215, s71, v36
  v_cvt_pk_bf16_f32 v212, v16, v17
  v_cvt_pk_bf16_f32 v213, v18, v19
  v_cvt_pk_bf16_f32 v214, v20, v21
  v_cvt_pk_bf16_f32 v215, v22, v23
  v_dot2_f32_bf16 v16, v216, s70, v36
  v_dot2_f32_bf16 v17, v216, s71, v36
  v_dot2_f32_bf16 v18, v217, s70, v36
  v_dot2_f32_bf16 v19, v217, s71, v36
  v_dot2_f32_bf16 v20, v218, s70, v36
  v_dot2_f32_bf16 v21, v218, s71, v36
  v_dot2_f32_bf16 v22, v219, s70, v36
  v_dot2_f32_bf16 v23, v219, s71, v36
  v_cvt_pk_bf16_f32 v216, v16, v17
  v_cvt_pk_bf16_f32 v217, v18, v19
  v_cvt_pk_bf16_f32 v218, v20, v21
  v_cvt_pk_bf16_f32 v219, v22, v23
  v_dot2_f32_bf16 v16, v220, s70, v36
  v_dot2_f32_bf16 v17, v220, s71, v36
  v_dot2_f32_bf16 v18, v221, s70, v36
  v_dot2_f32_bf16 v19, v221, s71, v36
  v_dot2_f32_bf16 v20, v222, s70, v36
  v_dot2_f32_bf16 v21, v222, s71, v36
  v_dot2_f32_bf16 v22, v223, s70, v36
  v_dot2_f32_bf16 v23, v223, s71, v36
  v_cvt_pk_bf16_f32 v220, v16, v17
  v_cvt_pk_bf16_f32 v221, v18, v19
  v_cvt_pk_bf16_f32 v222, v20, v21
  v_cvt_pk_bf16_f32 v223, v22, v23
  buffer_load_dwordx4 v2, s[12:15], s49 offen offset:1024 lds
  v_dot2_f32_bf16 v16, v224, s70, v36
  v_dot2_f32_bf16 v17, v224, s71, v36
  v_dot2_f32_bf16 v18, v225, s70, v36
  v_dot2_f32_bf16 v19, v225, s71, v36
  v_dot2_f32_bf16 v20, v226, s70, v36
  v_dot2_f32_bf16 v21, v226, s71, v36
  v_dot2_f32_bf16 v22, v227, s70, v36
  v_dot2_f32_bf16 v23, v227, s71, v36
  v_cvt_pk_bf16_f32 v224, v16, v17
  v_cvt_pk_bf16_f32 v225, v18, v19
  v_cvt_pk_bf16_f32 v226, v20, v21
  v_cvt_pk_bf16_f32 v227, v22, v23
  v_dot2_f32_bf16 v16, v228, s70, v36
  v_dot2_f32_bf16 v17, v228, s71, v36
  v_dot2_f32_bf16 v18, v229, s70, v36
  v_dot2_f32_bf16 v19, v229, s71, v36
  v_dot2_f32_bf16 v20, v230, s70, v36
  v_dot2_f32_bf16 v21, v230, s71, v36
  v_dot2_f32_bf16 v22, v231, s70, v36
  v_dot2_f32_bf16 v23, v231, s71, v36
  v_cvt_pk_bf16_f32 v228, v16, v17
  v_cvt_pk_bf16_f32 v229, v18, v19
  v_cvt_pk_bf16_f32 v230, v20, v21
  v_cvt_pk_bf16_f32 v231, v22, v23
  v_dot2_f32_bf16 v16, v232, s70, v36
  v_dot2_f32_bf16 v17, v232, s71, v36
  v_dot2_f32_bf16 v18, v233, s70, v36
  v_dot2_f32_bf16 v19, v233, s71, v36
  v_dot2_f32_bf16 v20, v234, s70, v36
  v_dot2_f32_bf16 v21, v234, s71, v36
  v_dot2_f32_bf16 v22, v235, s70, v36
  v_dot2_f32_bf16 v23, v235, s71, v36
  buffer_load_dwordx4 v2, s[12:15], s50 offen offset:2048 lds
  v_cvt_pk_bf16_f32 v232, v16, v17
  v_cvt_pk_bf16_f32 v233, v18, v19
  v_cvt_pk_bf16_f32 v234, v20, v21
  v_cvt_pk_bf16_f32 v235, v22, v23
  v_dot2_f32_bf16 v16, v236, s70, v36
  v_dot2_f32_bf16 v17, v236, s71, v36
  v_dot2_f32_bf16 v18, v237, s70, v36
  v_dot2_f32_bf16 v19, v237, s71, v36
  v_dot2_f32_bf16 v20, v238, s70, v36
  v_dot2_f32_bf16 v21, v238, s71, v36
  v_dot2_f32_bf16 v22, v239, s70, v36
  v_dot2_f32_bf16 v23, v239, s71, v36
  v_cvt_pk_bf16_f32 v236, v16, v17
  v_cvt_pk_bf16_f32 v237, v18, v19
  v_cvt_pk_bf16_f32 v238, v20, v21
  v_cvt_pk_bf16_f32 v239, v22, v23
  v_dot2_f32_bf16 v16, v240, s70, v36
  v_dot2_f32_bf16 v17, v240, s71, v36
  v_dot2_f32_bf16 v18, v241, s70, v36
  v_dot2_f32_bf16 v19, v241, s71, v36
  v_dot2_f32_bf16 v20, v242, s70, v36
  v_dot2_f32_bf16 v21, v242, s71, v36
  v_dot2_f32_bf16 v22, v243, s70, v36
  v_dot2_f32_bf16 v23, v243, s71, v36
  v_cvt_pk_bf16_f32 v240, v16, v17
  v_cvt_pk_bf16_f32 v241, v18, v19
  v_cvt_pk_bf16_f32 v242, v20, v21
  v_cvt_pk_bf16_f32 v243, v22, v23
  v_dot2_f32_bf16 v16, v244, s70, v36
  v_dot2_f32_bf16 v17, v244, s71, v36
  v_dot2_f32_bf16 v18, v245, s70, v36
  v_dot2_f32_bf16 v19, v245, s71, v36
  buffer_load_dwordx4 v2, s[12:15], s51 offen offset:3072 lds
  v_dot2_f32_bf16 v20, v246, s70, v36
  v_dot2_f32_bf16 v21, v246, s71, v36
  v_dot2_f32_bf16 v22, v247, s70, v36
  v_dot2_f32_bf16 v23, v247, s71, v36
  v_cvt_pk_bf16_f32 v244, v16, v17
  v_cvt_pk_bf16_f32 v245, v18, v19
  v_cvt_pk_bf16_f32 v246, v20, v21
  v_cvt_pk_bf16_f32 v247, v22, v23
  v_dot2_f32_bf16 v16, v248, s70, v36
  v_dot2_f32_bf16 v17, v248, s71, v36
  v_dot2_f32_bf16 v18, v249, s70, v36
  v_dot2_f32_bf16 v19, v249, s71, v36
  v_dot2_f32_bf16 v20, v250, s70, v36
  v_dot2_f32_bf16 v21, v250, s71, v36
  v_dot2_f32_bf16 v22, v251, s70, v36
  v_dot2_f32_bf16 v23, v251, s71, v36
  v_cvt_pk_bf16_f32 v248, v16, v17
  v_cvt_pk_bf16_f32 v249, v18, v19
  v_cvt_pk_bf16_f32 v250, v20, v21
  v_cvt_pk_bf16_f32 v251, v22, v23
  v_dot2_f32_bf16 v16, v252, s70, v36
  v_dot2_f32_bf16 v17, v252, s71, v36
  v_dot2_f32_bf16 v18, v253, s70, v36
  v_dot2_f32_bf16 v19, v253, s71, v36
  v_dot2_f32_bf16 v20, v254, s70, v36
  v_dot2_f32_bf16 v21, v254, s71, v36
  v_dot2_f32_bf16 v22, v255, s70, v36
  v_dot2_f32_bf16 v23, v255, s71, v36
  v_cvt_pk_bf16_f32 v252, v16, v17
  v_cvt_pk_bf16_f32 v253, v18, v19
  v_cvt_pk_bf16_f32 v254, v20, v21
  v_cvt_pk_bf16_f32 v255, v22, v23
  s_waitcnt vmcnt(12)
  s_barrier
  ds_read_b64_tr_b16 a[224:225], v1 offset:32768
  ds_read_b64_tr_b16 a[226:227], v1 offset:33024
  ds_read_b64_tr_b16 a[228:229], v1 offset:33280
  ds_read_b64_tr_b16 a[230:231], v1 offset:33536
  ds_read_b64_tr_b16 a[232:233], v1 offset:34816
  ds_read_b64_tr_b16 a[234:235], v1 offset:35072
  ds_read_b64_tr_b16 a[236:237], v1 offset:35328
  ds_read_b64_tr_b16 a[238:239], v1 offset:35584
  ds_read_b64_tr_b16 a[240:241], v1 offset:36864
  ds_read_b64_tr_b16 a[242:243], v1 offset:37120
  ds_read_b64_tr_b16 a[244:245], v1 offset:37376
  ds_read_b64_tr_b16 a[246:247], v1 offset:37632
  ds_read_b64_tr_b16 a[248:249], v1 offset:38912
  ds_read_b64_tr_b16 a[250:251], v1 offset:39168
  ds_read_b64_tr_b16 a[252:253], v1 offset:39424
  ds_read_b64_tr_b16 a[254:255], v1 offset:39680
  s_waitcnt lgkmcnt(8)
  v_mfma_f32_32x32x16_bf16 v[48:63], a[224:227], v[128:131], 0
  ds_read_b64_tr_b16 a[224:225], v1 offset:40960
  ds_read_b64_tr_b16 a[226:227], v1 offset:41216
  v_mfma_f32_32x32x16_bf16 v[64:79], a[228:231], v[128:131], 0
  ds_read_b64_tr_b16 a[228:229], v1 offset:41472
  ds_read_b64_tr_b16 a[230:231], v1 offset:41728
  v_mfma_f32_32x32x16_bf16 v[48:63], a[232:235], v[132:135], v[48:63]
  ds_read_b64_tr_b16 a[232:233], v1 offset:43008
  ds_read_b64_tr_b16 a[234:235], v1 offset:43264
  v_mfma_f32_32x32x16_bf16 v[64:79], a[236:239], v[132:135], v[64:79]
  ds_read_b64_tr_b16 a[236:237], v1 offset:43520
  ds_read_b64_tr_b16 a[238:239], v1 offset:43776
  s_waitcnt lgkmcnt(8)
  v_mfma_f32_32x32x16_bf16 v[48:63], a[240:243], v[136:139], v[48:63]
  ds_read_b64_tr_b16 a[240:241], v1 offset:45056
  ds_read_b64_tr_b16 a[242:243], v1 offset:45312
  v_and_b32 v16, 0x1f0, v0
  v_lshrrev_b32 v16, 2, v16
  v_mfma_f32_32x32x16_bf16 v[64:79], a[244:247], v[136:139], v[64:79]
  ds_read_b64_tr_b16 a[244:245], v1 offset:45568
  ds_read_b64_tr_b16 a[246:247], v1 offset:45824
  v_mfma_f32_32x32x16_bf16 v[48:63], a[248:251], v[140:143], v[48:63]
  ds_read_b64_tr_b16 a[248:249], v1 offset:47104
  ds_read_b64_tr_b16 a[250:251], v1 offset:47360
  s_lshl_b32 s77, s43, 7
  v_add_u32 v16, s77, v16
  v_mfma_f32_32x32x16_bf16 v[64:79], a[252:255], v[140:143], v[64:79]
  ds_write_b32 v16, v10
  ds_read_b64_tr_b16 a[252:253], v1 offset:47616
  ds_read_b64_tr_b16 a[254:255], v1 offset:47872
  s_waitcnt lgkmcnt(9)
  v_mfma_f32_32x32x16_bf16 v[48:63], a[224:227], v[144:147], v[48:63]
  v_mfma_f32_32x32x16_bf16 v[64:79], a[228:231], v[144:147], v[64:79]
  s_waitcnt vmcnt(8) lgkmcnt(0)
  s_barrier
  ds_read_b64_tr_b16 a[224:225], v1 offset:49152
  ds_read_b64_tr_b16 a[226:227], v1 offset:49408
  ds_read_b64_tr_b16 a[228:229], v1 offset:49664
  ds_read_b64_tr_b16 a[230:231], v1 offset:49920
  v_mfma_f32_32x32x16_bf16 v[48:63], a[232:235], v[148:151], v[48:63]
  ds_read_b64_tr_b16 a[232:233], v1 offset:51200
  ds_read_b64_tr_b16 a[234:235], v1 offset:51456
  s_add_u32 m0, s63, 32768
  v_add_u32 v2, s84, v46
  v_mfma_f32_32x32x16_bf16 v[64:79], a[236:239], v[148:151], v[64:79]
  ds_read_b64_tr_b16 a[236:237], v1 offset:51712
  ds_read_b64_tr_b16 a[238:239], v1 offset:51968
  v_mfma_f32_32x32x16_bf16 v[48:63], a[240:243], v[152:155], v[48:63]
  ds_read_b64_tr_b16 a[240:241], v1 offset:53248
  ds_read_b64_tr_b16 a[242:243], v1 offset:53504
  v_mfma_f32_32x32x16_bf16 v[64:79], a[244:247], v[152:155], v[64:79]
  buffer_load_dwordx4 v2, s[8:11], 0 offen lds
  ds_read_b64_tr_b16 a[244:245], v1 offset:53760
  ds_read_b64_tr_b16 a[246:247], v1 offset:54016
  v_mfma_f32_32x32x16_bf16 v[48:63], a[248:251], v[156:159], v[48:63]
  ds_read_b64_tr_b16 a[248:249], v1 offset:55296
  ds_read_b64_tr_b16 a[250:251], v1 offset:55552
  v_mfma_f32_32x32x16_bf16 v[64:79], a[252:255], v[156:159], v[64:79]
  ds_read_b64_tr_b16 a[252:253], v1 offset:55808
  ds_read_b64_tr_b16 a[254:255], v1 offset:56064
  s_waitcnt lgkmcnt(8)
  v_mfma_f32_32x32x16_bf16 v[48:63], a[224:227], v[160:163], v[48:63]
  buffer_load_dwordx4 v2, s[8:11], s53 offen offset:1024 lds
  ds_read_b64_tr_b16 a[224:225], v1 offset:57344
  ds_read_b64_tr_b16 a[226:227], v1 offset:57600
  v_mfma_f32_32x32x16_bf16 v[64:79], a[228:231], v[160:163], v[64:79]
  ds_read_b64_tr_b16 a[228:229], v1 offset:57856
  ds_read_b64_tr_b16 a[230:231], v1 offset:58112
  v_mfma_f32_32x32x16_bf16 v[48:63], a[232:235], v[164:167], v[48:63]
  ds_read_b64_tr_b16 a[232:233], v1 offset:59392
  ds_read_b64_tr_b16 a[234:235], v1 offset:59648
  v_mfma_f32_32x32x16_bf16 v[64:79], a[236:239], v[164:167], v[64:79]
  ds_read_b64_tr_b16 a[236:237], v1 offset:59904
  ds_read_b64_tr_b16 a[238:239], v1 offset:60160
  s_waitcnt lgkmcnt(8)
  v_mfma_f32_32x32x16_bf16 v[48:63], a[240:243], v[168:171], v[48:63]
  buffer_load_dwordx4 v2, s[8:11], s54 offen offset:2048 lds
  ds_read_b64_tr_b16 a[240:241], v1 offset:61440
  ds_read_b64_tr_b16 a[242:243], v1 offset:61696
  v_mfma_f32_32x32x16_bf16 v[64:79], a[244:247], v[168:171], v[64:79]
  ds_read_b64_tr_b16 a[244:245], v1 offset:61952
  ds_read_b64_tr_b16 a[246:247], v1 offset:62208
  v_mfma_f32_32x32x16_bf16 v[48:63], a[248:251], v[172:175], v[48:63]
  ds_read_b64_tr_b16 a[248:249], v1 offset:63488
  ds_read_b64_tr_b16 a[250:251], v1 offset:63744
  v_mfma_f32_32x32x16_bf16 v[64:79], a[252:255], v[172:175], v[64:79]
  ds_read_b64_tr_b16 a[252:253], v1 offset:64000
  ds_read_b64_tr_b16 a[254:255], v1 offset:64256
  s_waitcnt lgkmcnt(8)
  v_mfma_f32_32x32x16_bf16 v[48:63], a[224:227], v[176:179], v[48:63]
  buffer_load_dwordx4 v2, s[8:11], s55 offen offset:3072 lds
  v_mfma_f32_32x32x16_bf16 v[64:79], a[228:231], v[176:179], v[64:79]
  s_waitcnt vmcnt(8) lgkmcnt(0)
  s_barrier
  ds_read_b64_tr_b16 a[224:225], v1
  ds_read_b64_tr_b16 a[226:227], v1 offset:256
  ds_read_b64_tr_b16 a[228:229], v1 offset:512
  ds_read_b64_tr_b16 a[230:231], v1 offset:768
  v_mfma_f32_32x32x16_bf16 v[48:63], a[232:235], v[180:183], v[48:63]
  ds_read_b64_tr_b16 a[232:233], v1 offset:2048
  ds_read_b64_tr_b16 a[234:235], v1 offset:2304
  s_add_u32 m0, s63, 49152
  v_add_u32 v2, s85, v46
  v_mfma_f32_32x32x16_bf16 v[64:79], a[236:239], v[180:183], v[64:79]
  ds_read_b64_tr_b16 a[236:237], v1 offset:2560
  ds_read_b64_tr_b16 a[238:239], v1 offset:2816
  v_mfma_f32_32x32x16_bf16 v[48:63], a[240:243], v[184:187], v[48:63]
  ds_read_b64_tr_b16 a[240:241], v1 offset:4096
  ds_read_b64_tr_b16 a[242:243], v1 offset:4352
  v_mfma_f32_32x32x16_bf16 v[64:79], a[244:247], v[184:187], v[64:79]
  buffer_load_dwordx4 v2, s[8:11], 0 offen lds
  ds_read_b64_tr_b16 a[244:245], v1 offset:4608
  ds_read_b64_tr_b16 a[246:247], v1 offset:4864
  v_mfma_f32_32x32x16_bf16 v[48:63], a[248:251], v[188:191], v[48:63]
  ds_read_b64_tr_b16 a[248:249], v1 offset:6144
  ds_read_b64_tr_b16 a[250:251], v1 offset:6400
  v_mfma_f32_32x32x16_bf16 v[64:79], a[252:255], v[188:191], v[64:79]
  ds_read_b64_tr_b16 a[252:253], v1 offset:6656
  ds_read_b64_tr_b16 a[254:255], v1 offset:6912
  s_waitcnt lgkmcnt(8)
  v_mfma_f32_32x32x16_bf16 v[48:63], a[224:227], v[192:195], v[48:63]
  buffer_load_dwordx4 v2, s[8:11], s53 offen offset:1024 lds
  ds_read_b64_tr_b16 a[224:225], v1 offset:8192
  ds_read_b64_tr_b16 a[226:227], v1 offset:8448
  v_mfma_f32_32x32x16_bf16 v[64:79], a[228:231], v[192:195], v[64:79]
  ds_read_b64_tr_b16 a[228:229], v1 offset:8704
  ds_read_b64_tr_b16 a[230:231], v1 offset:8960
  v_mfma_f32_32x32x16_bf16 v[48:63], a[232:235], v[196:199], v[48:63]
  ds_read_b64_tr_b16 a[232:233], v1 offset:10240
  ds_read_b64_tr_b16 a[234:235], v1 offset:10496
  v_mfma_f32_32x32x16_bf16 v[64:79], a[236:239], v[196:199], v[64:79]
  ds_read_b64_tr_b16 a[236:237], v1 offset:10752
  ds_read_b64_tr_b16 a[238:239], v1 offset:11008
  s_waitcnt lgkmcnt(8)
  v_mfma_f32_32x32x16_bf16 v[48:63], a[240:243], v[200:203], v[48:63]
  buffer_load_dwordx4 v2, s[8:11], s54 offen offset:2048 lds
  ds_read_b64_tr_b16 a[240:241], v1 offset:12288
  ds_read_b64_tr_b16 a[242:243], v1 offset:12544
  v_mfma_f32_32x32x16_bf16 v[64:79], a[244:247], v[200:203], v[64:79]
  ds_read_b64_tr_b16 a[244:245], v1 offset:12800
  ds_read_b64_tr_b16 a[246:247], v1 offset:13056
  v_mfma_f32_32x32x16_bf16 v[48:63], a[248:251], v[204:207], v[48:63]
  ds_read_b64_tr_b16 a[248:249], v1 offset:14336
  ds_read_b64_tr_b16 a[250:251], v1 offset:14592
  v_mfma_f32_32x32x16_bf16 v[64:79], a[252:255], v[204:207], v[64:79]
  ds_read_b64_tr_b16 a[252:253], v1 offset:14848
  ds_read_b64_tr_b16 a[254:255], v1 offset:15104
  s_waitcnt lgkmcnt(8)
  v_mfma_f32_32x32x16_bf16 v[48:63], a[224:227], v[208:211], v[48:63]
  buffer_load_dwordx4 v2, s[8:11], s55 offen offset:3072 lds
  v_mfma_f32_32x32x16_bf16 v[64:79], a[228:231], v[208:211], v[64:79]
  s_waitcnt vmcnt(8) lgkmcnt(0)
  s_barrier
  ds_read_b64_tr_b16 a[224:225], v1 offset:16384
  ds_read_b64_tr_b16 a[226:227], v1 offset:16640
  ds_read_b64_tr_b16 a[228:229], v1 offset:16896
  ds_read_b64_tr_b16 a[230:231], v1 offset:17152
  v_mfma_f32_32x32x16_bf16 v[48:63], a[232:235], v[212:215], v[48:63]
  ds_read_b64_tr_b16 a[232:233], v1 offset:18432
  ds_read_b64_tr_b16 a[234:235], v1 offset:18688
  s_add_u32 m0, s63, 0
  v_add_u32 v2, s86, v46
  v_mfma_f32_32x32x16_bf16 v[64:79], a[236:239], v[212:215], v[64:79]
  ds_read_b64_tr_b16 a[236:237], v1 offset:18944
  ds_read_b64_tr_b16 a[238:239], v1 offset:19200
  v_mfma_f32_32x32x16_bf16 v[48:63], a[240:243], v[216:219], v[48:63]
  ds_read_b64_tr_b16 a[240:241], v1 offset:20480
  ds_read_b64_tr_b16 a[242:243], v1 offset:20736
  v_mfma_f32_32x32x16_bf16 v[64:79], a[244:247], v[216:219], v[64:79]
  buffer_load_dwordx4 v2, s[8:11], 0 offen lds
  ds_read_b64_tr_b16 a[244:245], v1 offset:20992
  ds_read_b64_tr_b16 a[246:247], v1 offset:21248
  v_mfma_f32_32x32x16_bf16 v[48:63], a[248:251], v[220:223], v[48:63]
  ds_read_b64_tr_b16 a[248:249], v1 offset:22528
  ds_read_b64_tr_b16 a[250:251], v1 offset:22784
  v_mfma_f32_32x32x16_bf16 v[64:79], a[252:255], v[220:223], v[64:79]
  ds_read_b64_tr_b16 a[252:253], v1 offset:23040
  ds_read_b64_tr_b16 a[254:255], v1 offset:23296
  s_waitcnt lgkmcnt(8)
  v_mfma_f32_32x32x16_bf16 v[48:63], a[224:227], v[224:227], v[48:63]
  buffer_load_dwordx4 v2, s[8:11], s53 offen offset:1024 lds
  ds_read_b64_tr_b16 a[224:225], v1 offset:24576
  ds_read_b64_tr_b16 a[226:227], v1 offset:24832
  v_mfma_f32_32x32x16_bf16 v[64:79], a[228:231], v[224:227], v[64:79]
  ds_read_b64_tr_b16 a[228:229], v1 offset:25088
  ds_read_b64_tr_b16 a[230:231], v1 offset:25344
  v_mfma_f32_32x32x16_bf16 v[48:63], a[232:235], v[228:231], v[48:63]
  ds_read_b64_tr_b16 a[232:233], v1 offset:26624
  ds_read_b64_tr_b16 a[234:235], v1 offset:26880
  v_mfma_f32_32x32x16_bf16 v[64:79], a[236:239], v[228:231], v[64:79]
  ds_read_b64_tr_b16 a[236:237], v1 offset:27136
  ds_read_b64_tr_b16 a[238:239], v1 offset:27392
  s_waitcnt lgkmcnt(8)
  v_mfma_f32_32x32x16_bf16 v[48:63], a[240:243], v[232:235], v[48:63]
  buffer_load_dwordx4 v2, s[8:11], s54 offen offset:2048 lds
  ds_read_b64_tr_b16 a[240:241], v1 offset:28672
  ds_read_b64_tr_b16 a[242:243], v1 offset:28928
  v_mfma_f32_32x32x16_bf16 v[64:79], a[244:247], v[232:235], v[64:79]
  ds_read_b64_tr_b16 a[244:245], v1 offset:29184
  ds_read_b64_tr_b16 a[246:247], v1 offset:29440
  v_mfma_f32_32x32x16_bf16 v[48:63], a[248:251], v[236:239], v[48:63]
  ds_read_b64_tr_b16 a[248:249], v1 offset:30720
  ds_read_b64_tr_b16 a[250:251], v1 offset:30976
  v_mfma_f32_32x32x16_bf16 v[64:79], a[252:255], v[236:239], v[64:79]
  ds_read_b64_tr_b16 a[252:253], v1 offset:31232
  ds_read_b64_tr_b16 a[254:255], v1 offset:31488
  s_waitcnt lgkmcnt(8)
  v_mfma_f32_32x32x16_bf16 v[48:63], a[224:227], v[240:243], v[48:63]
  buffer_load_dwordx4 v2, s[8:11], s55 offen offset:3072 lds
  v_mfma_f32_32x32x16_bf16 v[64:79], a[228:231], v[240:243], v[64:79]
  s_waitcnt vmcnt(8) lgkmcnt(0)
  s_barrier
  ds_read_b64_tr_b16 a[224:225], v1 offset:32768
  ds_read_b64_tr_b16 a[226:227], v1 offset:33024
  ds_read_b64_tr_b16 a[228:229], v1 offset:33280
  ds_read_b64_tr_b16 a[230:231], v1 offset:33536
  v_mfma_f32_32x32x16_bf16 v[48:63], a[232:235], v[244:247], v[48:63]
  ds_read_b64_tr_b16 a[232:233], v1 offset:34816
  ds_read_b64_tr_b16 a[234:235], v1 offset:35072
  s_add_u32 m0, s63, 16384
  v_add_u32 v2, s87, v46
  v_mfma_f32_32x32x16_bf16 v[64:79], a[236:239], v[244:247], v[64:79]
  ds_read_b64_tr_b16 a[236:237], v1 offset:35328
  ds_read_b64_tr_b16 a[238:239], v1 offset:35584
  v_mfma_f32_32x32x16_bf16 v[48:63], a[240:243], v[248:251], v[48:63]
  ds_read_b64_tr_b16 a[240:241], v1 offset:36864
  ds_read_b64_tr_b16 a[242:243], v1 offset:37120
  v_mfma_f32_32x32x16_bf16 v[64:79], a[244:247], v[248:251], v[64:79]
  buffer_load_dwordx4 v2, s[8:11], 0 offen lds
  ds_read_b64_tr_b16 a[244:245], v1 offset:37376
  ds_read_b64_tr_b16 a[246:247], v1 offset:37632
  v_mfma_f32_32x32x16_bf16 v[48:63], a[248:251], v[252:255], v[48:63]
  ds_read_b64_tr_b16 a[248:249], v1 offset:38912
  ds_read_b64_tr_b16 a[250:251], v1 offset:39168
  v_mfma_f32_32x32x16_bf16 v[64:79], a[252:255], v[252:255], v[64:79]
  ds_read_b64_tr_b16 a[252:253], v1 offset:39424
  ds_read_b64_tr_b16 a[254:255], v1 offset:39680
  s_waitcnt lgkmcnt(8)
  v_mfma_f32_32x32x16_bf16 v[80:95], a[224:227], v[128:131], 0
  buffer_load_dwordx4 v2, s[8:11], s53 offen offset:1024 lds
  ds_read_b64_tr_b16 a[224:225], v1 offset:40960
  ds_read_b64_tr_b16 a[226:227], v1 offset:41216
  v_mfma_f32_32x32x16_bf16 v[96:111], v[128:131], a[228:231], 0
  ds_read_b64_tr_b16 a[228:229], v1 offset:41472
  ds_read_b64_tr_b16 a[230:231], v1 offset:41728
  v_mfma_f32_32x32x16_bf16 v[80:95], a[232:235], v[132:135], v[80:95]
  ds_read_b64_tr_b16 a[232:233], v1 offset:43008
  ds_read_b64_tr_b16 a[234:235], v1 offset:43264
  v_mfma_f32_32x32x16_bf16 v[96:111], v[132:135], a[236:239], v[96:111]
  ds_read_b64_tr_b16 a[236:237], v1 offset:43520
  ds_read_b64_tr_b16 a[238:239], v1 offset:43776
  v_mul_f32 v16, v48, v48
  v_mul_f32 v17, v49, v49
  v_mul_f32 v18, v50, v50
  v_mul_f32 v19, v51, v51
  v_fma_f32 v16, v16, v11, v12
  v_fma_f32 v17, v17, v11, v12
  s_waitcnt lgkmcnt(8)
  v_mfma_f32_32x32x16_bf16 v[80:95], a[240:243], v[136:139], v[80:95]
  buffer_load_dwordx4 v2, s[8:11], s54 offen offset:2048 lds
  ds_read_b64_tr_b16 a[240:241], v1 offset:45056
  ds_read_b64_tr_b16 a[242:243], v1 offset:45312
  v_fma_f32 v18, v18, v11, v12
  v_fma_f32 v19, v19, v11, v12
  v_mfma_f32_32x32x16_bf16 v[96:111], v[136:139], a[244:247], v[96:111]
  ds_read_b64_tr_b16 a[244:245], v1 offset:45568
  ds_read_b64_tr_b16 a[246:247], v1 offset:45824
  v_mul_f32 v16, v16, v48
  v_mul_f32 v17, v17, v49
  v_mul_f32 v18, v18, v50
  v_mul_f32 v19, v19, v51
  v_exp_f32 v16, v16
  v_mfma_f32_32x32x16_bf16 v[80:95], a[248:251], v[140:143], v[80:95]
  ds_read_b64_tr_b16 a[248:249], v1 offset:47104
  ds_read_b64_tr_b16 a[250:251], v1 offset:47360
  v_exp_f32 v17, v17
  v_exp_f32 v18, v18
  v_exp_f32 v19, v19
  v_fma_f32 v16, v16, v13, v13
  v_mfma_f32_32x32x16_bf16 v[96:111], v[140:143], a[252:255], v[96:111]
  ds_read_b64_tr_b16 a[252:253], v1 offset:47616
  ds_read_b64_tr_b16 a[254:255], v1 offset:47872
  v_fma_f32 v17, v17, v13, v13
  v_fma_f32 v18, v18, v13, v13
  v_fma_f32 v19, v19, v13, v13
  v_rcp_f32 v16, v16
  s_waitcnt lgkmcnt(8)
  v_mfma_f32_32x32x16_bf16 v[80:95], a[224:227], v[144:147], v[80:95]
  buffer_load_dwordx4 v2, s[8:11], s55 offen offset:3072 lds
  v_rcp_f32 v17, v17
  v_rcp_f32 v18, v18
  v_mfma_f32_32x32x16_bf16 v[96:111], v[144:147], a[228:231], v[96:111]
  v_rcp_f32 v19, v19
  s_waitcnt vmcnt(8) lgkmcnt(0)
  s_barrier
  ds_read_b64_tr_b16 a[224:225], v1 offset:49152
  ds_read_b64_tr_b16 a[226:227], v1 offset:49408
  ds_read_b64_tr_b16 a[228:229], v1 offset:49664
  ds_read_b64_tr_b16 a[230:231], v1 offset:49920
  v_mfma_f32_32x32x16_bf16 v[80:95], a[232:235], v[148:151], v[80:95]
  ds_read_b64_tr_b16 a[232:233], v1 offset:51200
  ds_read_b64_tr_b16 a[234:235], v1 offset:51456
  v_mul_f32 v48, v48, v16
  v_mul_f32 v49, v49, v17
  v_mul_f32 v50, v50, v18
  v_mul_f32 v51, v51, v19
  v_mov_b32 v14, v48
  v_mul_f32 v15, v48, v48
  s_add_u32 m0, s63, 32768
  v_mfma_f32_32x32x16_bf16 v[96:111], v[148:151], a[236:239], v[96:111]
  buffer_load_dwordx4 v43, s[8:11], 0 offen lds
  ds_read_b64_tr_b16 a[236:237], v1 offset:51712
  ds_read_b64_tr_b16 a[238:239], v1 offset:51968
  v_add_f32 v14, v14, v49
  v_mfma_f32_32x32x16_bf16 v[80:95], a[240:243], v[152:155], v[80:95]
  buffer_load_dwordx4 v43, s[8:11], s53 offen offset:1024 lds
  ds_read_b64_tr_b16 a[240:241], v1 offset:53248
  ds_read_b64_tr_b16 a[242:243], v1 offset:53504
  v_fmac_f32 v15, v49, v49
  v_add_f32 v14, v14, v50
  v_mfma_f32_32x32x16_bf16 v[96:111], v[152:155], a[244:247], v[96:111]
  ds_read_b64_tr_b16 a[244:245], v1 offset:53760
  ds_read_b64_tr_b16 a[246:247], v1 offset:54016
  v_fmac_f32 v15, v50, v50
  v_add_f32 v14, v14, v51
  v_fmac_f32 v15, v51, v51
  v_mul_f32 v16, v52, v52
  v_mul_f32 v17, v53, v53
  v_mul_f32 v18, v54, v54
  v_mfma_f32_32x32x16_bf16 v[80:95], a[248:251], v[156:159], v[80:95]
  buffer_load_dwordx4 v43, s[8:11], s54 offen offset:2048 lds
  ds_read_b64_tr_b16 a[248:249], v1 offset:55296
  ds_read_b64_tr_b16 a[250:251], v1 offset:55552
  v_mul_f32 v19, v55, v55
  v_fma_f32 v16, v16, v11, v12
  v_mfma_f32_32x32x16_bf16 v[96:111], v[156:159], a[252:255], v[96:111]
  ds_read_b64_tr_b16 a[252:253], v1 offset:55808
  ds_read_b64_tr_b16 a[254:255], v1 offset:56064
  v_fma_f32 v17, v17, v11, v12
  v_fma_f32 v18, v18, v11, v12
  v_fma_f32 v19, v19, v11, v12
  v_mul_f32 v16, v16, v52
  v_mul_f32 v17, v17, v53
  v_mul_f32 v18, v18, v54
  s_waitcnt lgkmcnt(8)
  v_mfma_f32_32x32x16_bf16 v[80:95], a[224:227], v[160:163], v[80:95]
  buffer_load_dwordx4 v43, s[8:11], s55 offen offset:3072 lds
  ds_read_b64_tr_b16 a[224:225], v1 offset:57344
  ds_read_b64_tr_b16 a[226:227], v1 offset:57600
  v_mul_f32 v19, v19, v55
  v_mfma_f32_32x32x16_bf16 v[96:111], v[160:163], a[228:231], v[96:111]
  ds_read_b64_tr_b16 a[228:229], v1 offset:57856
  ds_read_b64_tr_b16 a[230:231], v1 offset:58112
  v_exp_f32 v16, v16
  v_exp_f32 v17, v17
  s_add_u32 s61, s0, s1
  s_add_u32 s62, s61, 63488
  v_mfma_f32_32x32x16_bf16 v[80:95], a[232:235], v[164:167], v[80:95]
  ds_read_b64_tr_b16 a[232:233], v1 offset:59392
  ds_read_b64_tr_b16 a[234:235], v1 offset:59648
  v_exp_f32 v18, v18
  v_exp_f32 v19, v19
  s_add_u32 m0, s64, 0
  s_add_u32 s1, s1, 128
  s_and_b32 s1, s1, 2047
  v_mfma_f32_32x32x16_bf16 v[96:111], v[164:167], a[236:239], v[96:111]
  buffer_load_dwordx4 v3, s[16:19], s61 offen lds
  ds_read_b64_tr_b16 a[236:237], v1 offset:59904
  ds_read_b64_tr_b16 a[238:239], v1 offset:60160
  v_fma_f32 v16, v16, v13, v13
  s_waitcnt lgkmcnt(8)
  v_mfma_f32_32x32x16_bf16 v[80:95], a[240:243], v[168:171], v[80:95]
  ds_read_b64_tr_b16 a[240:241], v1 offset:61440
  ds_read_b64_tr_b16 a[242:243], v1 offset:61696
  v_fma_f32 v17, v17, v13, v13
  v_fma_f32 v18, v18, v13, v13
  v_fma_f32 v19, v19, v13, v13
  v_rcp_f32 v16, v16
  v_rcp_f32 v17, v17
  v_mfma_f32_32x32x16_bf16 v[96:111], v[168:171], a[244:247], v[96:111]
  buffer_load_dwordx4 v4, s[16:19], s61 offen offset:1024 lds
  ds_read_b64_tr_b16 a[244:245], v1 offset:61952
  ds_read_b64_tr_b16 a[246:247], v1 offset:62208
  v_mfma_f32_32x32x16_bf16 v[80:95], a[248:251], v[172:175], v[80:95]
  ds_read_b64_tr_b16 a[248:249], v1 offset:63488
  ds_read_b64_tr_b16 a[250:251], v1 offset:63744
  v_rcp_f32 v18, v18
  v_rcp_f32 v19, v19
  v_mul_f32 v52, v52, v16
  v_mul_f32 v53, v53, v17
  v_mul_f32 v54, v54, v18
  v_mul_f32 v55, v55, v19
  v_mfma_f32_32x32x16_bf16 v[96:111], v[172:175], a[252:255], v[96:111]
  buffer_load_dwordx4 v3, s[16:19], s62 offen offset:2048 lds
  ds_read_b64_tr_b16 a[252:253], v1 offset:64000
  ds_read_b64_tr_b16 a[254:255], v1 offset:64256
  v_add_f32 v14, v14, v52
  s_waitcnt lgkmcnt(8)
  v_mfma_f32_32x32x16_bf16 v[80:95], a[224:227], v[176:179], v[80:95]
  buffer_load_dwordx4 v4, s[16:19], s62 offen offset:3072 lds
  v_fmac_f32 v15, v52, v52
  v_add_f32 v14, v14, v53
  v_fmac_f32 v15, v53, v53
  v_add_f32 v14, v14, v54
  v_mfma_f32_32x32x16_bf16 v[96:111], v[176:179], a[228:231], v[96:111]
  v_fmac_f32 v15, v54, v54
  s_waitcnt vmcnt(12) lgkmcnt(0)
  s_barrier
  ds_read_b64_tr_b16 a[224:225], v1
  ds_read_b64_tr_b16 a[226:227], v1 offset:256
  ds_read_b64_tr_b16 a[228:229], v1 offset:512
  ds_read_b64_tr_b16 a[230:231], v1 offset:768
  v_mfma_f32_32x32x16_bf16 v[80:95], a[232:235], v[180:183], v[80:95]
  ds_read_b64_tr_b16 a[232:233], v1 offset:2048
  ds_read_b64_tr_b16 a[234:235], v1 offset:2304
  v_add_f32 v14, v14, v55
  v_fmac_f32 v15, v55, v55
  v_mul_f32 v16, v56, v56
  v_mul_f32 v17, v57, v57
  v_mul_f32 v18, v58, v58
  v_mul_f32 v19, v59, v59
  s_add_u32 m0, s63, 49152
  v_mfma_f32_32x32x16_bf16 v[96:111], v[180:183], a[236:239], v[96:111]
  buffer_load_dwordx4 v44, s[8:11], 0 offen lds
  ds_read_b64_tr_b16 a[236:237], v1 offset:2560
  ds_read_b64_tr_b16 a[238:239], v1 offset:2816
  v_fma_f32 v16, v16, v11, v12
  v_mfma_f32_32x32x16_bf16 v[80:95], a[240:243], v[184:187], v[80:95]
  buffer_load_dwordx4 v44, s[8:11], s53 offen offset:1024 lds
  ds_read_b64_tr_b16 a[240:241], v1 offset:4096
  ds_read_b64_tr_b16 a[242:243], v1 offset:4352
  v_fma_f32 v17, v17, v11, v12
  v_fma_f32 v18, v18, v11, v12
  v_mfma_f32_32x32x16_bf16 v[96:111], v[184:187], a[244:247], v[96:111]
  ds_read_b64_tr_b16 a[244:245], v1 offset:4608
  ds_read_b64_tr_b16 a[246:247], v1 offset:4864
  v_fma_f32 v19, v19, v11, v12
  v_mul_f32 v16, v16, v56
  v_mul_f32 v17, v17, v57
  v_mul_f32 v18, v18, v58
  v_mul_f32 v19, v19, v59
  v_exp_f32 v16, v16
  v_mfma_f32_32x32x16_bf16 v[80:95], a[248:251], v[188:191], v[80:95]
  buffer_load_dwordx4 v44, s[8:11], s54 offen offset:2048 lds
  ds_read_b64_tr_b16 a[248:249], v1 offset:6144
  ds_read_b64_tr_b16 a[250:251], v1 offset:6400
  v_mfma_f32_32x32x16_bf16 v[96:111], v[188:191], a[252:255], v[96:111]
  ds_read_b64_tr_b16 a[252:253], v1 offset:6656
  ds_read_b64_tr_b16 a[254:255], v1 offset:6912
  v_exp_f32 v17, v17
  v_exp_f32 v18, v18
  v_exp_f32 v19, v19
  v_fma_f32 v16, v16, v13, v13
  s_waitcnt lgkmcnt(8)
  v_mfma_f32_32x32x16_bf16 v[80:95], a[224:227], v[192:195], v[80:95]
  buffer_load_dwordx4 v44, s[8:11], s55 offen offset:3072 lds
  ds_read_b64_tr_b16 a[224:225], v1 offset:8192
  ds_read_b64_tr_b16 a[226:227], v1 offset:8448
  v_fma_f32 v17, v17, v13, v13
  v_fma_f32 v18, v18, v13, v13
  v_mfma_f32_32x32x16_bf16 v[96:111], v[192:195], a[228:231], v[96:111]
  ds_read_b64_tr_b16 a[228:229], v1 offset:8704
  ds_read_b64_tr_b16 a[230:231], v1 offset:8960
  v_fma_f32 v19, v19, v13, v13
  v_rcp_f32 v16, v16
  s_add_u32 s61, s0, s1
  s_add_u32 s62, s61, 63488
  v_mfma_f32_32x32x16_bf16 v[80:95], a[232:235], v[196:199], v[80:95]
  ds_read_b64_tr_b16 a[232:233], v1 offset:10240
  ds_read_b64_tr_b16 a[234:235], v1 offset:10496
  v_rcp_f32 v17, v17
  v_rcp_f32 v18, v18
  s_add_u32 m0, s64, 4096
  s_add_u32 s1, s1, 128
  s_and_b32 s1, s1, 2047
  v_mfma_f32_32x32x16_bf16 v[96:111], v[196:199], a[236:239], v[96:111]
  buffer_load_dwordx4 v3, s[16:19], s61 offen lds
  ds_read_b64_tr_b16 a[236:237], v1 offset:10752
  ds_read_b64_tr_b16 a[238:239], v1 offset:11008
  v_rcp_f32 v19, v19
  s_waitcnt lgkmcnt(8)
  v_mfma_f32_32x32x16_bf16 v[80:95], a[240:243], v[200:203], v[80:95]
  ds_read_b64_tr_b16 a[240:241], v1 offset:12288
  ds_read_b64_tr_b16 a[242:243], v1 offset:12544
  v_mul_f32 v56, v56, v16
  v_mul_f32 v57, v57, v17
  v_mul_f32 v58, v58, v18
  v_mul_f32 v59, v59, v19
  v_add_f32 v14, v14, v56
  v_fmac_f32 v15, v56, v56
  v_mfma_f32_32x32x16_bf16 v[96:111], v[200:203], a[244:247], v[96:111]
  buffer_load_dwordx4 v4, s[16:19], s61 offen offset:1024 lds
  ds_read_b64_tr_b16 a[244:245], v1 offset:12800
  ds_read_b64_tr_b16 a[246:247], v1 offset:13056
  v_add_f32 v14, v14, v57
  v_mfma_f32_32x32x16_bf16 v[80:95], a[248:251], v[204:207], v[80:95]
  ds_read_b64_tr_b16 a[248:249], v1 offset:14336
  ds_read_b64_tr_b16 a[250:251], v1 offset:14592
  v_fmac_f32 v15, v57, v57
  v_add_f32 v14, v14, v58
  v_fmac_f32 v15, v58, v58
  v_add_f32 v14, v14, v59
  v_fmac_f32 v15, v59, v59
  v_mul_f32 v16, v60, v60
  v_mul_f32 v17, v61, v61
  v_mfma_f32_32x32x16_bf16 v[96:111], v[204:207], a[252:255], v[96:111]
  buffer_load_dwordx4 v3, s[16:19], s62 offen offset:2048 lds
  ds_read_b64_tr_b16 a[252:253], v1 offset:14848
  ds_read_b64_tr_b16 a[254:255], v1 offset:15104
  v_mul_f32 v18, v62, v62
  s_waitcnt lgkmcnt(8)
  v_mfma_f32_32x32x16_bf16 v[80:95], a[224:227], v[208:211], v[80:95]
  buffer_load_dwordx4 v4, s[16:19], s62 offen offset:3072 lds
  v_mul_f32 v19, v63, v63
  v_fma_f32 v16, v16, v11, v12
  v_fma_f32 v17, v17, v11, v12
  v_fma_f32 v18, v18, v11, v12
  v_mfma_f32_32x32x16_bf16 v[96:111], v[208:211], a[228:231], v[96:111]
  v_fma_f32 v19, v19, v11, v12
  v_mul_f32 v16, v16, v60
  s_waitcnt vmcnt(16) lgkmcnt(0)
  s_barrier
  ds_read_b64_tr_b16 a[224:225], v1 offset:16384
  ds_read_b64_tr_b16 a[226:227], v1 offset:16640
  ds_read_b64_tr_b16 a[228:229], v1 offset:16896
  ds_read_b64_tr_b16 a[230:231], v1 offset:17152
  v_mfma_f32_32x32x16_bf16 v[80:95], a[232:235], v[212:215], v[80:95]
  ds_read_b64_tr_b16 a[232:233], v1 offset:18432
  ds_read_b64_tr_b16 a[234:235], v1 offset:18688
  v_mul_f32 v17, v17, v61
  v_mul_f32 v18, v18, v62
  v_mul_f32 v19, v19, v63
  v_exp_f32 v16, v16
  s_add_u32 m0, s63, 0
  v_add_u32 v2, s80, v47
  v_mfma_f32_32x32x16_bf16 v[96:111], v[212:215], a[236:239], v[96:111]
  buffer_load_dwordx4 v2, s[12:15], 0 offen lds
  ds_read_b64_tr_b16 a[236:237], v1 offset:18944
  ds_read_b64_tr_b16 a[238:239], v1 offset:19200
  v_mfma_f32_32x32x16_bf16 v[80:95], a[240:243], v[216:219], v[80:95]
  ds_read_b64_tr_b16 a[240:241], v1 offset:20480
  ds_read_b64_tr_b16 a[242:243], v1 offset:20736
  v_exp_f32 v17, v17
  v_exp_f32 v18, v18
  v_exp_f32 v19, v19
  v_fma_f32 v16, v16, v13, v13
  v_mfma_f32_32x32x16_bf16 v[96:111], v[216:219], a[244:247], v[96:111]
  buffer_load_dwordx4 v2, s[12:15], s49 offen offset:1024 lds
  ds_read_b64_tr_b16 a[244:245], v1 offset:20992
  ds_read_b64_tr_b16 a[246:247], v1 offset:21248
  v_fma_f32 v17, v17, v13, v13
  v_mfma_f32_32x32x16_bf16 v[80:95], a[248:251], v[220:223], v[80:95]
  buffer_load_dwordx4 v2, s[12:15], s50 offen offset:2048 lds
  ds_read_b64_tr_b16 a[248:249], v1 offset:22528
  ds_read_b64_tr_b16 a[250:251], v1 offset:22784
  v_fma_f32 v18, v18, v13, v13
  v_fma_f32 v19, v19, v13, v13
  v_mfma_f32_32x32x16_bf16 v[96:111], v[220:223], a[252:255], v[96:111]
  ds_read_b64_tr_b16 a[252:253], v1 offset:23040
  ds_read_b64_tr_b16 a[254:255], v1 offset:23296
  v_rcp_f32 v16, v16
  v_rcp_f32 v17, v17
  v_rcp_f32 v18, v18
  s_waitcnt lgkmcnt(8)
  v_mfma_f32_32x32x16_bf16 v[80:95], a[224:227], v[224:227], v[80:95]
  buffer_load_dwordx4 v2, s[12:15], s51 offen offset:3072 lds
  ds_read_b64_tr_b16 a[224:225], v1 offset:24576
  ds_read_b64_tr_b16 a[226:227], v1 offset:24832
  v_rcp_f32 v19, v19
  v_mfma_f32_32x32x16_bf16 v[96:111], v[224:227], a[228:231], v[96:111]
  ds_read_b64_tr_b16 a[228:229], v1 offset:25088
  ds_read_b64_tr_b16 a[230:231], v1 offset:25344
  v_mul_f32 v60, v60, v16
  v_mul_f32 v61, v61, v17
  v_mul_f32 v62, v62, v18
  v_mul_f32 v63, v63, v19
  s_add_u32 s61, s0, s1
  s_add_u32 s62, s61, 63488
  v_mfma_f32_32x32x16_bf16 v[80:95], a[232:235], v[228:231], v[80:95]
  ds_read_b64_tr_b16 a[232:233], v1 offset:26624
  ds_read_b64_tr_b16 a[234:235], v1 offset:26880
  v_add_f32 v14, v14, v60
  v_fmac_f32 v15, v60, v60
  v_add_f32 v14, v14, v61
  v_fmac_f32 v15, v61, v61
  s_add_u32 m0, s64, 8192
  s_add_u32 s1, s1, 128
  s_and_b32 s1, s1, 2047
  v_mfma_f32_32x32x16_bf16 v[96:111], v[228:231], a[236:239], v[96:111]
  buffer_load_dwordx4 v3, s[16:19], s61 offen lds
  ds_read_b64_tr_b16 a[236:237], v1 offset:27136
  ds_read_b64_tr_b16 a[238:239], v1 offset:27392
  v_add_f32 v14, v14, v62
  s_waitcnt lgkmcnt(8)
  v_mfma_f32_32x32x16_bf16 v[80:95], a[240:243], v[232:235], v[80:95]
  ds_read_b64_tr_b16 a[240:241], v1 offset:28672
  ds_read_b64_tr_b16 a[242:243], v1 offset:28928
  v_fmac_f32 v15, v62, v62
  v_add_f32 v14, v14, v63
  v_fmac_f32 v15, v63, v63
  v_mul_f32 v16, v64, v64
  v_mul_f32 v17, v65, v65
  v_mul_f32 v18, v66, v66
  v_mul_f32 v19, v67, v67
  v_mfma_f32_32x32x16_bf16 v[96:111], v[232:235], a[244:247], v[96:111]
  buffer_load_dwordx4 v4, s[16:19], s61 offen offset:1024 lds
  ds_read_b64_tr_b16 a[244:245], v1 offset:29184
  ds_read_b64_tr_b16 a[246:247], v1 offset:29440
  v_mfma_f32_32x32x16_bf16 v[80:95], a[248:251], v[236:239], v[80:95]
  ds_read_b64_tr_b16 a[248:249], v1 offset:30720
  ds_read_b64_tr_b16 a[250:251], v1 offset:30976
  v_fma_f32 v16, v16, v11, v12
  v_fma_f32 v17, v17, v11, v12
  v_fma_f32 v18, v18, v11, v12
  v_fma_f32 v19, v19, v11, v12
  v_mul_f32 v16, v16, v64
  v_mul_f32 v17, v17, v65
  v_mul_f32 v18, v18, v66
  v_mfma_f32_32x32x16_bf16 v[96:111], v[236:239], a[252:255], v[96:111]
  buffer_load_dwordx4 v3, s[16:19], s62 offen offset:2048 lds
  ds_read_b64_tr_b16 a[252:253], v1 offset:31232
  ds_read_b64_tr_b16 a[254:255], v1 offset:31488
  v_mul_f32 v19, v19, v67
  s_waitcnt lgkmcnt(8)
  v_mfma_f32_32x32x16_bf16 v[80:95], a[224:227], v[240:243], v[80:95]
  buffer_load_dwordx4 v4, s[16:19], s62 offen offset:3072 lds
  v_exp_f32 v16, v16
  v_exp_f32 v17, v17
  v_mfma_f32_32x32x16_bf16 v[96:111], v[240:243], a[228:231], v[96:111]
  v_exp_f32 v18, v18
  s_waitcnt vmcnt(12) lgkmcnt(0)
  s_barrier
  ds_read_b64_tr_b16 a[224:225], v1 offset:32768
  ds_read_b64_tr_b16 a[226:227], v1 offset:33024
  ds_read_b64_tr_b16 a[228:229], v1 offset:33280
  ds_read_b64_tr_b16 a[230:231], v1 offset:33536
  v_mfma_f32_32x32x16_bf16 v[80:95], a[232:235], v[244:247], v[80:95]
  ds_read_b128 a[0:3], v5
  ds_read_b128 a[4:7], v6
  ds_read_b128 a[8:11], v7
  ds_read_b64_tr_b16 a[232:233], v1 offset:34816
  ds_read_b64_tr_b16 a[234:235], v1 offset:35072
  v_exp_f32 v19, v19
  v_fma_f32 v16, v16, v13, v13
  v_mfma_f32_32x32x16_bf16 v[96:111], v[244:247], a[236:239], v[96:111]
  ds_read_b128 a[12:15], v8
  ds_read_b64_tr_b16 a[236:237], v1 offset:35328
  ds_read_b64_tr_b16 a[238:239], v1 offset:35584
  v_fma_f32 v17, v17, v13, v13
  v_fma_f32 v18, v18, v13, v13
  v_fma_f32 v19, v19, v13, v13
  s_add_u32 m0, s63, 16384
  v_add_u32 v2, s81, v47
  v_mfma_f32_32x32x16_bf16 v[80:95], a[240:243], v[248:251], v[80:95]
  buffer_load_dwordx4 v2, s[12:15], 0 offen lds
  ds_read_b64_tr_b16 a[240:241], v1 offset:36864
  ds_read_b64_tr_b16 a[242:243], v1 offset:37120
  v_rcp_f32 v16, v16
  v_mfma_f32_32x32x16_bf16 v[96:111], v[248:251], a[244:247], v[96:111]
  ds_read_b64_tr_b16 a[244:245], v1 offset:37376
  ds_read_b64_tr_b16 a[246:247], v1 offset:37632
  v_rcp_f32 v17, v17
  v_rcp_f32 v18, v18
  v_rcp_f32 v19, v19
  v_mfma_f32_32x32x16_bf16 v[80:95], a[248:251], v[252:255], v[80:95]
  buffer_load_dwordx4 v2, s[12:15], s49 offen offset:1024 lds
  ds_read_b64_tr_b16 a[248:249], v1 offset:38912
  ds_read_b64_tr_b16 a[250:251], v1 offset:39168
  v_mul_f32 v64, v64, v16
  v_mfma_f32_32x32x16_bf16 v[96:111], v[252:255], a[252:255], v[96:111]
  buffer_load_dwordx4 v2, s[12:15], s50 offen offset:2048 lds
  ds_read_b64_tr_b16 a[252:253], v1 offset:39424
  ds_read_b64_tr_b16 a[254:255], v1 offset:39680
  v_mul_f32 v65, v65, v17
  s_waitcnt lgkmcnt(8)
  v_mfma_f32_32x32x16_bf16 v[112:127], a[224:227], v[128:131], 0
  buffer_load_dwordx4 v2, s[12:15], s51 offen offset:3072 lds
  ds_read_b64_tr_b16 a[224:225], v1 offset:40960
  ds_read_b64_tr_b16 a[226:227], v1 offset:41216
  v_mul_f32 v66, v66, v18
  v_mul_f32 v67, v67, v19
  v_mfma_f32_32x32x16_bf16 v[112:127], a[228:231], v[192:195], v[112:127]
  ds_read_b64_tr_b16 a[228:229], v1 offset:41472
  ds_read_b64_tr_b16 a[230:231], v1 offset:41728
  v_add_f32 v14, v14, v64
  v_fmac_f32 v15, v64, v64
  v_add_f32 v14, v14, v65
  v_fmac_f32 v15, v65, v65
  v_add_f32 v14, v14, v66
  v_mfma_f32_32x32x16_bf16 v[112:127], a[232:235], v[132:135], v[112:127]
  ds_read_b64_tr_b16 a[232:233], v1 offset:43008
  ds_read_b64_tr_b16 a[234:235], v1 offset:43264
  v_fmac_f32 v15, v66, v66
  v_add_f32 v14, v14, v67
  v_fmac_f32 v15, v67, v67
  s_add_u32 s61, s0, s1
  s_add_u32 s62, s61, 63488
  s_add_u32 m0, s64, 0
  s_add_u32 s1, s1, 128
  v_mfma_f32_32x32x16_bf16 v[112:127], a[236:239], v[196:199], v[112:127]
  v_lshrrev_b32 v20, 9, v0
  v_lshlrev_b32 v20, 4, v20
  s_lshl_b32 s77, s43, 7
  v_add_u32 v20, s77, v20
  s_and_b32 s1, s1, 2047
  s_waitcnt lgkmcnt(6)
  v_mfma_f32_32x32x16_bf16 v[112:127], a[240:243], v[136:139], v[112:127]
  buffer_load_dwordx4 v3, s[16:19], s61 offen lds
  ds_read_b128 v[24:27], v20
  ds_read_b128 v[28:31], v20 offset:32
  ds_read_b128 v[32:35], v20 offset:64
  ds_read_b128 v[36:39], v20 offset:96
  ds_read_b64_tr_b16 a[236:237], v1 offset:43520
  ds_read_b64_tr_b16 a[238:239], v1 offset:43776
  ds_read_b64_tr_b16 a[240:241], v1 offset:45056
  ds_read_b64_tr_b16 a[242:243], v1 offset:45312
  s_lshl_b32 s77, s43, 12
  s_add_u32 s77, s77, 32768
  v_add_u32 v21, s77, v0
  v_mul_f32 v80, v80, v10
  v_mul_f32 v81, v81, v10
  v_mfma_f32_32x32x16_bf16 v[112:127], a[244:247], v[200:203], v[112:127]
  buffer_load_dwordx4 v4, s[16:19], s61 offen offset:1024 lds
  ds_read_b64_tr_b16 a[244:245], v1 offset:45568
  ds_read_b64_tr_b16 a[246:247], v1 offset:45824
  v_mul_f32 v82, v82, v10
  v_mul_f32 v83, v83, v10
  v_mul_f32 v84, v84, v10
  v_mul_f32 v85, v85, v10
  v_mul_f32 v86, v86, v10
  v_mfma_f32_32x32x16_bf16 v[112:127], a[248:251], v[140:143], v[112:127]
  buffer_load_dwordx4 v3, s[16:19], s62 offen offset:2048 lds
  ds_read_b64_tr_b16 a[248:249], v1 offset:47104
  ds_read_b64_tr_b16 a[250:251], v1 offset:47360
  v_mul_f32 v87, v87, v10
  v_mul_f32 v88, v88, v10
  v_mul_f32 v89, v89, v10
  v_mul_f32 v90, v90, v10
  v_mul_f32 v91, v91, v10
  v_mfma_f32_32x32x16_bf16 v[112:127], a[252:255], v[204:207], v[112:127]
  ds_read_b64_tr_b16 a[252:253], v1 offset:47616
  ds_read_b64_tr_b16 a[254:255], v1 offset:47872
  v_mul_f32 v92, v92, v10
  v_mul_f32 v93, v93, v10
  v_mul_f32 v94, v94, v10
  v_mul_f32 v95, v95, v10
  v_cvt_pk_bf16_f32 v80, v80, v81
  v_cvt_pk_bf16_f32 v81, v82, v83
  v_cvt_pk_bf16_f32 v82, v84, v85
  v_cvt_pk_bf16_f32 v83, v86, v87
  v_cvt_pk_bf16_f32 v84, v88, v89
  s_waitcnt lgkmcnt(8)
  v_mfma_f32_32x32x16_bf16 v[112:127], a[224:227], v[144:147], v[112:127]
  buffer_load_dwordx4 v4, s[16:19], s62 offen offset:3072 lds
  ds_read_b64_tr_b16 a[224:225], v1 offset:49152
  ds_read_b64_tr_b16 a[226:227], v1 offset:49408
  v_cvt_pk_bf16_f32 v85, v90, v91
  v_cvt_pk_bf16_f32 v86, v92, v93
  v_cvt_pk_bf16_f32 v87, v94, v95
  s_lshl_b32 s78, s41, 6
  s_add_u32 s78, s78, s46
  s_lshl_b32 s78, s78, 12
  s_add_u32 s60, s78, 2097152
  v_mfma_f32_32x32x16_bf16 v[112:127], a[228:231], v[208:211], v[112:127]
  buffer_store_dwordx4 v[80:83], v0, s[36:39], s60 offen sc1
  ds_read_b64_tr_b16 a[228:229], v1 offset:49664
  ds_read_b64_tr_b16 a[230:231], v1 offset:49920
  v_mfma_f32_32x32x16_bf16 v[112:127], a[232:235], v[148:151], v[112:127]
  ds_write_b128 v21, v[80:83]
  s_waitcnt vmcnt(17)
  ds_read_b128 a[16:19], v5 offset:4096
  ds_read_b64_tr_b16 a[232:233], v1 offset:51200
  ds_read_b64_tr_b16 a[234:235], v1 offset:51456
  v_mul_f32 v96, v96, v24
  v_mul_f32 v97, v97, v25
  v_mul_f32 v98, v98, v26
  v_mul_f32 v99, v99, v27
  v_mul_f32 v100, v100, v28
  v_mul_f32 v101, v101, v29
  v_mfma_f32_32x32x16_bf16 v[112:127], a[236:239], v[212:215], v[112:127]
  ds_read_b128 a[20:23], v6 offset:4096
  ds_read_b128 a[24:27], v7 offset:4096
  ds_read_b64_tr_b16 a[236:237], v1 offset:51712
  ds_read_b64_tr_b16 a[238:239], v1 offset:51968
  v_mul_f32 v102, v102, v30
  v_mul_f32 v103, v103, v31
  v_mul_f32 v104, v104, v32
  v_mul_f32 v105, v105, v33
  v_mul_f32 v106, v106, v34
  s_waitcnt lgkmcnt(12)
  v_mfma_f32_32x32x16_bf16 v[112:127], a[240:243], v[152:155], v[112:127]
  buffer_store_dwordx4 v[84:87], v0, s[36:39], s60 offen offset:1024 sc1
  ds_read_b128 a[28:31], v8 offset:4096
  ds_read_b64_tr_b16 a[240:241], v1 offset:53248
  ds_read_b64_tr_b16 a[242:243], v1 offset:53504
  v_mul_f32 v107, v107, v35
  v_mul_f32 v108, v108, v36
  s_waitcnt lgkmcnt(2)
  v_mfma_f32_32x32x16_bf16 v[112:127], a[244:247], v[216:219], v[112:127]
  ds_read_b64_tr_b16 a[244:245], v1 offset:53760
  ds_read_b64_tr_b16 a[246:247], v1 offset:54016
  v_mul_f32 v109, v109, v37
  v_mul_f32 v110, v110, v38
  v_mul_f32 v111, v111, v39
  v_cvt_pk_bf16_f32 v96, v96, v97
  v_cvt_pk_bf16_f32 v97, v98, v99
  s_add_u32 s61, s0, s1
  s_add_u32 s62, s61, 63488
  v_mfma_f32_32x32x16_bf16 v[112:127], a[248:251], v[156:159], v[112:127]
  ds_write_b128 v21, v[84:87] offset:1024
  ds_read_b64_tr_b16 a[248:249], v1 offset:55296
  ds_read_b64_tr_b16 a[250:251], v1 offset:55552
  v_cvt_pk_bf16_f32 v98, v100, v101
  v_cvt_pk_bf16_f32 v99, v102, v103
  v_cvt_pk_bf16_f32 v100, v104, v105
  v_cvt_pk_bf16_f32 v101, v106, v107
  v_cvt_pk_bf16_f32 v102, v108, v109
  s_add_u32 m0, s64, 4096
  s_add_u32 s1, s1, 128
  v_mfma_f32_32x32x16_bf16 v[112:127], a[252:255], v[220:223], v[112:127]
  buffer_store_dwordx4 v[96:99], v0, s[36:39], s60 offen offset:2048 sc1
  ds_read_b64_tr_b16 a[252:253], v1 offset:55808
  ds_read_b64_tr_b16 a[254:255], v1 offset:56064
  v_cvt_pk_bf16_f32 v103, v110, v111
  s_and_b32 s1, s1, 2047
  v_mfma_f32_32x32x16_bf16 v[112:127], a[224:227], v[160:163], v[112:127]
  buffer_load_dwordx4 v3, s[16:19], s61 offen lds
  ds_write_b128 v21, v[96:99] offset:2048
  ds_read_b64_tr_b16 a[224:225], v1 offset:57344
  ds_read_b64_tr_b16 a[226:227], v1 offset:57600
  v_mfma_f32_32x32x16_bf16 v[112:127], a[228:231], v[224:227], v[112:127]
  buffer_store_dwordx4 v[100:103], v0, s[36:39], s60 offen offset:3072 sc1
  ds_write_b128 v21, v[100:103] offset:3072
  ds_read_b64_tr_b16 a[228:229], v1 offset:57856
  ds_read_b64_tr_b16 a[230:231], v1 offset:58112
  v_mfma_f32_32x32x16_bf16 v[112:127], a[232:235], v[164:167], v[112:127]
  ds_read_b64_tr_b16 a[232:233], v1 offset:59392
  ds_read_b64_tr_b16 a[234:235], v1 offset:59648
  v_mul_f32 v16, v68, v68
  v_mul_f32 v17, v69, v69
  v_mul_f32 v18, v70, v70
  v_mul_f32 v19, v71, v71
  v_fma_f32 v16, v16, v11, v12
  v_fma_f32 v17, v17, v11, v12
  v_fma_f32 v18, v18, v11, v12
  v_fma_f32 v19, v19, v11, v12
  v_mfma_f32_32x32x16_bf16 v[112:127], a[236:239], v[228:231], v[112:127]
  buffer_load_dwordx4 v4, s[16:19], s61 offen offset:1024 lds
  ds_read_b64_tr_b16 a[236:237], v1 offset:59904
  ds_read_b64_tr_b16 a[238:239], v1 offset:60160
  v_mul_f32 v16, v16, v68
  v_mul_f32 v17, v17, v69
  s_waitcnt lgkmcnt(10)
  v_mfma_f32_32x32x16_bf16 v[112:127], a[240:243], v[168:171], v[112:127]
  ds_read_b64_tr_b16 a[240:241], v1 offset:61440
  ds_read_b64_tr_b16 a[242:243], v1 offset:61696
  v_mul_f32 v18, v18, v70
  v_mul_f32 v19, v19, v71
  v_exp_f32 v16, v16
  v_exp_f32 v17, v17
  v_exp_f32 v18, v18
  v_mfma_f32_32x32x16_bf16 v[112:127], a[244:247], v[232:235], v[112:127]
  ds_read_b64_tr_b16 a[244:245], v1 offset:61952
  ds_read_b64_tr_b16 a[246:247], v1 offset:62208
  v_exp_f32 v19, v19
  v_fma_f32 v16, v16, v13, v13
  v_fma_f32 v17, v17, v13, v13
  v_fma_f32 v18, v18, v13, v13
  v_fma_f32 v19, v19, v13, v13
  v_mfma_f32_32x32x16_bf16 v[112:127], a[248:251], v[172:175], v[112:127]
  buffer_load_dwordx4 v3, s[16:19], s62 offen offset:2048 lds
  ds_read_b64_tr_b16 a[248:249], v1 offset:63488
  ds_read_b64_tr_b16 a[250:251], v1 offset:63744
  v_rcp_f32 v16, v16
  v_rcp_f32 v17, v17
  v_mfma_f32_32x32x16_bf16 v[112:127], a[252:255], v[236:239], v[112:127]
  ds_read_b64_tr_b16 a[252:253], v1 offset:64000
  ds_read_b64_tr_b16 a[254:255], v1 offset:64256
  v_rcp_f32 v18, v18
  v_rcp_f32 v19, v19
  v_mul_f32 v68, v68, v16
  v_mul_f32 v69, v69, v17
  v_mul_f32 v70, v70, v18
  s_waitcnt lgkmcnt(8)
  v_mfma_f32_32x32x16_bf16 v[112:127], a[224:227], v[176:179], v[112:127]
  buffer_load_dwordx4 v4, s[16:19], s62 offen offset:3072 lds
  v_mul_f32 v71, v71, v19
  v_add_f32 v14, v14, v68
  v_fmac_f32 v15, v68, v68
  v_add_f32 v14, v14, v69
  v_fmac_f32 v15, v69, v69
  v_mfma_f32_32x32x16_bf16 v[112:127], a[228:231], v[240:243], v[112:127]
  v_add_f32 v14, v14, v70
  v_fmac_f32 v15, v70, v70
  v_add_f32 v14, v14, v71
  s_waitcnt vmcnt(12) lgkmcnt(0)
  s_barrier
  ds_read_b64_tr_b16 a[224:225], v1
  ds_read_b64_tr_b16 a[226:227], v1 offset:256
  ds_read_b64_tr_b16 a[228:229], v1 offset:512
  ds_read_b64_tr_b16 a[230:231], v1 offset:768
  v_mfma_f32_32x32x16_bf16 v[112:127], a[232:235], v[180:183], v[112:127]
  ds_read_b128 a[32:35], v5 offset:8192
  ds_read_b128 a[36:39], v6 offset:8192
  ds_read_b128 a[40:43], v7 offset:8192
  ds_read_b128 a[44:47], v8 offset:8192
  ds_read_b64_tr_b16 a[232:233], v1 offset:2048
  ds_read_b64_tr_b16 a[234:235], v1 offset:2304
  v_fmac_f32 v15, v71, v71
  v_mul_f32 v16, v72, v72
  v_mul_f32 v17, v73, v73
  v_mfma_f32_32x32x16_bf16 v[112:127], a[236:239], v[244:247], v[112:127]
  ds_read_b64_tr_b16 a[236:237], v1 offset:2560
  ds_read_b64_tr_b16 a[238:239], v1 offset:2816
  s_add_u32 m0, s63, 32768
  v_add_u32 v2, s82, v47
  v_mfma_f32_32x32x16_bf16 v[112:127], a[240:243], v[184:187], v[112:127]
  buffer_load_dwordx4 v2, s[12:15], 0 offen lds
  buffer_load_dwordx4 v2, s[12:15], s49 offen offset:1024 lds
  ds_read_b64_tr_b16 a[240:241], v1 offset:4096
  ds_read_b64_tr_b16 a[242:243], v1 offset:4352
  v_mul_f32 v18, v74, v74
  v_mul_f32 v19, v75, v75
  v_mfma_f32_32x32x16_bf16 v[112:127], a[244:247], v[248:251], v[112:127]
  buffer_load_dwordx4 v2, s[12:15], s50 offen offset:2048 lds
  ds_read_b64_tr_b16 a[244:245], v1 offset:4608
  ds_read_b64_tr_b16 a[246:247], v1 offset:4864
  v_fma_f32 v16, v16, v11, v12
  v_fma_f32 v17, v17, v11, v12
  v_mfma_f32_32x32x16_bf16 v[112:127], a[248:251], v[188:191], v[112:127]
  buffer_load_dwordx4 v2, s[12:15], s51 offen offset:3072 lds
  ds_read_b64_tr_b16 a[248:249], v1 offset:6144
  ds_read_b64_tr_b16 a[250:251], v1 offset:6400
  v_fma_f32 v18, v18, v11, v12
  v_fma_f32 v19, v19, v11, v12
  v_mul_f32 v16, v16, v72
  v_mfma_f32_32x32x16_bf16 v[112:127], a[252:255], v[252:255], v[112:127]
  ds_read_b64_tr_b16 a[252:253], v1 offset:6656
  ds_read_b64_tr_b16 a[254:255], v1 offset:6912
  v_mul_f32 v17, v17, v73
  v_mul_f32 v18, v18, v74
  v_mul_f32 v19, v19, v75
  v_exp_f32 v16, v16
  s_add_u32 m0, s63, 49152
  v_add_u32 v2, s83, v47
  s_waitcnt lgkmcnt(8)
  v_mfma_f32_32x32x16_bf16 v[80:95], a[224:227], v[128:131], 0
  buffer_load_dwordx4 v2, s[12:15], 0 offen lds
  ds_read_b64_tr_b16 a[224:225], v1 offset:8192
  ds_read_b64_tr_b16 a[226:227], v1 offset:8448
  v_exp_f32 v17, v17
  v_exp_f32 v18, v18
  v_mfma_f32_32x32x16_bf16 v[96:111], a[228:231], v[128:131], 0
  buffer_load_dwordx4 v2, s[12:15], s49 offen offset:1024 lds
  ds_read_b64_tr_b16 a[228:229], v1 offset:8704
  ds_read_b64_tr_b16 a[230:231], v1 offset:8960
  v_exp_f32 v19, v19
  v_mfma_f32_32x32x16_bf16 v[80:95], a[232:235], v[132:135], v[80:95]
  buffer_load_dwordx4 v2, s[12:15], s50 offen offset:2048 lds
  ds_read_b64_tr_b16 a[232:233], v1 offset:10240
  ds_read_b64_tr_b16 a[234:235], v1 offset:10496
  v_fma_f32 v16, v16, v13, v13
  v_fma_f32 v17, v17, v13, v13
  v_mfma_f32_32x32x16_bf16 v[96:111], a[236:239], v[132:135], v[96:111]
  buffer_load_dwordx4 v2, s[12:15], s51 offen offset:3072 lds
  ds_read_b64_tr_b16 a[236:237], v1 offset:10752
  ds_read_b64_tr_b16 a[238:239], v1 offset:11008
  v_fma_f32 v18, v18, v13, v13
  s_waitcnt lgkmcnt(8)
  v_mfma_f32_32x32x16_bf16 v[80:95], a[240:243], v[136:139], v[80:95]
  ds_read_b64_tr_b16 a[240:241], v1 offset:12288
  ds_read_b64_tr_b16 a[242:243], v1 offset:12544
  v_fma_f32 v19, v19, v13, v13
  v_rcp_f32 v16, v16
  s_add_u32 s61, s0, s1
  s_add_u32 s62, s61, 63488
  s_add_u32 m0, s64, 8192
  s_add_u32 s1, s1, 128
  s_and_b32 s1, s1, 2047
  v_mfma_f32_32x32x16_bf16 v[96:111], a[244:247], v[136:139], v[96:111]
  buffer_load_dwordx4 v3, s[16:19], s61 offen lds
  ds_read_b64_tr_b16 a[244:245], v1 offset:12800
  ds_read_b64_tr_b16 a[246:247], v1 offset:13056
  v_rcp_f32 v17, v17
  v_mfma_f32_32x32x16_bf16 v[80:95], a[248:251], v[140:143], v[80:95]
  buffer_load_dwordx4 v4, s[16:19], s61 offen offset:1024 lds
  ds_read_b64_tr_b16 a[248:249], v1 offset:14336
  ds_read_b64_tr_b16 a[250:251], v1 offset:14592
  v_rcp_f32 v18, v18
  v_mfma_f32_32x32x16_bf16 v[96:111], a[252:255], v[140:143], v[96:111]
  buffer_load_dwordx4 v3, s[16:19], s62 offen offset:2048 lds
  ds_read_b64_tr_b16 a[252:253], v1 offset:14848
  ds_read_b64_tr_b16 a[254:255], v1 offset:15104
  v_rcp_f32 v19, v19
  v_mul_f32 v72, v72, v16
  s_waitcnt lgkmcnt(8)
  v_mfma_f32_32x32x16_bf16 v[80:95], a[224:227], v[144:147], v[80:95]
  buffer_load_dwordx4 v4, s[16:19], s62 offen offset:3072 lds
  ds_read_b64_tr_b16 a[224:225], v1 offset:16384
  ds_read_b64_tr_b16 a[226:227], v1 offset:16640
  v_mul_f32 v73, v73, v17
  v_mul_f32 v74, v74, v18
  v_mul_f32 v75, v75, v19
  v_mfma_f32_32x32x16_bf16 v[96:111], a[228:231], v[144:147], v[96:111]
  ds_read_b64_tr_b16 a[228:229], v1 offset:16896
  ds_read_b64_tr_b16 a[230:231], v1 offset:17152
  v_add_f32 v14, v14, v72
  v_fmac_f32 v15, v72, v72
  v_add_f32 v14, v14, v73
  v_fmac_f32 v15, v73, v73
  v_add_f32 v14, v14, v74
  v_fmac_f32 v15, v74, v74
  v_add_f32 v14, v14, v75
  v_mfma_f32_32x32x16_bf16 v[80:95], a[232:235], v[148:151], v[80:95]
  s_waitcnt vmcnt(20)
  ds_read_b128 a[48:51], v5
  ds_read_b64_tr_b16 a[232:233], v1 offset:18432
  ds_read_b64_tr_b16 a[234:235], v1 offset:18688
  v_fmac_f32 v15, v75, v75
  v_mul_f32 v16, v76, v76
  v_mul_f32 v17, v77, v77
  v_mul_f32 v18, v78, v78
  v_mul_f32 v19, v79, v79
  v_fma_f32 v16, v16, v11, v12
  v_mfma_f32_32x32x16_bf16 v[96:111], a[236:239], v[148:151], v[96:111]
  ds_read_b128 a[52:55], v6
  ds_read_b128 a[56:59], v7
  ds_read_b64_tr_b16 a[236:237], v1 offset:18944
  ds_read_b64_tr_b16 a[238:239], v1 offset:19200
  v_fma_f32 v17, v17, v11, v12
  v_fma_f32 v18, v18, v11, v12
  v_fma_f32 v19, v19, v11, v12
  v_mul_f32 v16, v16, v76
  v_mul_f32 v17, v17, v77
  s_waitcnt lgkmcnt(11)
  v_mfma_f32_32x32x16_bf16 v[80:95], a[240:243], v[152:155], v[80:95]
  ds_read_b128 a[60:63], v8
  ds_read_b64_tr_b16 a[240:241], v1 offset:20480
  ds_read_b64_tr_b16 a[242:243], v1 offset:20736
  v_mul_f32 v18, v18, v78
  v_mul_f32 v19, v19, v79
  v_exp_f32 v16, v16
  v_exp_f32 v17, v17
  s_waitcnt lgkmcnt(2)
  v_mfma_f32_32x32x16_bf16 v[96:111], a[244:247], v[152:155], v[96:111]
  ds_read_b64_tr_b16 a[244:245], v1 offset:20992
  ds_read_b64_tr_b16 a[246:247], v1 offset:21248
  v_exp_f32 v18, v18
  v_exp_f32 v19, v19
  s_add_u32 s61, s0, s1
  s_add_u32 s62, s61, 63488
  v_mfma_f32_32x32x16_bf16 v[80:95], a[248:251], v[156:159], v[80:95]
  ds_read_b64_tr_b16 a[248:249], v1 offset:22528
  ds_read_b64_tr_b16 a[250:251], v1 offset:22784
  v_fma_f32 v16, v16, v13, v13
  v_fma_f32 v17, v17, v13, v13
  v_fma_f32 v18, v18, v13, v13
  v_fma_f32 v19, v19, v13, v13
  v_rcp_f32 v16, v16
  s_add_u32 m0, s64, 0
  s_add_u32 s1, s1, 128
  v_mfma_f32_32x32x16_bf16 v[96:111], a[252:255], v[156:159], v[96:111]
  ds_read_b64_tr_b16 a[252:253], v1 offset:23040
  ds_read_b64_tr_b16 a[254:255], v1 offset:23296
  v_rcp_f32 v17, v17
  v_rcp_f32 v18, v18
  v_rcp_f32 v19, v19
  s_and_b32 s1, s1, 2047
  v_mfma_f32_32x32x16_bf16 v[80:95], a[224:227], v[160:163], v[80:95]
  buffer_load_dwordx4 v3, s[16:19], s61 offen lds
  ds_read_b64_tr_b16 a[224:225], v1 offset:24576
  ds_read_b64_tr_b16 a[226:227], v1 offset:24832
  v_mul_f32 v76, v76, v16
  v_mul_f32 v77, v77, v17
  v_mul_f32 v78, v78, v18
  v_mfma_f32_32x32x16_bf16 v[96:111], a[228:231], v[160:163], v[96:111]
  ds_read_b64_tr_b16 a[228:229], v1 offset:25088
  ds_read_b64_tr_b16 a[230:231], v1 offset:25344
  v_mul_f32 v79, v79, v19
  v_add_f32 v14, v14, v76
  v_fmac_f32 v15, v76, v76
  v_add_f32 v14, v14, v77
  v_fmac_f32 v15, v77, v77
  v_add_f32 v14, v14, v78
  v_fmac_f32 v15, v78, v78
  v_mfma_f32_32x32x16_bf16 v[80:95], a[232:235], v[164:167], v[80:95]
  ds_read_b64_tr_b16 a[232:233], v1 offset:26624
  ds_read_b64_tr_b16 a[234:235], v1 offset:26880
  v_add_f32 v14, v14, v79
  v_fmac_f32 v15, v79, v79
  v_mov_b32 v16, v14
  s_nop 1
  v_permlane32_swap_b32 v14, v16
  v_add_f32 v14, v14, v16
  v_mov_b32 v17, v15
  s_nop 1
  v_permlane32_swap_b32 v15, v17
  v_add_f32 v15, v15, v17
  v_mfma_f32_32x32x16_bf16 v[96:111], a[236:239], v[164:167], v[96:111]
  buffer_load_dwordx4 v4, s[16:19], s61 offen offset:1024 lds
  ds_read_b64_tr_b16 a[236:237], v1 offset:27136
  ds_read_b64_tr_b16 a[238:239], v1 offset:27392
  v_mov_b32 v20, v14
  v_mov_b32 v22, v15
  s_waitcnt lgkmcnt(8)
  v_mfma_f32_32x32x16_bf16 v[80:95], a[240:243], v[168:171], v[80:95]
  ds_read_b64_tr_b16 a[240:241], v1 offset:28672
  ds_read_b64_tr_b16 a[242:243], v1 offset:28928
  v_mov_b32 v21, s44
  v_mov_b32 v23, s44
  v_lshlrev_b32 v24, 22, v0
  v_and_b32 v24, 0x80000000, v24
  v_or_b32 v24, v24, v0
  v_mfma_f32_32x32x16_bf16 v[96:111], a[244:247], v[168:171], v[96:111]
  s_lshl_b32 s77, s46, 4
  s_add_u32 s77, s77, s41
  s_lshl_b32 s77, s77, 9
  s_add_u32 s77, s77, 1048576
  buffer_store_dwordx4 v[20:23], v24, s[36:39], s77 offen sc1
  ds_read_b64_tr_b16 a[244:245], v1 offset:29184
  ds_read_b64_tr_b16 a[246:247], v1 offset:29440
  v_mfma_f32_32x32x16_bf16 v[80:95], a[248:251], v[172:175], v[80:95]
  buffer_load_dwordx4 v3, s[16:19], s62 offen offset:2048 lds
  ds_read_b64_tr_b16 a[248:249], v1 offset:30720
  ds_read_b64_tr_b16 a[250:251], v1 offset:30976
  v_mfma_f32_32x32x16_bf16 v[96:111], a[252:255], v[172:175], v[96:111]
  ds_read_b64_tr_b16 a[252:253], v1 offset:31232
  ds_read_b64_tr_b16 a[254:255], v1 offset:31488
  v_mul_f32 v40, 0x3eb8aa3b, v10
  v_mul_f32 v112, v112, v40
  v_mul_f32 v113, v113, v40
  v_mul_f32 v114, v114, v40
  s_waitcnt lgkmcnt(8)
  v_mfma_f32_32x32x16_bf16 v[80:95], a[224:227], v[176:179], v[80:95]
  buffer_load_dwordx4 v4, s[16:19], s62 offen offset:3072 lds
  v_mul_f32 v115, v115, v40
  v_mul_f32 v116, v116, v40
  v_mul_f32 v117, v117, v40
  v_mfma_f32_32x32x16_bf16 v[96:111], a[228:231], v[176:179], v[96:111]
  s_waitcnt vmcnt(9) lgkmcnt(0)
  s_barrier
  s_add_u32 s77, s48, 0
  v_mov_b32 v2, s44
  buffer_store_dword v2, v9, s[36:39], s77 offen sc1
  ds_read_b64_tr_b16 a[224:225], v1 offset:32768
  ds_read_b64_tr_b16 a[226:227], v1 offset:33024
  ds_read_b64_tr_b16 a[228:229], v1 offset:33280
  ds_read_b64_tr_b16 a[230:231], v1 offset:33536
  v_mfma_f32_32x32x16_bf16 v[80:95], a[232:235], v[180:183], v[80:95]
  ds_read_b128 a[64:67], v5 offset:4096
  ds_read_b128 a[68:71], v6 offset:4096
  ds_read_b64_tr_b16 a[232:233], v1 offset:34816
  ds_read_b64_tr_b16 a[234:235], v1 offset:35072
  v_mfma_f32_32x32x16_bf16 v[96:111], a[236:239], v[180:183], v[96:111]
  ds_read_b128 a[72:75], v7 offset:4096
  ds_read_b64_tr_b16 a[236:237], v1 offset:35328
  ds_read_b64_tr_b16 a[238:239], v1 offset:35584
  v_mfma_f32_32x32x16_bf16 v[80:95], a[240:243], v[184:187], v[80:95]
  ds_read_b128 a[76:79], v8 offset:4096
  ds_read_b64_tr_b16 a[240:241], v1 offset:36864
  ds_read_b64_tr_b16 a[242:243], v1 offset:37120
  s_waitcnt lgkmcnt(2)
  s_add_u32 s61, s0, s1
  v_mfma_f32_32x32x16_bf16 v[96:111], a[244:247], v[184:187], v[96:111]
  ds_read_b64_tr_b16 a[244:245], v1 offset:37376
  ds_read_b64_tr_b16 a[246:247], v1 offset:37632
  v_mul_f32 v118, v118, v40
  v_mul_f32 v119, v119, v40
  v_mul_f32 v120, v120, v40
  s_add_u32 s62, s61, 63488
  v_mfma_f32_32x32x16_bf16 v[80:95], a[248:251], v[188:191], v[80:95]
  ds_read_b64_tr_b16 a[248:249], v1 offset:38912
  ds_read_b64_tr_b16 a[250:251], v1 offset:39168
  v_mul_f32 v121, v121, v40
  v_mul_f32 v122, v122, v40
  v_mul_f32 v123, v123, v40
  s_add_u32 m0, s64, 4096
  s_add_u32 s1, s1, 128
  s_and_b32 s1, s1, 2047
  v_mfma_f32_32x32x16_bf16 v[96:111], a[252:255], v[188:191], v[96:111]
  ds_read_b64_tr_b16 a[252:253], v1 offset:39424
  ds_read_b64_tr_b16 a[254:255], v1 offset:39680
  v_mul_f32 v124, v124, v40
  v_mul_f32 v125, v125, v40
  v_mul_f32 v126, v126, v40
  v_mul_f32 v127, v127, v40
  v_mfma_f32_32x32x16_bf16 v[80:95], a[224:227], v[192:195], v[80:95]
  buffer_load_dwordx4 v3, s[16:19], s61 offen lds
  ds_read_b64_tr_b16 a[224:225], v1 offset:40960
  ds_read_b64_tr_b16 a[226:227], v1 offset:41216
  v_mfma_f32_32x32x16_bf16 v[96:111], a[228:231], v[192:195], v[96:111]
  ds_read_b64_tr_b16 a[228:229], v1 offset:41472
  ds_read_b64_tr_b16 a[230:231], v1 offset:41728
  v_cvt_pk_bf16_f32 v112, v112, v113
  v_cvt_pk_bf16_f32 v113, v114, v115
  v_cvt_pk_bf16_f32 v114, v116, v117
  v_cvt_pk_bf16_f32 v115, v118, v119
  v_mfma_f32_32x32x16_bf16 v[80:95], a[232:235], v[196:199], v[80:95]
  buffer_load_dwordx4 v4, s[16:19], s61 offen offset:1024 lds
  ds_read_b64_tr_b16 a[232:233], v1 offset:43008
  ds_read_b64_tr_b16 a[234:235], v1 offset:43264
  v_mfma_f32_32x32x16_bf16 v[96:111], a[236:239], v[196:199], v[96:111]
  ds_read_b64_tr_b16 a[236:237], v1 offset:43520
  ds_read_b64_tr_b16 a[238:239], v1 offset:43776
  v_cvt_pk_bf16_f32 v116, v120, v121
  v_cvt_pk_bf16_f32 v117, v122, v123
  v_cvt_pk_bf16_f32 v118, v124, v125
  v_cvt_pk_bf16_f32 v119, v126, v127
  s_waitcnt lgkmcnt(8)
  v_mfma_f32_32x32x16_bf16 v[80:95], a[240:243], v[200:203], v[80:95]
  ds_read_b64_tr_b16 a[240:241], v1 offset:45056
  ds_read_b64_tr_b16 a[242:243], v1 offset:45312
  v_lshrrev_b32 v122, 3, v0
  v_and_b32 v122, 64, v122
  v_add_u32 v122, v122, v0
  v_and_b32 v123, 0x200, v0
  v_or_b32 v123, s63, v123
  v_and_b32 v120, 0x1f0, v122
  v_mfma_f32_32x32x16_bf16 v[96:111], a[244:247], v[200:203], v[96:111]
  buffer_load_dwordx4 v3, s[16:19], s62 offen offset:2048 lds
  ds_read_b64_tr_b16 a[244:245], v1 offset:45568
  ds_read_b64_tr_b16 a[246:247], v1 offset:45824
  v_mfma_f32_32x32x16_bf16 v[80:95], a[248:251], v[204:207], v[80:95]
  ds_read_b64_tr_b16 a[248:249], v1 offset:47104
  ds_read_b64_tr_b16 a[250:251], v1 offset:47360
  v_or_b32 v120, v120, v123
  v_add_u32 v122, 128, v122
  v_and_b32 v121, 0x1f0, v122
  v_or_b32 v121, v121, v123
  v_mfma_f32_32x32x16_bf16 v[96:111], a[252:255], v[204:207], v[96:111]
  ds_read_b64_tr_b16 a[252:253], v1 offset:47616
  ds_read_b64_tr_b16 a[254:255], v1 offset:47872
  v_bfe_u32 v122, v0, 8, 1
  v_bfe_u32 v123, v0, 5, 1
  v_lshlrev_b32 v126, 10, v122
  v_lshl_add_u32 v126, v123, 9, v126
  s_waitcnt lgkmcnt(8)
  v_mfma_f32_32x32x16_bf16 v[80:95], a[224:227], v[208:211], v[80:95]
  buffer_load_dwordx4 v4, s[16:19], s62 offen offset:3072 lds
  ds_read_b64_tr_b16 a[224:225], v1 offset:49152
  ds_read_b64_tr_b16 a[226:227], v1 offset:49408
  v_mfma_f32_32x32x16_bf16 v[96:111], a[228:231], v[208:211], v[96:111]
  ds_read_b64_tr_b16 a[228:229], v1 offset:49664
  ds_read_b64_tr_b16 a[230:231], v1 offset:49920
  v_bfe_u32 v127, v0, 4, 1
  v_lshl_add_u32 v126, v127, 3, v126
  v_add_u32 v126, s63, v126
  v_lshlrev_b32 v127, 3, v122
  v_lshl_add_u32 v127, v123, 2, v127
  v_mfma_f32_32x32x16_bf16 v[80:95], a[232:235], v[212:215], v[80:95]
  s_waitcnt vmcnt(10)
  ds_read_b128 a[80:83], v5 offset:8192
  ds_read_b128 a[84:87], v6 offset:8192
  ds_read_b128 a[88:91], v7 offset:8192
  ds_read_b64_tr_b16 a[232:233], v1 offset:51200
  ds_read_b64_tr_b16 a[234:235], v1 offset:51456
  v_lshrrev_b32 v123, 9, v0
  v_mfma_f32_32x32x16_bf16 v[96:111], a[236:239], v[212:215], v[96:111]
  ds_read_b128 a[92:95], v8 offset:8192
  ds_read_b64_tr_b16 a[236:237], v1 offset:51712
  ds_read_b64_tr_b16 a[238:239], v1 offset:51968
  v_lshl_add_u32 v127, v123, 3, v127
  v_bfe_u32 v123, v0, 6, 2
  s_waitcnt lgkmcnt(2)
  v_mfma_f32_32x32x16_bf16 v[80:95], a[240:243], v[216:219], v[80:95]
  ds_read_b64_tr_b16 a[240:241], v1 offset:53248
  ds_read_b64_tr_b16 a[242:243], v1 offset:53504
  v_add_u32 v127, v127, v123
  s_add_u32 s61, s0, s1
  s_add_u32 s62, s61, 63488
  s_add_u32 m0, s64, 8192
  s_add_u32 s1, s1, 128
  v_mfma_f32_32x32x16_bf16 v[96:111], a[244:247], v[216:219], v[96:111]
  ds_read_b64_tr_b16 a[244:245], v1 offset:53760
  ds_read_b64_tr_b16 a[246:247], v1 offset:54016
  v_add_u32 v122, 0, v127
  v_and_b32 v122, 31, v122
  v_lshl_add_u32 v122, v122, 4, v126
  s_and_b32 s1, s1, 2047
  v_mfma_f32_32x32x16_bf16 v[80:95], a[248:251], v[220:223], v[80:95]
  buffer_load_dwordx4 v3, s[16:19], s61 offen lds
  ds_read_b64_tr_b16 a[248:249], v1 offset:55296
  ds_read_b64_tr_b16 a[250:251], v1 offset:55552
  v_mfma_f32_32x32x16_bf16 v[96:111], a[252:255], v[220:223], v[96:111]
  buffer_load_dwordx4 v4, s[16:19], s61 offen offset:1024 lds
  ds_read_b64_tr_b16 a[252:253], v1 offset:55808
  ds_read_b64_tr_b16 a[254:255], v1 offset:56064
  s_waitcnt lgkmcnt(8)
  v_mfma_f32_32x32x16_bf16 v[80:95], a[224:227], v[224:227], v[80:95]
  ds_read_b64_tr_b16 a[224:225], v1 offset:57344
  ds_read_b64_tr_b16 a[226:227], v1 offset:57600
  v_add_u32 v123, 4, v127
  v_and_b32 v123, 31, v123
  v_lshl_add_u32 v123, v123, 4, v126
  v_add_u32 v124, 16, v127
  v_and_b32 v124, 31, v124
  v_mfma_f32_32x32x16_bf16 v[96:111], a[228:231], v[224:227], v[96:111]
  buffer_load_dwordx4 v3, s[16:19], s62 offen offset:2048 lds
  ds_read_b64_tr_b16 a[228:229], v1 offset:57856
  ds_read_b64_tr_b16 a[230:231], v1 offset:58112
  v_mfma_f32_32x32x16_bf16 v[80:95], a[232:235], v[228:231], v[80:95]
  ds_read_b64_tr_b16 a[232:233], v1 offset:59392
  ds_read_b64_tr_b16 a[234:235], v1 offset:59648
  v_lshl_add_u32 v124, v124, 4, v126
  v_add_u32 v125, 20, v127
  v_and_b32 v125, 31, v125
  v_lshl_add_u32 v125, v125, 4, v126
  v_mfma_f32_32x32x16_bf16 v[96:111], a[236:239], v[228:231], v[96:111]
  buffer_load_dwordx4 v4, s[16:19], s62 offen offset:3072 lds
  ds_read_b64_tr_b16 a[236:237], v1 offset:59904
  ds_read_b64_tr_b16 a[238:239], v1 offset:60160
  s_waitcnt lgkmcnt(8)
  v_mfma_f32_32x32x16_bf16 v[80:95], a[240:243], v[232:235], v[80:95]
  ds_read_b64_tr_b16 a[240:241], v1 offset:61440
  ds_read_b64_tr_b16 a[242:243], v1 offset:61696
  s_lshl_b32 s78, s41, 7
  s_add_u32 s78, s78, s46
  s_lshl_b32 s78, s78, 11
  s_add_u32 s73, s78, 6291456
  v_mfma_f32_32x32x16_bf16 v[96:111], a[244:247], v[232:235], v[96:111]
  ds_read_b64_tr_b16 a[244:245], v1 offset:61952
  ds_read_b64_tr_b16 a[246:247], v1 offset:62208
  v_add_u32 v126, 131072, v0
  v_mfma_f32_32x32x16_bf16 v[80:95], a[248:251], v[236:239], v[80:95]
  ds_read_b64_tr_b16 a[248:249], v1 offset:63488
  ds_read_b64_tr_b16 a[250:251], v1 offset:63744
  s_max_u32 s77, s40, 1
  s_sub_u32 s77, s77, 1
  s_max_u32 s78, s40, 2
  s_sub_u32 s78, s78, 2
  s_sub_u32 s77, s77, s78
  s_lshl_b32 s77, s77, 8
  s_lshl_b32 s78, s78, 4
  s_add_u32 s78, s78, s41
  s_lshl_b32 s78, s78, 8
  s_add_u32 s78, s78, 4096
  v_and_b32 v2, 16, v0
  v_mul_u32_u24 v2, s77, v2
  v_add_u32 v2, s78, v2
  v_mfma_f32_32x32x16_bf16 v[96:111], a[252:255], v[236:239], v[96:111]
  ds_read_b64_tr_b16 a[252:253], v1 offset:64000
  ds_read_b64_tr_b16 a[254:255], v1 offset:64256
  s_waitcnt lgkmcnt(8)
  v_mfma_f32_32x32x16_bf16 v[80:95], a[224:227], v[240:243], v[80:95]
  buffer_load_dword v10, v2, s[36:39], 0 offen sc1
  v_and_b32 v14, 0x1f0, v0
  v_and_b32 v15, 0x200, v0
  v_mfma_f32_32x32x16_bf16 v[96:111], a[228:231], v[240:243], v[96:111]
  v_lshl_add_u32 v14, v15, 3, v14
  s_lshl_b32 s77, s46, 13
  s_add_u32 s77, s77, 1048576
  v_add_u32 v14, s77, v14
  v_mfma_f32_32x32x16_bf16 v[80:95], a[232:235], v[244:247], v[80:95]
  buffer_load_dwordx4 v[16:19], v14, s[36:39], 0 offen sc1
  buffer_load_dwordx4 v[20:23], v14, s[36:39], 0 offen offset:512 sc1
  v_mfma_f32_32x32x16_bf16 v[96:111], a[236:239], v[244:247], v[96:111]
  buffer_load_dwordx4 v[24:27], v14, s[36:39], 0 offen offset:1024 sc1
  s_waitcnt lgkmcnt(0)
  v_mfma_f32_32x32x16_bf16 v[80:95], a[240:243], v[248:251], v[80:95]
  buffer_load_dwordx4 v[28:31], v14, s[36:39], 0 offen offset:1536 sc1
  v_mfma_f32_32x32x16_bf16 v[96:111], a[244:247], v[248:251], v[96:111]
  buffer_load_dwordx4 v[32:35], v14, s[36:39], 0 offen offset:2048 sc1
  v_mfma_f32_32x32x16_bf16 v[80:95], a[248:251], v[252:255], v[80:95]
  buffer_load_dwordx4 v[36:39], v14, s[36:39], 0 offen offset:2560 sc1
  buffer_load_dwordx4 v[40:43], v14, s[36:39], 0 offen offset:3072 sc1
  v_mfma_f32_32x32x16_bf16 v[96:111], a[252:255], v[252:255], v[96:111]
  buffer_load_dwordx4 v[44:47], v14, s[36:39], 0 offen offset:3584 sc1
  s_waitcnt vmcnt(8)
  v_cmp_ne_u32 s[74:75], s44, v10
  s_nop 1
  s_cmp_lg_u64 s[74:75], 0
  s_cbranch_scc1 L_slow_1
L_back_2:
  s_lshl_b32 s77, s43, 1
  s_add_u32 s77, s77, 0
  s_lshl_b32 m0, s77, 12
  s_lshl_b32 s78, s40, 2
  s_add_u32 s77, s77, s78
  s_max_u32 s77, s77, 8
  s_sub_u32 s77, s77, 8
  s_lshl_b32 s78, s41, 6
  s_add_u32 s77, s77, s78
  s_lshl_b32 s77, s77, 12
  s_add_u32 s69, s77, 2097152
  v_bfe_u32 v132, v0, 4, 5
  v_lshrrev_b32 v133, 9, v0
  v_lshlrev_b32 v133, 2, v133
  v_sub_u32 v132, v132, v133
  buffer_load_dwordx4 v0, s[36:39], s69 offen sc1 lds
  v_mov_b32 v134, 0xff800000
  v_cmp_gt_i32 vcc, 0, v132
  v_mov_b32 v224, s72
  s_nop 0
  v_cndmask_b32 v176, 0, v134, vcc
  buffer_load_dwordx4 v0, s[36:39], s69 offen offset:1024 sc1 lds
  v_cmp_gt_i32 vcc, 1, v132
  v_mov_b32 v225, s72
  v_xor_b32 v192, v176, v134
  v_cndmask_b32 v177, 0, v134, vcc
  buffer_load_dwordx4 v0, s[36:39], s69 offen offset:2048 sc1 lds
  v_cmp_gt_i32 vcc, 2, v132
  v_mov_b32 v226, s72
  v_xor_b32 v193, v177, v134
  v_cndmask_b32 v178, 0, v134, vcc
  buffer_load_dwordx4 v0, s[36:39], s69 offen offset:3072 sc1 lds
  v_cmp_gt_i32 vcc, 3, v132
  v_mov_b32 v227, s72
  v_xor_b32 v194, v178, v134
  v_cndmask_b32 v179, 0, v134, vcc
  s_lshl_b32 s77, s43, 1
  s_add_u32 s77, s77, 1
  s_lshl_b32 m0, s77, 12
  s_lshl_b32 s78, s40, 2
  s_add_u32 s77, s77, s78
  s_max_u32 s77, s77, 8
  s_sub_u32 s77, s77, 8
  s_lshl_b32 s78, s41, 6
  s_add_u32 s77, s77, s78
  s_lshl_b32 s77, s77, 12
  s_add_u32 s69, s77, 2097152
  v_cmp_gt_i32 vcc, 8, v132
  v_mov_b32 v228, s72
  v_xor_b32 v195, v179, v134
  v_cndmask_b32 v180, 0, v134, vcc
  buffer_load_dwordx4 v0, s[36:39], s69 offen sc1 lds
  v_cmp_gt_i32 vcc, 9, v132
  v_mov_b32 v229, s72
  v_xor_b32 v196, v180, v134
  v_cndmask_b32 v181, 0, v134, vcc
  buffer_load_dwordx4 v0, s[36:39], s69 offen offset:1024 sc1 lds
  v_cmp_gt_i32 vcc, 10, v132
  v_mov_b32 v230, s72
  v_xor_b32 v197, v181, v134
  v_cndmask_b32 v182, 0, v134, vcc
  buffer_load_dwordx4 v0, s[36:39], s69 offen offset:2048 sc1 lds
  v_cmp_gt_i32 vcc, 11, v132
  v_mov_b32 v231, s72
  v_xor_b32 v198, v182, v134
  v_cndmask_b32 v183, 0, v134, vcc
  buffer_load_dwordx4 v0, s[36:39], s69 offen offset:3072 sc1 lds
  v_cmp_gt_i32 vcc, 16, v132
  v_mov_b32 v232, s72
  v_xor_b32 v199, v183, v134
  v_cndmask_b32 v184, 0, v134, vcc
  s_waitcnt vmcnt(8)
  v_xor_b32 v15, s44, v17
  v_bitop3_b32 v15, v15, v19, s44 bitop3:0xf6
  v_bitop3_b32 v15, v15, v21, s44 bitop3:0xf6
  v_bitop3_b32 v15, v15, v23, s44 bitop3:0xf6
  v_bitop3_b32 v15, v15, v25, s44 bitop3:0xf6
  v_bitop3_b32 v15, v15, v27, s44 bitop3:0xf6
  v_bitop3_b32 v15, v15, v29, s44 bitop3:0xf6
  v_bitop3_b32 v15, v15, v31, s44 bitop3:0xf6
  v_bitop3_b32 v15, v15, v33, s44 bitop3:0xf6
  v_bitop3_b32 v15, v15, v35, s44 bitop3:0xf6
  v_bitop3_b32 v15, v15, v37, s44 bitop3:0xf6
  v_bitop3_b32 v15, v15, v39, s44 bitop3:0xf6
  v_bitop3_b32 v15, v15, v41, s44 bitop3:0xf6
  v_bitop3_b32 v15, v15, v43, s44 bitop3:0xf6
  v_bitop3_b32 v15, v15, v45, s44 bitop3:0xf6
  v_bitop3_b32 v15, v15, v47, s44 bitop3:0xf6
  v_cmp_ne_u32 s[74:75], 0, v15
  s_nop 1
  s_cmp_lg_u64 s[74:75], 0
  s_cbranch_scc1 L_slow_4
L_back_5:
  v_add_f32 v16, v16, v20
  v_add_f32 v18, v18, v22
  v_add_f32 v24, v24, v28
  v_add_f32 v26, v26, v30
  v_add_f32 v32, v32, v36
  v_add_f32 v34, v34, v38
  v_add_f32 v40, v40, v44
  v_add_f32 v42, v42, v46
  v_add_f32 v16, v16, v24
  v_add_f32 v18, v18, v26
  v_add_f32 v32, v32, v40
  v_add_f32 v34, v34, v42
  v_add_f32 v16, v16, v32
  v_add_f32 v18, v18, v34
  v_mov_b32 v17, v16
  s_nop 1
  v_permlane32_swap_b32 v16, v17
  v_add_f32 v16, v16, v17
  v_mov_b32 v19, v18
  s_nop 1
  v_permlane32_swap_b32 v18, v19
  v_add_f32 v18, v18, v19
  v_mul_f32 v16, 0x3a924925, v16
  v_mul_f32 v18, 0x3a924925, v18
  v_fma_f32 v18, -v16, v16, v18
  v_max_f32 v18, 0, v18
  v_cvt_pk_bf16_f32 v16, v16, v16
  v_and_b32 v16, 0xffff0000, v16
  v_cvt_pk_bf16_f32 v18, v18, v18
  v_and_b32 v18, 0xffff0000, v18
  v_add_f32 v18, 0x3727c5ac, v18
  v_cvt_pk_bf16_f32 v18, v18, v18
  v_and_b32 v18, 0xffff0000, v18
  v_sqrt_f32 v18, v18
  s_nop 0
  v_cvt_pk_bf16_f32 v18, v18, v18
  v_and_b32 v18, 0xffff0000, v18
  v_rcp_f32 v14, v18
  s_nop 0
  v_mul_f32 v15, v16, v14
  v_xor_b32 v15, 0x80000000, v15
  v_fma_f32 v48, v48, v14, v15
  v_fma_f32 v49, v49, v14, v15
  v_fma_f32 v50, v50, v14, v15
  v_fma_f32 v51, v51, v14, v15
  v_fma_f32 v52, v52, v14, v15
  v_fma_f32 v53, v53, v14, v15
  v_fma_f32 v54, v54, v14, v15
  v_fma_f32 v55, v55, v14, v15
  v_fma_f32 v56, v56, v14, v15
  v_fma_f32 v57, v57, v14, v15
  v_fma_f32 v58, v58, v14, v15
  v_fma_f32 v59, v59, v14, v15
  v_fma_f32 v60, v60, v14, v15
  v_fma_f32 v61, v61, v14, v15
  v_fma_f32 v62, v62, v14, v15
  v_fma_f32 v63, v63, v14, v15
  v_cvt_pk_bf16_f32 v48, v48, v49
  v_cvt_pk_bf16_f32 v49, v50, v51
  v_cvt_pk_bf16_f32 v50, v52, v53
  v_cvt_pk_bf16_f32 v51, v54, v55
  v_cvt_pk_bf16_f32 v52, v56, v57
  v_cvt_pk_bf16_f32 v53, v58, v59
  v_cvt_pk_bf16_f32 v54, v60, v61
  v_cvt_pk_bf16_f32 v55, v62, v63
  v_permlane32_swap_b32 v48, v50
  v_permlane32_swap_b32 v49, v51
  v_permlane32_swap_b32 v52, v54
  v_permlane32_swap_b32 v53, v55
  ds_write_b128 v120, v[48:51]
  v_fma_f32 v64, v64, v14, v15
  v_fma_f32 v65, v65, v14, v15
  v_fma_f32 v66, v66, v14, v15
  v_fma_f32 v67, v67, v14, v15
  v_fma_f32 v68, v68, v14, v15
  v_fma_f32 v69, v69, v14, v15
  ds_write_b128 v121, v[52:55] offset:1024
  v_fma_f32 v70, v70, v14, v15
  v_fma_f32 v71, v71, v14, v15
  v_fma_f32 v72, v72, v14, v15
  v_fma_f32 v73, v73, v14, v15
  v_fma_f32 v74, v74, v14, v15
  v_fma_f32 v75, v75, v14, v15
  v_fma_f32 v76, v76, v14, v15
  v_fma_f32 v77, v77, v14, v15
  s_waitcnt lgkmcnt(0)
  ds_read_b64_tr_b16 v[16:17], v122
  ds_read_b64_tr_b16 v[18:19], v123
  ds_read_b64_tr_b16 v[20:21], v124
  ds_read_b64_tr_b16 v[22:23], v125
  v_fma_f32 v78, v78, v14, v15
  v_fma_f32 v79, v79, v14, v15
  v_cvt_pk_bf16_f32 v64, v64, v65
  v_cvt_pk_bf16_f32 v65, v66, v67
  v_cvt_pk_bf16_f32 v66, v68, v69
  v_cvt_pk_bf16_f32 v67, v70, v71
  v_cvt_pk_bf16_f32 v68, v72, v73
  v_cvt_pk_bf16_f32 v69, v74, v75
  s_waitcnt lgkmcnt(0)
  buffer_store_dwordx4 v[16:19], v0, s[36:39], s73 offen sc1
  v_cvt_pk_bf16_f32 v70, v76, v77
  v_cvt_pk_bf16_f32 v71, v78, v79
  v_permlane32_swap_b32 v64, v66
  v_permlane32_swap_b32 v65, v67
  v_permlane32_swap_b32 v68, v70
  v_permlane32_swap_b32 v69, v71
  ds_write_b128 v120, v[64:67] offset:2048
  buffer_store_dwordx4 v[20:23], v0, s[36:39], s73 offen offset:1024 sc1
  ds_write_b128 v121, v[68:71] offset:3072
  v_cmp_gt_i32 vcc, 17, v132
  v_mov_b32 v233, s72
  v_xor_b32 v200, v184, v134
  v_cndmask_b32 v185, 0, v134, vcc
  v_cmp_gt_i32 vcc, 18, v132
  v_mov_b32 v234, s72
  v_xor_b32 v201, v185, v134
  v_cndmask_b32 v186, 0, v134, vcc
  v_cmp_gt_i32 vcc, 19, v132
  v_mov_b32 v235, s72
  v_xor_b32 v202, v186, v134
  v_cndmask_b32 v187, 0, v134, vcc
  v_cmp_gt_i32 vcc, 24, v132
  v_mov_b32 v236, s72
  v_xor_b32 v203, v187, v134
  v_cndmask_b32 v188, 0, v134, vcc
  s_waitcnt lgkmcnt(0)
  ds_read_b64_tr_b16 v[24:25], v122 offset:2048
  ds_read_b64_tr_b16 v[26:27], v123 offset:2048
  ds_read_b64_tr_b16 v[28:29], v124 offset:2048
  ds_read_b64_tr_b16 v[30:31], v125 offset:2048
  v_cmp_gt_i32 vcc, 25, v132
  v_mov_b32 v237, s72
  v_xor_b32 v204, v188, v134
  v_cndmask_b32 v189, 0, v134, vcc
  v_cmp_gt_i32 vcc, 26, v132
  v_mov_b32 v238, s72
  v_xor_b32 v205, v189, v134
  v_cndmask_b32 v190, 0, v134, vcc
  v_cmp_gt_i32 vcc, 27, v132
  v_mov_b32 v239, s72
  v_xor_b32 v206, v190, v134
  v_cndmask_b32 v191, 0, v134, vcc
  v_xor_b32 v207, v191, v134
  s_mov_b32 s70, 0xffff
  s_mov_b32 s71, 0xffff
  s_min_u32 s52, s46, 8
  s_sub_u32 s52, 8, s52
  s_waitcnt lgkmcnt(0)
  buffer_store_dwordx4 v[24:27], v126, s[36:39], s73 offen sc1
  buffer_store_dwordx4 v[28:31], v126, s[36:39], s73 offen offset:1024 sc1
  s_lshl_b32 s77, s43, 12
  v_add_u32 v120, s77, v0
  s_waitcnt vmcnt(4)
  s_waitcnt lgkmcnt(0)
  s_barrier
  s_cmp_lt_u32 s40, 2
  s_cbranch_scc1 L_fedge
  ds_read_b128 v[128:131], v120 offset:32768
  ds_read_b128 v[132:135], v120 offset:28672
  ds_read_b128 v[136:139], v120 offset:24576
  s_mov_b64 exec, s[70:71]
  ds_read_b128 v[224:227], v120 offset:34816
  ds_read_b128 v[228:231], v120 offset:35840
  s_mov_b64 exec, -1
  s_waitcnt lgkmcnt(4)
  v_mfma_f32_32x32x16_bf16 v[144:159], v[128:131], v[112:115], v[176:191]
  s_waitcnt lgkmcnt(3)
  v_mfma_f32_32x32x16_bf16 v[160:175], v[132:135], v[112:115], 0
  s_mov_b64 exec, s[70:71]
  ds_read_b128 v[232:235], v120 offset:30720
  ds_read_b128 v[236:239], v120 offset:31744
  s_mov_b64 exec, -1
  ds_read_b128 v[140:143], v120 offset:20480
  s_nop 4
  v_exp_f32 v144, v144
  v_exp_f32 v145, v145
  v_exp_f32 v146, v146
  v_exp_f32 v147, v147
  v_exp_f32 v148, v148
  v_exp_f32 v149, v149
  v_exp_f32 v150, v150
  v_exp_f32 v151, v151
  v_exp_f32 v152, v152
  v_exp_f32 v153, v153
  v_exp_f32 v154, v154
  v_exp_f32 v155, v155
  v_exp_f32 v156, v156
  v_exp_f32 v157, v157
  v_exp_f32 v158, v158
  v_exp_f32 v159, v159
  v_cvt_pk_bf16_f32 v208, v144, v145
  v_cvt_pk_bf16_f32 v209, v146, v147
  v_cvt_pk_bf16_f32 v210, v148, v149
  v_cvt_pk_bf16_f32 v211, v150, v151
  v_cvt_pk_bf16_f32 v212, v152, v153
  v_cvt_pk_bf16_f32 v213, v154, v155
  v_cvt_pk_bf16_f32 v214, v156, v157
  v_cvt_pk_bf16_f32 v215, v158, v159
  ds_read_b128 a[96:99], v5
  ds_read_b128 a[100:103], v6
  ds_read_b128 a[104:107], v7
  ds_read_b128 a[108:111], v8
  v_exp_f32 v160, v160
  v_exp_f32 v161, v161
  s_waitcnt lgkmcnt(9)
  v_mfma_f32_32x32x16_bf16 v[144:159], v[136:139], v[112:115], 0
  s_waitcnt lgkmcnt(0)
  s_add_u32 s61, s0, s1
  s_add_u32 s62, s61, 63488
  s_add_u32 m0, s64, 0
  s_nop 0
  buffer_load_dwordx4 v3, s[16:19], s61 offen lds
  s_add_u32 s1, s1, 128
  s_and_b32 s1, s1, 2047
  v_exp_f32 v162, v162
  v_exp_f32 v163, v163
  v_exp_f32 v164, v164
  v_exp_f32 v165, v165
  v_exp_f32 v166, v166
  v_mfma_f32_32x32x16_bf16 v[240:255], v[224:227], v[208:211], 0
  buffer_load_dwordx4 v4, s[16:19], s61 offen offset:1024 lds
  buffer_load_dwordx4 v3, s[16:19], s62 offen offset:2048 lds
  buffer_load_dwordx4 v4, s[16:19], s62 offen offset:3072 lds
  ds_read_b128 a[112:115], v5 offset:4096
  ds_read_b128 a[116:119], v6 offset:4096
  ds_read_b128 a[120:123], v7 offset:4096
  ds_read_b128 a[124:127], v8 offset:4096
  v_exp_f32 v167, v167
  v_exp_f32 v168, v168
  v_exp_f32 v169, v169
  v_exp_f32 v170, v170
  v_exp_f32 v171, v171
  v_mfma_f32_32x32x16_bf16 v[240:255], v[228:231], v[212:215], v[240:255]
  s_mov_b64 exec, s[70:71]
  ds_read_b128 v[224:227], v120 offset:26624
  ds_read_b128 v[228:231], v120 offset:27648
  s_mov_b64 exec, -1
  ds_read_b128 v[128:131], v120 offset:16384
  v_exp_f32 v172, v172
  v_exp_f32 v173, v173
  v_exp_f32 v174, v174
  v_exp_f32 v175, v175
  v_cvt_pk_bf16_f32 v216, v160, v161
  v_cvt_pk_bf16_f32 v217, v162, v163
  v_cvt_pk_bf16_f32 v218, v164, v165
  v_cvt_pk_bf16_f32 v219, v166, v167
  v_cvt_pk_bf16_f32 v220, v168, v169
  v_cvt_pk_bf16_f32 v221, v170, v171
  v_cvt_pk_bf16_f32 v222, v172, v173
  v_cvt_pk_bf16_f32 v223, v174, v175
  v_exp_f32 v144, v144
  v_exp_f32 v145, v145
  v_mfma_f32_32x32x16_bf16 v[160:175], v[140:143], v[112:115], 0
  s_waitcnt lgkmcnt(3)
  s_add_u32 s61, s0, s1
  s_add_u32 s62, s61, 63488
  s_add_u32 m0, s64, 4096
  s_nop 0
  buffer_load_dwordx4 v3, s[16:19], s61 offen lds
  s_add_u32 s1, s1, 128
  s_and_b32 s1, s1, 2047
  v_exp_f32 v146, v146
  v_exp_f32 v147, v147
  v_exp_f32 v148, v148
  v_exp_f32 v149, v149
  v_exp_f32 v150, v150
  v_mfma_f32_32x32x16_bf16 v[240:255], v[232:235], v[216:219], v[240:255]
  buffer_load_dwordx4 v4, s[16:19], s61 offen offset:1024 lds
  buffer_load_dwordx4 v3, s[16:19], s62 offen offset:2048 lds
  buffer_load_dwordx4 v4, s[16:19], s62 offen offset:3072 lds
  ds_read_b128 a[128:131], v5 offset:8192
  ds_read_b128 a[132:135], v6 offset:8192
  ds_read_b128 a[136:139], v7 offset:8192
  ds_read_b128 a[140:143], v8 offset:8192
  v_exp_f32 v151, v151
  v_exp_f32 v152, v152
  v_exp_f32 v153, v153
  v_exp_f32 v154, v154
  v_exp_f32 v155, v155
  v_mfma_f32_32x32x16_bf16 v[240:255], v[236:239], v[220:223], v[240:255]
  s_mov_b64 exec, s[70:71]
  ds_read_b128 v[232:235], v120 offset:22528
  ds_read_b128 v[236:239], v120 offset:23552
  s_mov_b64 exec, -1
  ds_read_b128 v[132:135], v120 offset:12288
  v_exp_f32 v156, v156
  v_exp_f32 v157, v157
  v_exp_f32 v158, v158
  v_exp_f32 v159, v159
  v_cvt_pk_bf16_f32 v208, v144, v145
  v_cvt_pk_bf16_f32 v209, v146, v147
  v_cvt_pk_bf16_f32 v210, v148, v149
  v_cvt_pk_bf16_f32 v211, v150, v151
  v_cvt_pk_bf16_f32 v212, v152, v153
  v_cvt_pk_bf16_f32 v213, v154, v155
  v_cvt_pk_bf16_f32 v214, v156, v157
  v_cvt_pk_bf16_f32 v215, v158, v159
  v_exp_f32 v160, v160
  v_exp_f32 v161, v161
  s_waitcnt lgkmcnt(7)
  v_mfma_f32_32x32x16_bf16 v[144:159], v[128:131], v[112:115], 0
  s_waitcnt lgkmcnt(3)
  s_add_u32 s61, s0, s1
  s_add_u32 s62, s61, 63488
  s_add_u32 m0, s64, 8192
  s_add_u32 s1, s1, 128
  v_exp_f32 v162, v162
  v_exp_f32 v163, v163
  v_exp_f32 v164, v164
  v_exp_f32 v165, v165
  v_exp_f32 v166, v166
  v_mfma_f32_32x32x16_bf16 v[240:255], v[224:227], v[208:211], v[240:255]
  buffer_load_dwordx4 v3, s[16:19], s61 offen lds
  buffer_load_dwordx4 v4, s[16:19], s61 offen offset:1024 lds
  buffer_load_dwordx4 v3, s[16:19], s62 offen offset:2048 lds
  buffer_load_dwordx4 v4, s[16:19], s62 offen offset:3072 lds
  s_and_b32 s1, s1, 2047
  v_exp_f32 v167, v167
  v_exp_f32 v168, v168
  v_exp_f32 v169, v169
  v_exp_f32 v170, v170
  v_exp_f32 v171, v171
  v_mfma_f32_32x32x16_bf16 v[240:255], v[228:231], v[212:215], v[240:255]
  s_mov_b64 exec, s[70:71]
  ds_read_b128 v[224:227], v120 offset:18432
  ds_read_b128 v[228:231], v120 offset:19456
  s_mov_b64 exec, -1
  ds_read_b128 v[136:139], v120 offset:8192
  v_exp_f32 v172, v172
  v_exp_f32 v173, v173
  v_exp_f32 v174, v174
  v_exp_f32 v175, v175
  v_cvt_pk_bf16_f32 v216, v160, v161
  v_cvt_pk_bf16_f32 v217, v162, v163
  v_cvt_pk_bf16_f32 v218, v164, v165
  v_cvt_pk_bf16_f32 v219, v166, v167
  v_cvt_pk_bf16_f32 v220, v168, v169
  v_cvt_pk_bf16_f32 v221, v170, v171
  v_cvt_pk_bf16_f32 v222, v172, v173
  v_cvt_pk_bf16_f32 v223, v174, v175
  v_exp_f32 v144, v144
  v_exp_f32 v145, v145
  s_waitcnt lgkmcnt(3)
  v_mfma_f32_32x32x16_bf16 v[160:175], v[132:135], v[112:115], 0
  s_waitcnt vmcnt(12)
  s_barrier
  s_add_u32 s77, s48, 65536
  v_mov_b32 v126, s44
  buffer_store_dword v126, v9, s[36:39], s77 offen sc1
  s_waitcnt vmcnt(9)
  v_exp_f32 v146, v146
  v_exp_f32 v147, v147
  v_exp_f32 v148, v148
  v_exp_f32 v149, v149
  v_exp_f32 v150, v150
  v_mfma_f32_32x32x16_bf16 v[240:255], v[232:235], v[216:219], v[240:255]
  ds_read_b128 a[144:147], v5
  ds_read_b128 a[148:151], v6
  ds_read_b128 a[152:155], v7
  ds_read_b128 a[156:159], v8
  v_exp_f32 v151, v151
  v_exp_f32 v152, v152
  v_exp_f32 v153, v153
  v_exp_f32 v154, v154
  v_exp_f32 v155, v155
  v_mfma_f32_32x32x16_bf16 v[240:255], v[236:239], v[220:223], v[240:255]
  s_mov_b64 exec, s[70:71]
  ds_read_b128 v[232:235], v120 offset:14336
  ds_read_b128 v[236:239], v120 offset:15360
  s_mov_b64 exec, -1
  ds_read_b128 v[140:143], v120 offset:4096
  v_exp_f32 v156, v156
  v_exp_f32 v157, v157
  v_exp_f32 v158, v158
  v_exp_f32 v159, v159
  v_cvt_pk_bf16_f32 v208, v144, v145
  v_cvt_pk_bf16_f32 v209, v146, v147
  v_cvt_pk_bf16_f32 v210, v148, v149
  v_cvt_pk_bf16_f32 v211, v150, v151
  v_cvt_pk_bf16_f32 v212, v152, v153
  v_cvt_pk_bf16_f32 v213, v154, v155
  v_cvt_pk_bf16_f32 v214, v156, v157
  v_cvt_pk_bf16_f32 v215, v158, v159
  v_exp_f32 v160, v160
  v_exp_f32 v161, v161
  s_waitcnt lgkmcnt(7)
  v_mfma_f32_32x32x16_bf16 v[144:159], v[136:139], v[112:115], 0
  s_waitcnt lgkmcnt(3)
  s_add_u32 s61, s0, s1
  s_add_u32 s62, s61, 63488
  s_add_u32 m0, s64, 0
  s_nop 0
  buffer_load_dwordx4 v3, s[16:19], s61 offen lds
  s_add_u32 s1, s1, 128
  s_and_b32 s1, s1, 2047
  v_exp_f32 v162, v162
  v_exp_f32 v163, v163
  v_exp_f32 v164, v164
  v_exp_f32 v165, v165
  v_exp_f32 v166, v166
  v_mfma_f32_32x32x16_bf16 v[240:255], v[224:227], v[208:211], v[240:255]
  buffer_load_dwordx4 v4, s[16:19], s61 offen offset:1024 lds
  buffer_load_dwordx4 v3, s[16:19], s62 offen offset:2048 lds
  buffer_load_dwordx4 v4, s[16:19], s62 offen offset:3072 lds
  s_waitcnt vmcnt(9)
  ds_read_b128 a[160:163], v5 offset:4096
  ds_read_b128 a[164:167], v6 offset:4096
  ds_read_b128 a[168:171], v7 offset:4096
  ds_read_b128 a[172:175], v8 offset:4096
  v_exp_f32 v167, v167
  v_exp_f32 v168, v168
  v_exp_f32 v169, v169
  v_exp_f32 v170, v170
  v_exp_f32 v171, v171
  v_mfma_f32_32x32x16_bf16 v[240:255], v[228:231], v[212:215], v[240:255]
  s_mov_b64 exec, s[70:71]
  ds_read_b128 v[224:227], v120 offset:10240
  ds_read_b128 v[228:231], v120 offset:11264
  s_mov_b64 exec, -1
  ds_read_b128 v[128:131], v120
  v_exp_f32 v172, v172
  v_exp_f32 v173, v173
  v_exp_f32 v174, v174
  v_exp_f32 v175, v175
  v_cvt_pk_bf16_f32 v216, v160, v161
  v_cvt_pk_bf16_f32 v217, v162, v163
  v_cvt_pk_bf16_f32 v218, v164, v165
  v_cvt_pk_bf16_f32 v219, v166, v167
  v_cvt_pk_bf16_f32 v220, v168, v169
  v_cvt_pk_bf16_f32 v221, v170, v171
  v_cvt_pk_bf16_f32 v222, v172, v173
  v_cvt_pk_bf16_f32 v223, v174, v175
  v_exp_f32 v144, v144
  v_exp_f32 v145, v145
  s_waitcnt lgkmcnt(7)
  v_mfma_f32_32x32x16_bf16 v[160:175], v[140:143], v[112:115], 0
  s_waitcnt lgkmcnt(3)
  s_add_u32 s61, s0, s1
  s_add_u32 s62, s61, 63488
  s_add_u32 m0, s64, 4096
  s_add_u32 s1, s1, 128
  v_exp_f32 v146, v146
  v_exp_f32 v147, v147
  v_exp_f32 v148, v148
  v_exp_f32 v149, v149
  v_exp_f32 v150, v150
  v_mfma_f32_32x32x16_bf16 v[240:255], v[232:235], v[216:219], v[240:255]
  buffer_load_dwordx4 v3, s[16:19], s61 offen lds
  buffer_load_dwordx4 v4, s[16:19], s61 offen offset:1024 lds
  buffer_load_dwordx4 v3, s[16:19], s62 offen offset:2048 lds
  buffer_load_dwordx4 v4, s[16:19], s62 offen offset:3072 lds
  s_and_b32 s1, s1, 2047
  v_exp_f32 v151, v151
  v_exp_f32 v152, v152
  v_exp_f32 v153, v153
  v_exp_f32 v154, v154
  v_exp_f32 v155, v155
  v_mfma_f32_32x32x16_bf16 v[240:255], v[236:239], v[220:223], v[240:255]
  s_mov_b64 exec, s[70:71]
  ds_read_b128 v[232:235], v120 offset:6144
  ds_read_b128 v[236:239], v120 offset:7168
  s_mov_b64 exec, -1
  ds_read_b128 v[132:135], v120 offset:33792
  v_exp_f32 v156, v156
  v_exp_f32 v157, v157
  v_exp_f32 v158, v158
  v_exp_f32 v159, v159
  v_cvt_pk_bf16_f32 v208, v144, v145
  v_cvt_pk_bf16_f32 v209, v146, v147
  v_cvt_pk_bf16_f32 v210, v148, v149
  v_cvt_pk_bf16_f32 v211, v150, v151
  v_cvt_pk_bf16_f32 v212, v152, v153
  v_cvt_pk_bf16_f32 v213, v154, v155
  v_cvt_pk_bf16_f32 v214, v156, v157
  v_cvt_pk_bf16_f32 v215, v158, v159
  v_exp_f32 v160, v160
  v_exp_f32 v161, v161
  s_waitcnt lgkmcnt(3)
  v_mfma_f32_32x32x16_bf16 v[144:159], v[128:131], v[112:115], v[192:207]
  s_waitcnt vmcnt(9)
  ds_read_b128 a[176:179], v5 offset:8192
  v_exp_f32 v162, v162
  v_exp_f32 v163, v163
  v_exp_f32 v164, v164
  v_exp_f32 v165, v165
  v_exp_f32 v166, v166
  v_mfma_f32_32x32x16_bf16 v[240:255], v[224:227], v[208:211], v[240:255]
  ds_read_b128 a[180:183], v6 offset:8192
  ds_read_b128 a[184:187], v7 offset:8192
  ds_read_b128 a[188:191], v8 offset:8192
  v_exp_f32 v167, v167
  v_exp_f32 v168, v168
  v_exp_f32 v169, v169
  v_exp_f32 v170, v170
  v_exp_f32 v171, v171
  v_mfma_f32_32x32x16_bf16 v[240:255], v[228:231], v[212:215], v[240:255]
  s_mov_b64 exec, s[70:71]
  ds_read_b128 v[224:227], v120 offset:2048
  ds_read_b128 v[228:231], v120 offset:3072
  s_mov_b64 exec, -1
  ds_read_b128 v[136:139], v120 offset:29696
  v_exp_f32 v172, v172
  v_exp_f32 v173, v173
  v_exp_f32 v174, v174
  v_exp_f32 v175, v175
  v_cvt_pk_bf16_f32 v216, v160, v161
  v_cvt_pk_bf16_f32 v217, v162, v163
  v_cvt_pk_bf16_f32 v218, v164, v165
  v_cvt_pk_bf16_f32 v219, v166, v167
  v_cvt_pk_bf16_f32 v220, v168, v169
  v_cvt_pk_bf16_f32 v221, v170, v171
  v_cvt_pk_bf16_f32 v222, v172, v173
  v_cvt_pk_bf16_f32 v223, v174, v175
  v_exp_f32 v144, v144
  v_exp_f32 v145, v145
  s_waitcnt lgkmcnt(7)
  v_mfma_f32_32x32x16_bf16 v[160:175], v[132:135], v[116:119], v[176:191]
  s_waitcnt lgkmcnt(3)
  s_add_u32 s61, s0, s1
  s_add_u32 s62, s61, 63488
  s_add_u32 m0, s64, 8192
  s_nop 0
  buffer_load_dwordx4 v3, s[16:19], s61 offen lds
  s_add_u32 s1, s1, 128
  s_and_b32 s1, s1, 2047
  v_exp_f32 v146, v146
  v_exp_f32 v147, v147
  v_exp_f32 v148, v148
  v_exp_f32 v149, v149
  v_exp_f32 v150, v150
  v_mfma_f32_32x32x16_bf16 v[240:255], v[232:235], v[216:219], v[240:255]
  buffer_load_dwordx4 v4, s[16:19], s61 offen offset:1024 lds
  buffer_load_dwordx4 v3, s[16:19], s62 offen offset:2048 lds
  buffer_load_dwordx4 v4, s[16:19], s62 offen offset:3072 lds
  s_waitcnt vmcnt(8)
  ds_read_b128 a[192:195], v5
  ds_read_b128 a[196:199], v6
  ds_read_b128 a[200:203], v7
  ds_read_b128 a[204:207], v8
  v_exp_f32 v151, v151
  v_exp_f32 v152, v152
  v_exp_f32 v153, v153
  v_exp_f32 v154, v154
  v_exp_f32 v155, v155
  v_mfma_f32_32x32x16_bf16 v[240:255], v[236:239], v[220:223], v[240:255]
  s_mov_b64 exec, s[70:71]
  ds_read_b128 v[232:235], v120 offset:35072
  ds_read_b128 v[236:239], v120 offset:36096
  s_mov_b64 exec, -1
  ds_read_b128 v[140:143], v120 offset:25600
  v_exp_f32 v156, v156
  v_exp_f32 v157, v157
  v_exp_f32 v158, v158
  v_exp_f32 v159, v159
  v_cvt_pk_bf16_f32 v208, v144, v145
  v_cvt_pk_bf16_f32 v209, v146, v147
  v_cvt_pk_bf16_f32 v210, v148, v149
  v_cvt_pk_bf16_f32 v211, v150, v151
  v_cvt_pk_bf16_f32 v212, v152, v153
  v_cvt_pk_bf16_f32 v213, v154, v155
  v_cvt_pk_bf16_f32 v214, v156, v157
  v_cvt_pk_bf16_f32 v215, v158, v159
  v_exp_f32 v160, v160
  v_exp_f32 v161, v161
  s_waitcnt lgkmcnt(7)
  v_mfma_f32_32x32x16_bf16 v[144:159], v[136:139], v[116:119], 0
  s_waitcnt lgkmcnt(3)
  s_add_u32 s61, s0, s1
  s_add_u32 s62, s61, 63488
  s_add_u32 m0, s64, 0
  s_nop 0
  buffer_load_dwordx4 v3, s[16:19], s61 offen lds
  s_add_u32 s1, s1, 128
  s_and_b32 s1, s1, 2047
  v_exp_f32 v162, v162
  v_exp_f32 v163, v163
  v_exp_f32 v164, v164
  v_exp_f32 v165, v165
  v_exp_f32 v166, v166
  v_mfma_f32_32x32x16_bf16 v[240:255], v[224:227], v[208:211], v[240:255]
  buffer_load_dwordx4 v4, s[16:19], s61 offen offset:1024 lds
  buffer_load_dwordx4 v3, s[16:19], s62 offen offset:2048 lds
  buffer_load_dwordx4 v4, s[16:19], s62 offen offset:3072 lds
  s_waitcnt vmcnt(8)
  ds_read_b128 a[208:211], v5 offset:4096
  ds_read_b128 a[212:215], v6 offset:4096
  ds_read_b128 a[216:219], v7 offset:4096
  ds_read_b128 a[220:223], v8 offset:4096
  v_exp_f32 v167, v167
  v_exp_f32 v168, v168
  v_exp_f32 v169, v169
  v_exp_f32 v170, v170
  v_exp_f32 v171, v171
  v_mfma_f32_32x32x16_bf16 v[240:255], v[228:231], v[212:215], v[240:255]
  s_mov_b64 exec, s[70:71]
  ds_read_b128 v[224:227], v120 offset:30976
  ds_read_b128 v[228:231], v120 offset:32000
  s_mov_b64 exec, -1
  ds_read_b128 v[128:131], v120 offset:21504
  v_exp_f32 v172, v172
  v_exp_f32 v173, v173
  v_exp_f32 v174, v174
  v_exp_f32 v175, v175
  v_cvt_pk_bf16_f32 v216, v160, v161
  v_cvt_pk_bf16_f32 v217, v162, v163
  v_cvt_pk_bf16_f32 v218, v164, v165
  v_cvt_pk_bf16_f32 v219, v166, v167
  v_cvt_pk_bf16_f32 v220, v168, v169
  v_cvt_pk_bf16_f32 v221, v170, v171
  v_cvt_pk_bf16_f32 v222, v172, v173
  v_cvt_pk_bf16_f32 v223, v174, v175
  v_exp_f32 v144, v144
  v_exp_f32 v145, v145
  s_waitcnt lgkmcnt(7)
  v_mfma_f32_32x32x16_bf16 v[160:175], v[140:143], v[116:119], 0
  s_lshl_b32 s66, s43, 12
  s_xor_b32 s77, s41, 1
  s_lshl_b32 s77, s77, 18
  s_lshl_b32 s78, s42, 16
  s_add_u32 s77, s77, s78
  s_add_u32 s77, s77, s66
  s_add_u32 s60, s77, 6291456
  s_xor_b32 s73, s60, 262144
  v_add_u32 v2, 131072, v0
  s_and_b32 s77, s40, 3
  s_lshl_b32 s69, s77, 14
  v_bfe_u32 v124, v0, 7, 1
  v_xor_b32 v124, s41, v124
  v_and_b32 v125, 0x70, v0
  v_exp_f32 v146, v146
  v_exp_f32 v147, v147
  v_exp_f32 v148, v148
  v_exp_f32 v149, v149
  v_exp_f32 v150, v150
  v_mfma_f32_32x32x16_bf16 v[16:31], v[232:235], v[216:219], 0
  v_add_u32 v124, v124, v125
  v_lshlrev_b32 v124, 8, v124
  s_lshl_b32 s77, s42, 15
  s_add_u32 s77, s77, 69632
  v_add_u32 v124, s77, v124
  v_exp_f32 v151, v151
  v_exp_f32 v152, v152
  v_exp_f32 v153, v153
  v_exp_f32 v154, v154
  v_exp_f32 v155, v155
  v_mfma_f32_32x32x16_bf16 v[16:31], v[236:239], v[220:223], v[16:31]
  buffer_load_dword v123, v124, s[36:39], 0 offen sc1
  s_mov_b64 exec, s[70:71]
  ds_read_b128 v[232:235], v120 offset:26880
  ds_read_b128 v[236:239], v120 offset:27904
  s_mov_b64 exec, -1
  ds_read_b128 v[132:135], v120 offset:17408
  v_exp_f32 v156, v156
  v_exp_f32 v157, v157
  v_exp_f32 v158, v158
  v_exp_f32 v159, v159
  v_cvt_pk_bf16_f32 v208, v144, v145
  v_cvt_pk_bf16_f32 v209, v146, v147
  v_cvt_pk_bf16_f32 v210, v148, v149
  v_cvt_pk_bf16_f32 v211, v150, v151
  v_cvt_pk_bf16_f32 v212, v152, v153
  v_cvt_pk_bf16_f32 v213, v154, v155
  v_cvt_pk_bf16_f32 v214, v156, v157
  v_cvt_pk_bf16_f32 v215, v158, v159
  v_max3_f32 v122, |v240|, |v241|, |v242|
  v_max3_f32 v122, v122, |v243|, |v244|
  v_max3_f32 v122, v122, |v245|, |v246|
  v_max3_f32 v122, v122, |v247|, |v247|
  v_cmp_nge_f32 vcc, 0x5d800000, v248
  s_nop 1
  s_mov_b64 s[86:87], vcc
  v_cmp_nle_f32 vcc, 0x21800000, v248
  s_nop 1
  s_or_b64 s[86:87], s[86:87], vcc
  v_cmp_nge_f32 vcc, 0x7e800000, v122
  s_nop 1
  s_or_b64 s[86:87], s[86:87], vcc
  v_rcp_f32 v121, v248
  s_nop 0
  v_mul_f32 v240, v240, v121
  v_mul_f32 v241, v241, v121
  v_mul_f32 v242, v242, v121
  v_mul_f32 v243, v243, v121
  v_mul_f32 v244, v244, v121
  v_mul_f32 v245, v245, v121
  v_mul_f32 v246, v246, v121
  v_mul_f32 v247, v247, v121
  v_cvt_pk_bf16_f32 v48, v240, v241
  v_cvt_pk_bf16_f32 v49, v242, v243
  v_cvt_pk_bf16_f32 v50, v244, v245
  v_cvt_pk_bf16_f32 v51, v246, v247
  v_exp_f32 v160, v160
  v_exp_f32 v161, v161
  s_waitcnt lgkmcnt(3)
  v_mfma_f32_32x32x16_bf16 v[144:159], v[128:131], v[116:119], 0
  s_waitcnt vmcnt(5)
  ds_read_b128 a[224:227], v5 offset:8192
  v_exp_f32 v162, v162
  v_exp_f32 v163, v163
  v_exp_f32 v164, v164
  v_exp_f32 v165, v165
  v_exp_f32 v166, v166
  v_mfma_f32_32x32x16_bf16 v[16:31], v[224:227], v[208:211], v[16:31]
  ds_read_b128 a[228:231], v6 offset:8192
  ds_read_b128 a[232:235], v7 offset:8192
  ds_read_b128 a[236:239], v8 offset:8192
  v_exp_f32 v167, v167
  v_exp_f32 v168, v168
  v_exp_f32 v169, v169
  v_exp_f32 v170, v170
  v_exp_f32 v171, v171
  v_mfma_f32_32x32x16_bf16 v[16:31], v[228:231], v[212:215], v[16:31]
  s_mov_b64 exec, s[70:71]
  ds_read_b128 v[224:227], v120 offset:22784
  ds_read_b128 v[228:231], v120 offset:23808
  s_mov_b64 exec, -1
  ds_read_b128 v[136:139], v120 offset:13312
  v_exp_f32 v172, v172
  v_exp_f32 v173, v173
  v_exp_f32 v174, v174
  v_exp_f32 v175, v175
  v_cvt_pk_bf16_f32 v216, v160, v161
  v_cvt_pk_bf16_f32 v217, v162, v163
  v_cvt_pk_bf16_f32 v218, v164, v165
  v_cvt_pk_bf16_f32 v219, v166, v167
  v_cvt_pk_bf16_f32 v220, v168, v169
  v_cvt_pk_bf16_f32 v221, v170, v171
  v_cvt_pk_bf16_f32 v222, v172, v173
  v_cvt_pk_bf16_f32 v223, v174, v175
  v_exp_f32 v144, v144
  v_exp_f32 v145, v145
  s_waitcnt lgkmcnt(7)
  v_mfma_f32_32x32x16_bf16 v[160:175], v[132:135], v[116:119], 0
  s_waitcnt vmcnt(1)
  ds_read_b128 a[240:243], v5
  v_exp_f32 v146, v146
  v_exp_f32 v147, v147
  v_exp_f32 v148, v148
  v_exp_f32 v149, v149
  v_exp_f32 v150, v150
  v_mfma_f32_32x32x16_bf16 v[16:31], v[232:235], v[216:219], v[16:31]
  ds_read_b128 a[244:247], v6
  ds_read_b128 a[248:251], v7
  ds_read_b128 a[252:255], v8
  v_exp_f32 v151, v151
  v_exp_f32 v152, v152
  v_exp_f32 v153, v153
  v_exp_f32 v154, v154
  v_exp_f32 v155, v155
  v_mfma_f32_32x32x16_bf16 v[16:31], v[236:239], v[220:223], v[16:31]
  s_mov_b64 exec, s[70:71]
  ds_read_b128 v[232:235], v120 offset:18688
  ds_read_b128 v[236:239], v120 offset:19712
  s_mov_b64 exec, -1
  ds_read_b128 v[140:143], v120 offset:9216
  v_exp_f32 v156, v156
  v_exp_f32 v157, v157
  v_exp_f32 v158, v158
  v_exp_f32 v159, v159
  v_cvt_pk_bf16_f32 v208, v144, v145
  v_cvt_pk_bf16_f32 v209, v146, v147
  v_cvt_pk_bf16_f32 v210, v148, v149
  v_cvt_pk_bf16_f32 v211, v150, v151
  v_cvt_pk_bf16_f32 v212, v152, v153
  v_cvt_pk_bf16_f32 v213, v154, v155
  v_cvt_pk_bf16_f32 v214, v156, v157
  v_cvt_pk_bf16_f32 v215, v158, v159
  v_exp_f32 v160, v160
  v_exp_f32 v161, v161
  s_waitcnt lgkmcnt(7)
  v_mfma_f32_32x32x16_bf16 v[144:159], v[136:139], v[116:119], 0
  s_waitcnt vmcnt(0)
  v_cmp_ne_u32 s[74:75], s44, v123
  s_nop 1
  s_cmp_lg_u64 s[74:75], 0
  s_cbranch_scc1 L_slow_10
L_back_11:
  s_add_u32 m0, s66, 98304
  s_add_u32 s65, s69, 0
  s_and_b32 s65, s65, 0xffff
  v_exp_f32 v162, v162
  v_exp_f32 v163, v163
  v_exp_f32 v164, v164
  v_exp_f32 v165, v165
  v_exp_f32 v166, v166
  v_mfma_f32_32x32x16_bf16 v[16:31], v[224:227], v[208:211], v[16:31]
  s_add_u32 s65, s65, s60
  buffer_load_dwordx4 v0, s[36:39], s65 offen sc1 lds
  buffer_load_dwordx4 v0, s[36:39], s65 offen offset:1024 sc1 lds
  buffer_load_dwordx4 v0, s[36:39], s65 offen offset:2048 sc1 lds
  buffer_load_dwordx4 v0, s[36:39], s65 offen offset:3072 sc1 lds
  v_exp_f32 v167, v167
  v_exp_f32 v168, v168
  v_exp_f32 v169, v169
  v_exp_f32 v170, v170
  v_exp_f32 v171, v171
  v_mfma_f32_32x32x16_bf16 v[16:31], v[228:231], v[212:215], v[16:31]
  s_mov_b64 exec, s[70:71]
  ds_read_b128 v[224:227], v120 offset:14592
  ds_read_b128 v[228:231], v120 offset:15616
  s_mov_b64 exec, -1
  ds_read_b128 v[128:131], v120 offset:5120
  v_exp_f32 v172, v172
  v_exp_f32 v173, v173
  v_exp_f32 v174, v174
  v_exp_f32 v175, v175
  v_cvt_pk_bf16_f32 v216, v160, v161
  v_cvt_pk_bf16_f32 v217, v162, v163
  v_cvt_pk_bf16_f32 v218, v164, v165
  v_cvt_pk_bf16_f32 v219, v166, v167
  v_cvt_pk_bf16_f32 v220, v168, v169
  v_cvt_pk_bf16_f32 v221, v170, v171
  v_cvt_pk_bf16_f32 v222, v172, v173
  v_cvt_pk_bf16_f32 v223, v174, v175
  v_exp_f32 v144, v144
  v_exp_f32 v145, v145
  s_waitcnt lgkmcnt(3)
  v_mfma_f32_32x32x16_bf16 v[160:175], v[140:143], v[116:119], 0
  s_add_u32 m0, s66, 114688
  s_add_u32 s65, s69, 16384
  s_and_b32 s65, s65, 0xffff
  s_add_u32 s65, s65, s60
  v_exp_f32 v146, v146
  v_exp_f32 v147, v147
  v_exp_f32 v148, v148
  v_exp_f32 v149, v149
  v_exp_f32 v150, v150
  v_mfma_f32_32x32x16_bf16 v[16:31], v[232:235], v[216:219], v[16:31]
  buffer_load_dwordx4 v0, s[36:39], s65 offen sc1 lds
  buffer_load_dwordx4 v0, s[36:39], s65 offen offset:1024 sc1 lds
  buffer_load_dwordx4 v0, s[36:39], s65 offen offset:2048 sc1 lds
  buffer_load_dwordx4 v0, s[36:39], s65 offen offset:3072 sc1 lds
  v_exp_f32 v151, v151
  v_exp_f32 v152, v152
  v_exp_f32 v153, v153
  v_exp_f32 v154, v154
  v_exp_f32 v155, v155
  v_mfma_f32_32x32x16_bf16 v[16:31], v[236:239], v[220:223], v[16:31]
  s_mov_b64 exec, s[70:71]
  ds_read_b128 v[232:235], v120 offset:10496
  ds_read_b128 v[236:239], v120 offset:11520
  s_mov_b64 exec, -1
  ds_read_b128 v[132:135], v120 offset:1024
  v_exp_f32 v156, v156
  v_exp_f32 v157, v157
  v_exp_f32 v158, v158
  v_exp_f32 v159, v159
  v_cvt_pk_bf16_f32 v208, v144, v145
  v_cvt_pk_bf16_f32 v209, v146, v147
  v_cvt_pk_bf16_f32 v210, v148, v149
  v_cvt_pk_bf16_f32 v211, v150, v151
  v_cvt_pk_bf16_f32 v212, v152, v153
  v_cvt_pk_bf16_f32 v213, v154, v155
  v_cvt_pk_bf16_f32 v214, v156, v157
  v_cvt_pk_bf16_f32 v215, v158, v159
  v_exp_f32 v160, v160
  v_exp_f32 v161, v161
  s_waitcnt lgkmcnt(3)
  v_mfma_f32_32x32x16_bf16 v[144:159], v[128:131], v[116:119], 0
  s_add_u32 m0, s66, 131072
  s_add_u32 s65, s69, 32768
  s_and_b32 s65, s65, 0xffff
  s_add_u32 s65, s65, s60
  v_exp_f32 v162, v162
  v_exp_f32 v163, v163
  v_exp_f32 v164, v164
  v_exp_f32 v165, v165
  v_exp_f32 v166, v166
  v_mfma_f32_32x32x16_bf16 v[16:31], v[224:227], v[208:211], v[16:31]
  buffer_load_dwordx4 v0, s[36:39], s65 offen sc1 lds
  buffer_load_dwordx4 v0, s[36:39], s65 offen offset:1024 sc1 lds
  buffer_load_dwordx4 v0, s[36:39], s65 offen offset:2048 sc1 lds
  buffer_load_dwordx4 v0, s[36:39], s65 offen offset:3072 sc1 lds
  v_exp_f32 v167, v167
  v_exp_f32 v168, v168
  v_exp_f32 v169, v169
  v_exp_f32 v170, v170
  v_exp_f32 v171, v171
  v_mfma_f32_32x32x16_bf16 v[16:31], v[228:231], v[212:215], v[16:31]
  s_mov_b64 exec, s[70:71]
  ds_read_b128 v[224:227], v120 offset:6400
  ds_read_b128 v[228:231], v120 offset:7424
  s_mov_b64 exec, -1
  v_exp_f32 v172, v172
  v_exp_f32 v173, v173
  v_exp_f32 v174, v174
  v_exp_f32 v175, v175
  v_cvt_pk_bf16_f32 v216, v160, v161
  v_cvt_pk_bf16_f32 v217, v162, v163
  v_cvt_pk_bf16_f32 v218, v164, v165
  v_cvt_pk_bf16_f32 v219, v166, v167
  v_cvt_pk_bf16_f32 v220, v168, v169
  v_cvt_pk_bf16_f32 v221, v170, v171
  v_cvt_pk_bf16_f32 v222, v172, v173
  v_cvt_pk_bf16_f32 v223, v174, v175
  v_exp_f32 v144, v144
  v_exp_f32 v145, v145
  s_waitcnt lgkmcnt(2)
  v_mfma_f32_32x32x16_bf16 v[160:175], v[132:135], v[116:119], v[192:207]
  s_add_u32 m0, s66, 147456
  s_add_u32 s65, s69, 49152
  s_and_b32 s65, s65, 0xffff
  s_add_u32 s65, s65, s60
  v_exp_f32 v146, v146
  v_exp_f32 v147, v147
  v_exp_f32 v148, v148
  v_exp_f32 v149, v149
  v_exp_f32 v150, v150
  v_mfma_f32_32x32x16_bf16 v[16:31], v[232:235], v[216:219], v[16:31]
  buffer_load_dwordx4 v0, s[36:39], s65 offen sc1 lds
  buffer_load_dwordx4 v0, s[36:39], s65 offen offset:1024 sc1 lds
  buffer_load_dwordx4 v0, s[36:39], s65 offen offset:2048 sc1 lds
  buffer_load_dwordx4 v0, s[36:39], s65 offen offset:3072 sc1 lds
  v_exp_f32 v151, v151
  v_exp_f32 v152, v152
  v_exp_f32 v153, v153
  v_exp_f32 v154, v154
  v_exp_f32 v155, v155
  v_mfma_f32_32x32x16_bf16 v[16:31], v[236:239], v[220:223], v[16:31]
  s_mov_b64 exec, s[70:71]
  ds_read_b128 v[232:235], v120 offset:2304
  ds_read_b128 v[236:239], v120 offset:3328
  s_mov_b64 exec, -1
  v_exp_f32 v156, v156
  v_exp_f32 v157, v157
  v_exp_f32 v158, v158
  v_exp_f32 v159, v159
  v_cvt_pk_bf16_f32 v208, v144, v145
  v_cvt_pk_bf16_f32 v209, v146, v147
  v_cvt_pk_bf16_f32 v210, v148, v149
  v_cvt_pk_bf16_f32 v211, v150, v151
  v_cvt_pk_bf16_f32 v212, v152, v153
  v_cvt_pk_bf16_f32 v213, v154, v155
  v_cvt_pk_bf16_f32 v214, v156, v157
  v_cvt_pk_bf16_f32 v215, v158, v159
  v_exp_f32 v160, v160
  v_exp_f32 v161, v161
  v_exp_f32 v162, v162
  v_exp_f32 v163, v163
  v_exp_f32 v164, v164
  v_exp_f32 v165, v165
  v_exp_f32 v166, v166
  s_waitcnt lgkmcnt(2)
  v_mfma_f32_32x32x16_bf16 v[16:31], v[224:227], v[208:211], v[16:31]
  v_exp_f32 v167, v167
  v_exp_f32 v168, v168
  v_exp_f32 v169, v169
  v_exp_f32 v170, v170
  v_exp_f32 v171, v171
  v_mfma_f32_32x32x16_bf16 v[16:31], v[228:231], v[212:215], v[16:31]
  v_exp_f32 v172, v172
  v_exp_f32 v173, v173
  v_exp_f32 v174, v174
  v_exp_f32 v175, v175
  v_cvt_pk_bf16_f32 v216, v160, v161
  v_cvt_pk_bf16_f32 v217, v162, v163
  v_cvt_pk_bf16_f32 v218, v164, v165
  v_cvt_pk_bf16_f32 v219, v166, v167
  v_cvt_pk_bf16_f32 v220, v168, v169
  v_cvt_pk_bf16_f32 v221, v170, v171
  v_cvt_pk_bf16_f32 v222, v172, v173
  v_cvt_pk_bf16_f32 v223, v174, v175
  s_waitcnt lgkmcnt(0)
  v_mfma_f32_32x32x16_bf16 v[16:31], v[232:235], v[216:219], v[16:31]
  v_mfma_f32_32x32x16_bf16 v[16:31], v[236:239], v[220:223], v[16:31]
  s_lshl_b32 s79, s46, 4
  s_add_u32 s79, s79, s45
  s_lshl_b32 s79, s79, 11
  s_add_u32 s79, s79, 18874368
  s_nop 7
  v_max3_f32 v122, |v16|, |v17|, |v18|
  v_max3_f32 v122, v122, |v19|, |v20|
  v_max3_f32 v122, v122, |v21|, |v22|
  v_max3_f32 v122, v122, |v23|, |v23|
  v_cmp_nge_f32 vcc, 0x5d800000, v24
  s_nop 1
  s_or_b64 s[86:87], s[86:87], vcc
  v_cmp_nle_f32 vcc, 0x21800000, v24
  s_nop 1
  s_or_b64 s[86:87], s[86:87], vcc
  v_cmp_nge_f32 vcc, 0x7e800000, v122
  s_nop 1
  s_or_b64 s[86:87], s[86:87], vcc
  v_rcp_f32 v121, v24
  s_nop 0
  v_mul_f32 v16, v16, v121
  v_mul_f32 v17, v17, v121
  v_mul_f32 v18, v18, v121
  v_mul_f32 v19, v19, v121
  v_mul_f32 v20, v20, v121
  v_mul_f32 v21, v21, v121
  v_mul_f32 v22, v22, v121
  v_mul_f32 v23, v23, v121
  v_cvt_pk_bf16_f32 v52, v16, v17
  v_cvt_pk_bf16_f32 v53, v18, v19
  v_cvt_pk_bf16_f32 v54, v20, v21
  v_cvt_pk_bf16_f32 v55, v22, v23
  s_cmp_eq_u64 s[86:87], 0
  s_cbranch_scc1 L_ok_13
  s_call_b64 s[84:85], L_attslow
L_ok_13:
  buffer_store_dwordx4 v[48:51], v0, s[36:39], s79 offen sc1
  buffer_store_dwordx4 v[52:55], v0, s[36:39], s79 offen offset:1024 sc1
L_p2:
  v_add_u32 v240, 65536, v0
  v_bfe_u32 v16, v0, 4, 5
  v_lshlrev_b32 v16, 1, v16
  s_lshl_b32 s77, s46, 6
  buffer_load_ushort v244, v16, s[28:31], s77 offen
  s_waitcnt vmcnt(11)
  s_waitcnt lgkmcnt(0)
  s_barrier
  ds_read_b128 v[128:131], v240 offset:32768
  ds_read_b128 v[132:135], v240 offset:33792
  ds_read_b128 v[136:139], v240 offset:34816
  ds_read_b128 v[140:143], v240 offset:35840
  ds_read_b128 v[144:147], v240 offset:36864
  ds_read_b128 v[148:151], v240 offset:37888
  ds_read_b128 v[152:155], v240 offset:38912
  ds_read_b128 v[156:159], v240 offset:39936
  s_waitcnt lgkmcnt(4)
  v_mfma_f32_32x32x16_bf16 v[160:175], v[128:131], a[0:3], 0
  ds_read_b128 v[128:131], v240 offset:40960
  s_add_u32 s56, s3, 4
  s_and_b32 s56, s56, 7
  s_lshl_b32 s56, s56, 7
  s_lshr_b32 s68, s43, 1
  s_and_b32 s77, s43, 1
  s_lshl_b32 s78, s42, 1
  s_add_u32 s77, s77, s78
  s_lshl_b32 s78, s40, 2
  s_add_u32 s67, s77, s78
  v_mfma_f32_32x32x16_bf16 v[160:175], v[132:135], a[4:7], v[160:175]
  ds_read_b128 v[132:135], v240 offset:41984
  v_mfma_f32_32x32x16_bf16 v[160:175], v[136:139], a[8:11], v[160:175]
  ds_read_b128 v[136:139], v240 offset:43008
  v_mul_f32 v32, v80, v80
  v_mul_f32 v33, v81, v81
  v_mul_f32 v34, v82, v82
  v_mul_f32 v35, v83, v83
  v_fma_f32 v32, v32, v11, v12
  v_mfma_f32_32x32x16_bf16 v[160:175], v[140:143], a[12:15], v[160:175]
  ds_read_b128 v[140:143], v240 offset:44032
  s_add_u32 s77, s40, s3
  s_and_b32 s77, s77, 3
  s_lshl_b32 s80, s77, 16
  s_lshl_b32 s81, s77, 12
  s_and_b32 s77, s40, 3
  s_lshl_b32 s77, s77, 1
  s_add_u32 s77, s77, s3
  s_sub_u32 s78, s77, 7
  s_cmp_ge_u32 s77, 7
  s_cselect_b32 s77, s78, s77
  s_lshl_b32 s82, s77, 16
  s_lshl_b32 s83, s77, 12
  s_waitcnt lgkmcnt(4)
  v_mfma_f32_32x32x16_bf16 v[160:175], v[144:147], a[16:19], v[160:175]
  ds_read_b128 v[144:147], v240 offset:45056
  v_bfe_u32 v16, v0, 6, 3
  v_mfma_f32_32x32x16_bf16 v[160:175], v[148:151], a[20:23], v[160:175]
  ds_read_b128 v[148:151], v240 offset:46080
  v_lshlrev_b32 v16, 10, v16
  v_and_b32 v17, 48, v0
  v_or_b32 v16, v16, v17
  v_lshrrev_b32 v17, 9, v0
  v_lshl_add_u32 v16, v17, 6, v16
  v_mfma_f32_32x32x16_bf16 v[160:175], v[152:155], a[24:27], v[160:175]
  ds_read_b128 v[152:155], v240 offset:47104
  s_and_b32 s77, s43, 1
  s_lshl_b32 s77, s77, 15
  s_add_u32 s77, s77, s56
  v_add_u32 v16, s77, v16
  v_mfma_f32_32x32x16_bf16 v[160:175], v[156:159], a[28:31], v[160:175]
  ds_read_b128 v[156:159], v240 offset:48128
  s_mul_i32 s77, s68, 458752
  v_add_u32 v8, s77, v16
  s_lshl_b32 s77, s68, 18
  v_add_u32 v7, s77, v16
  s_waitcnt lgkmcnt(4)
  v_mfma_f32_32x32x16_bf16 v[160:175], v[128:131], a[32:35], v[160:175]
  ds_read_b128 v[128:131], v240 offset:49152
  v_bfe_u32 v16, v0, 6, 2
  v_lshl_add_u32 v16, v17, 2, v16
  v_lshlrev_b32 v16, 6, v16
  v_bfe_u32 v18, v0, 8, 1
  v_lshl_add_u32 v16, v18, 5, v16
  v_mfma_f32_32x32x16_bf16 v[160:175], v[132:135], a[36:39], v[160:175]
  ds_read_b128 v[132:135], v240 offset:50176
  v_bfe_u32 v18, v0, 4, 2
  v_lshl_add_u32 v16, v18, 3, v16
  s_lshl_b32 s77, s68, 13
  v_add_u32 v5, s77, v16
  s_add_u32 m0, s66, 0
  v_mfma_f32_32x32x16_bf16 v[160:175], v[136:139], a[40:43], v[160:175]
  ds_read_b128 v[136:139], v240 offset:51200
  s_add_u32 s65, s69, 0
  s_and_b32 s65, s65, 0xffff
  s_add_u32 s65, s65, s60
  v_mfma_f32_32x32x16_bf16 v[160:175], v[140:143], a[44:47], v[160:175]
  buffer_load_dwordx4 v2, s[36:39], s65 offen sc1 lds
  ds_read_b128 v[140:143], v240 offset:52224
  s_waitcnt lgkmcnt(4)
  v_mfma_f32_32x32x16_bf16 v[160:175], v[144:147], a[48:51], v[160:175]
  buffer_load_dwordx4 v2, s[36:39], s65 offen offset:1024 sc1 lds
  ds_read_b128 v[144:147], v240 offset:53248
  v_mfma_f32_32x32x16_bf16 v[160:175], v[148:151], a[52:55], v[160:175]
  buffer_load_dwordx4 v2, s[36:39], s65 offen offset:2048 sc1 lds
  ds_read_b128 v[148:151], v240 offset:54272
  v_mfma_f32_32x32x16_bf16 v[160:175], v[152:155], a[56:59], v[160:175]
  buffer_load_dwordx4 v2, s[36:39], s65 offen offset:3072 sc1 lds
  ds_read_b128 v[152:155], v240 offset:55296
  v_mfma_f32_32x32x16_bf16 v[160:175], v[156:159], a[60:63], v[160:175]
  ds_read_b128 v[156:159], v240 offset:56320
  s_add_u32 m0, s66, 16384
  s_add_u32 s65, s69, 16384
  s_waitcnt lgkmcnt(4)
  v_mfma_f32_32x32x16_bf16 v[160:175], v[128:131], a[64:67], v[160:175]
  s_and_b32 s65, s65, 0xffff
  s_add_u32 s65, s65, s60
  buffer_load_dwordx4 v2, s[36:39], s65 offen sc1 lds
  ds_read_b128 v[128:131], v240 offset:57344
  v_mfma_f32_32x32x16_bf16 v[160:175], v[132:135], a[68:71], v[160:175]
  buffer_load_dwordx4 v2, s[36:39], s65 offen offset:1024 sc1 lds
  ds_read_b128 v[132:135], v240 offset:58368
  v_mfma_f32_32x32x16_bf16 v[160:175], v[136:139], a[72:75], v[160:175]
  ds_read_b128 v[136:139], v240 offset:59392
  v_mfma_f32_32x32x16_bf16 v[160:175], v[140:143], a[76:79], v[160:175]
  buffer_load_dwordx4 v2, s[36:39], s65 offen offset:2048 sc1 lds
  ds_read_b128 v[140:143], v240 offset:60416
  s_waitcnt lgkmcnt(4)
  v_mfma_f32_32x32x16_bf16 v[160:175], v[144:147], a[80:83], v[160:175]
  buffer_load_dwordx4 v2, s[36:39], s65 offen offset:3072 sc1 lds
  ds_read_b128 v[144:147], v240 offset:61440
  s_add_u32 m0, s66, 32768
  v_mfma_f32_32x32x16_bf16 v[160:175], v[148:151], a[84:87], v[160:175]
  ds_read_b128 v[148:151], v240 offset:62464
  v_add_u32 v6, s82, v8
  s_add_u32 s82, s82, 65536
  s_cmp_eq_u32 s82, 458752
  s_cselect_b32 s82, 0, s82
  v_mfma_f32_32x32x16_bf16 v[160:175], v[152:155], a[88:91], v[160:175]
  buffer_load_dwordx4 v6, s[24:27], 0 offen lds
  ds_read_b128 v[152:155], v240 offset:63488
  v_mfma_f32_32x32x16_bf16 v[160:175], v[156:159], a[92:95], v[160:175]
  buffer_load_dwordx4 v6, s[24:27], s57 offen offset:1024 lds
  ds_read_b128 v[156:159], v240 offset:64512
  s_waitcnt lgkmcnt(4)
  v_mfma_f32_32x32x16_bf16 v[160:175], v[128:131], a[96:99], v[160:175]
  buffer_load_dwordx4 v6, s[24:27], s58 offen offset:2048 lds
  v_mfma_f32_32x32x16_bf16 v[160:175], v[132:135], a[100:103], v[160:175]
  buffer_load_dwordx4 v6, s[24:27], s59 offen offset:3072 lds
  v_mfma_f32_32x32x16_bf16 v[160:175], v[136:139], a[104:107], v[160:175]
  s_waitcnt vmcnt(15) lgkmcnt(0)
  s_barrier
  v_add_u32 v240, 0x10000, v240
  ds_read_b128 v[128:131], v240
  ds_read_b128 v[132:135], v240 offset:1024
  ds_read_b128 v[136:139], v240 offset:2048
  v_mfma_f32_32x32x16_bf16 v[160:175], v[140:143], a[108:111], v[160:175]
  ds_read_b128 v[140:143], v240 offset:3072
  s_add_u32 m0, s66, 49152
  s_add_u32 s65, s69, 32768
  v_mfma_f32_32x32x16_bf16 v[160:175], v[144:147], a[112:115], v[160:175]
  ds_read_b128 v[144:147], v240 offset:4096
  s_and_b32 s65, s65, 0xffff
  s_add_u32 s65, s65, s60
  v_mfma_f32_32x32x16_bf16 v[160:175], v[148:151], a[116:119], v[160:175]
  buffer_load_dwordx4 v2, s[36:39], s65 offen sc1 lds
  ds_read_b128 v[148:151], v240 offset:5120
  v_mfma_f32_32x32x16_bf16 v[160:175], v[152:155], a[120:123], v[160:175]
  ds_read_b128 v[152:155], v240 offset:6144
  v_fma_f32 v33, v33, v11, v12
  v_fma_f32 v34, v34, v11, v12
  v_fma_f32 v35, v35, v11, v12
  v_mul_f32 v32, v32, v80
  v_mfma_f32_32x32x16_bf16 v[160:175], v[156:159], a[124:127], v[160:175]
  ds_read_b128 v[156:159], v240 offset:7168
  v_mul_f32 v33, v33, v81
  v_mul_f32 v34, v34, v82
  v_mul_f32 v35, v35, v83
  v_exp_f32 v32, v32
  s_waitcnt lgkmcnt(4)
  v_mfma_f32_32x32x16_bf16 v[160:175], v[128:131], a[128:131], v[160:175]
  buffer_load_dwordx4 v2, s[36:39], s65 offen offset:1024 sc1 lds
  ds_read_b128 v[128:131], v240 offset:8192
  v_mfma_f32_32x32x16_bf16 v[160:175], v[132:135], a[132:135], v[160:175]
  ds_read_b128 v[132:135], v240 offset:9216
  v_exp_f32 v33, v33
  v_exp_f32 v34, v34
  v_mfma_f32_32x32x16_bf16 v[160:175], v[136:139], a[136:139], v[160:175]
  buffer_load_dwordx4 v2, s[36:39], s65 offen offset:2048 sc1 lds
  ds_read_b128 v[136:139], v240 offset:10240
  v_mfma_f32_32x32x16_bf16 v[160:175], v[140:143], a[140:143], v[160:175]
  ds_read_b128 v[140:143], v240 offset:11264
  v_exp_f32 v35, v35
  v_fma_f32 v32, v32, v13, v13
  s_waitcnt lgkmcnt(4)
  v_mfma_f32_32x32x16_bf16 v[160:175], v[144:147], a[144:147], v[160:175]
  buffer_load_dwordx4 v2, s[36:39], s65 offen offset:3072 sc1 lds
  ds_read_b128 v[144:147], v240 offset:12288
  v_mfma_f32_32x32x16_bf16 v[160:175], v[148:151], a[148:151], v[160:175]
  ds_read_b128 v[148:151], v240 offset:13312
  v_fma_f32 v33, v33, v13, v13
  v_fma_f32 v34, v34, v13, v13
  v_fma_f32 v35, v35, v13, v13
  s_add_u32 m0, s66, 65536
  v_mfma_f32_32x32x16_bf16 v[160:175], v[152:155], a[152:155], v[160:175]
  ds_read_b128 v[152:155], v240 offset:14336
  v_rcp_f32 v32, v32
  s_add_u32 s65, s69, 49152
  s_and_b32 s65, s65, 0xffff
  s_add_u32 s65, s65, s60
  v_mfma_f32_32x32x16_bf16 v[160:175], v[156:159], a[156:159], v[160:175]
  ds_read_b128 v[156:159], v240 offset:15360
  v_rcp_f32 v33, v33
  v_rcp_f32 v34, v34
  s_waitcnt lgkmcnt(4)
  v_mfma_f32_32x32x16_bf16 v[160:175], v[128:131], a[160:163], v[160:175]
  buffer_load_dwordx4 v2, s[36:39], s65 offen sc1 lds
  ds_read_b128 v[128:131], v240 offset:16384
  v_mfma_f32_32x32x16_bf16 v[160:175], v[132:135], a[164:167], v[160:175]
  ds_read_b128 v[132:135], v240 offset:17408
  s_lshl_b32 s78, s40, 4
  s_add_u32 s78, s78, s41
  s_lshl_b32 s78, s78, 2
  s_add_u32 s78, s78, s43
  v_rcp_f32 v35, v35
  v_mul_f32 v80, v80, v32
  v_mul_f32 v81, v81, v33
  v_mfma_f32_32x32x16_bf16 v[160:175], v[136:139], a[168:171], v[160:175]
  buffer_load_dwordx4 v2, s[36:39], s65 offen offset:1024 sc1 lds
  ds_read_b128 v[136:139], v240 offset:18432
  v_mfma_f32_32x32x16_bf16 v[160:175], v[140:143], a[172:175], v[160:175]
  ds_read_b128 v[140:143], v240 offset:19456
  s_lshl_b32 s61, s78, 13
  s_add_u32 s61, s61, 10485760
  s_add_u32 s62, s61, 4096
  v_mul_f32 v82, v82, v34
  v_mul_f32 v83, v83, v35
  v_mul_f32 v32, v84, v84
  v_mul_f32 v33, v85, v85
  s_waitcnt lgkmcnt(4)
  v_mfma_f32_32x32x16_bf16 v[160:175], v[144:147], a[176:179], v[160:175]
  buffer_load_dwordx4 v2, s[36:39], s65 offen offset:2048 sc1 lds
  ds_read_b128 v[144:147], v240 offset:20480
  v_mfma_f32_32x32x16_bf16 v[160:175], v[148:151], a[180:183], v[160:175]
  ds_read_b128 v[148:151], v240 offset:21504
  s_xor_b32 s72, s61, 32768
  s_xor_b32 s87, s62, 32768
  v_mul_f32 v34, v86, v86
  v_mul_f32 v35, v87, v87
  v_fma_f32 v32, v32, v11, v12
  v_fma_f32 v33, v33, v11, v12
  v_mfma_f32_32x32x16_bf16 v[160:175], v[152:155], a[184:187], v[160:175]
  buffer_load_dwordx4 v2, s[36:39], s65 offen offset:3072 sc1 lds
  ds_read_b128 v[152:155], v240 offset:22528
  v_lshrrev_b32 v19, 2, v0
  v_mfma_f32_32x32x16_bf16 v[160:175], v[156:159], a[188:191], v[160:175]
  ds_read_b128 v[156:159], v240 offset:23552
  v_fma_f32 v34, v34, v11, v12
  v_fma_f32 v35, v35, v11, v12
  v_mul_f32 v32, v32, v84
  s_waitcnt lgkmcnt(4)
  v_mfma_f32_32x32x16_bf16 v[160:175], v[128:131], a[192:195], v[160:175]
  ds_read_b128 v[128:131], v240 offset:24576
  v_mul_f32 v33, v33, v85
  v_mul_f32 v34, v34, v86
  v_mul_f32 v35, v35, v87
  v_exp_f32 v32, v32
  s_add_u32 m0, s66, 81920
  v_mfma_f32_32x32x16_bf16 v[160:175], v[132:135], a[196:199], v[160:175]
  ds_read_b128 v[132:135], v240 offset:25600
  s_mul_i32 s78, s46, 56
  s_lshl_b32 s77, s41, 2
  s_add_u32 s78, s78, s77
  s_lshl_b32 s78, s78, 10
  s_add_u32 s86, s78, 20971520
  v_add_u32 v6, s82, v8
  s_add_u32 s82, s82, 65536
  s_cmp_eq_u32 s82, 458752
  s_cselect_b32 s82, 0, s82
  v_mfma_f32_32x32x16_bf16 v[160:175], v[136:139], a[200:203], v[160:175]
  ds_read_b128 v[136:139], v240 offset:26624
  v_exp_f32 v33, v33
  v_exp_f32 v34, v34
  v_mfma_f32_32x32x16_bf16 v[160:175], v[140:143], a[204:207], v[160:175]
  buffer_load_dwordx4 v6, s[24:27], 0 offen lds
  ds_read_b128 v[140:143], v240 offset:27648
  s_waitcnt lgkmcnt(4)
  v_mfma_f32_32x32x16_bf16 v[160:175], v[144:147], a[208:211], v[160:175]
  ds_read_b128 v[144:147], v240 offset:28672
  s_lshl_b32 s78, s46, 4
  s_add_u32 s78, s78, s41
  s_lshl_b32 s78, s78, 8
  s_add_u32 s85, s78, 27262976
  v_exp_f32 v35, v35
  v_fma_f32 v32, v32, v13, v13
  v_fma_f32 v33, v33, v13, v13
  v_mfma_f32_32x32x16_bf16 v[160:175], v[148:151], a[212:215], v[160:175]
  buffer_load_dwordx4 v6, s[24:27], s57 offen offset:1024 lds
  ds_read_b128 v[148:151], v240 offset:29696
  v_mfma_f32_32x32x16_bf16 v[160:175], v[152:155], a[216:219], v[160:175]
  v_cmp_ne_u32 vcc, 0, v0
  v_bfrev_b32 v249, 1
  s_nop 0
  v_cndmask_b32 v249, 0, v249, vcc
  v_fma_f32 v34, v34, v13, v13
  v_fma_f32 v35, v35, v13, v13
  v_rcp_f32 v32, v32
  ds_read_b128 v[152:155], v240 offset:30720
  v_mfma_f32_32x32x16_bf16 v[160:175], v[156:159], a[220:223], v[160:175]
  buffer_load_dwordx4 v6, s[24:27], s58 offen offset:2048 lds
  ds_read_b128 v[156:159], v240 offset:31744
  s_waitcnt lgkmcnt(4)
  v_mfma_f32_32x32x16_bf16 v[160:175], v[128:131], a[224:227], v[160:175]
  v_rcp_f32 v33, v33
  v_rcp_f32 v34, v34
  v_mfma_f32_32x32x16_bf16 v[160:175], v[132:135], a[228:231], v[160:175]
  buffer_load_dwordx4 v6, s[24:27], s59 offen offset:3072 lds
  v_rcp_f32 v35, v35
  v_mfma_f32_32x32x16_bf16 v[160:175], v[136:139], a[232:235], v[160:175]
  s_waitcnt vmcnt(16) lgkmcnt(0)
  s_barrier
  s_add_u32 s77, s48, 196608
  v_mov_b32 v29, s44
  buffer_store_dword v29, v9, s[36:39], s77 offen sc1
  v_add_u32 v240, 0xfffe0000, v240
  ds_read_b128 v[128:131], v240
  ds_read_b128 v[132:135], v240 offset:1024
  ds_read_b128 v[136:139], v240 offset:2048
  v_mfma_f32_32x32x16_bf16 v[160:175], v[140:143], a[236:239], v[160:175]
  ds_read_b128 v[140:143], v240 offset:3072
  s_add_u32 m0, s66, 98304
  s_add_u32 s65, s69, 0
  v_mfma_f32_32x32x16_bf16 v[160:175], v[144:147], a[240:243], v[160:175]
  ds_read_b128 v[144:147], v240 offset:4096
  s_and_b32 s65, s65, 0xffff
  s_add_u32 s65, s65, s73
  v_mfma_f32_32x32x16_bf16 v[160:175], v[148:151], a[244:247], v[160:175]
  buffer_load_dwordx4 v0, s[36:39], s65 offen sc1 lds
  ds_read_b128 v[148:151], v240 offset:5120
  v_mfma_f32_32x32x16_bf16 v[160:175], v[152:155], a[248:251], v[160:175]
  ds_read_b128 v[152:155], v240 offset:6144
  v_mul_f32 v84, v84, v32
  v_mfma_f32_32x32x16_bf16 v[160:175], v[156:159], a[252:255], v[160:175]
  ds_read_b128 v[156:159], v240 offset:7168
  v_mul_f32 v85, v85, v33
  v_mul_f32 v86, v86, v34
  v_mul_f32 v87, v87, v35
  v_mul_f32 v32, v88, v88
  s_waitcnt lgkmcnt(4)
  v_mfma_f32_32x32x16_bf16 v[176:191], v[128:131], a[0:3], 0
  buffer_load_dwordx4 v0, s[36:39], s65 offen offset:1024 sc1 lds
  ds_read_b128 v[128:131], v240 offset:8192
  v_mfma_f32_32x32x16_bf16 v[176:191], v[132:135], a[4:7], v[176:191]
  ds_read_b128 v[132:135], v240 offset:9216
  v_mul_f32 v33, v89, v89
  v_mul_f32 v34, v90, v90
  v_mul_f32 v35, v91, v91
  v_fma_f32 v32, v32, v11, v12
  v_mfma_f32_32x32x16_bf16 v[176:191], v[136:139], a[8:11], v[176:191]
  buffer_load_dwordx4 v0, s[36:39], s65 offen offset:2048 sc1 lds
  ds_read_b128 v[136:139], v240 offset:10240
  v_mfma_f32_32x32x16_bf16 v[176:191], v[140:143], a[12:15], v[176:191]
  ds_read_b128 v[140:143], v240 offset:11264
  v_fma_f32 v33, v33, v11, v12
  v_fma_f32 v34, v34, v11, v12
  v_fma_f32 v35, v35, v11, v12
  v_mul_f32 v32, v32, v88
  s_waitcnt lgkmcnt(4)
  v_mfma_f32_32x32x16_bf16 v[176:191], v[144:147], a[16:19], v[176:191]
  buffer_load_dwordx4 v0, s[36:39], s65 offen offset:3072 sc1 lds
  ds_read_b128 v[144:147], v240 offset:12288
  v_mfma_f32_32x32x16_bf16 v[176:191], v[148:151], a[20:23], v[176:191]
  ds_read_b128 v[148:151], v240 offset:13312
  v_mul_f32 v33, v33, v89
  v_mul_f32 v34, v34, v90
  v_mul_f32 v35, v35, v91
  s_add_u32 m0, s66, 114688
  v_mfma_f32_32x32x16_bf16 v[176:191], v[152:155], a[24:27], v[176:191]
  ds_read_b128 v[152:155], v240 offset:14336
  v_exp_f32 v32, v32
  s_add_u32 s65, s69, 16384
  s_and_b32 s65, s65, 0xffff
  s_add_u32 s65, s65, s73
  v_mfma_f32_32x32x16_bf16 v[176:191], v[156:159], a[28:31], v[176:191]
  ds_read_b128 v[156:159], v240 offset:15360
  v_exp_f32 v33, v33
  v_exp_f32 v34, v34
  s_waitcnt lgkmcnt(4)
  v_mfma_f32_32x32x16_bf16 v[176:191], v[128:131], a[32:35], v[176:191]
  buffer_load_dwordx4 v0, s[36:39], s65 offen sc1 lds
  ds_read_b128 v[128:131], v240 offset:16384
  v_mfma_f32_32x32x16_bf16 v[176:191], v[132:135], a[36:39], v[176:191]
  ds_read_b128 v[132:135], v240 offset:17408
  v_exp_f32 v35, v35
  v_fma_f32 v32, v32, v13, v13
  v_fma_f32 v33, v33, v13, v13
  v_mfma_f32_32x32x16_bf16 v[176:191], v[136:139], a[40:43], v[176:191]
  buffer_load_dwordx4 v0, s[36:39], s65 offen offset:1024 sc1 lds
  ds_read_b128 v[136:139], v240 offset:18432
  v_cvt_pk_bf16_f32 v64, v160, v161
  v_cvt_pk_bf16_f32 v65, v162, v163
  v_mfma_f32_32x32x16_bf16 v[176:191], v[140:143], a[44:47], v[176:191]
  ds_read_b128 v[140:143], v240 offset:19456
  v_cvt_pk_bf16_f32 v66, v164, v165
  v_fma_f32 v34, v34, v13, v13
  v_fma_f32 v35, v35, v13, v13
  v_rcp_f32 v32, v32
  s_waitcnt lgkmcnt(4)
  v_mfma_f32_32x32x16_bf16 v[176:191], v[144:147], a[48:51], v[176:191]
  buffer_load_dwordx4 v0, s[36:39], s65 offen offset:2048 sc1 lds
  ds_read_b128 v[144:147], v240 offset:20480
  v_cvt_pk_bf16_f32 v67, v166, v167
  v_mfma_f32_32x32x16_bf16 v[176:191], v[148:151], a[52:55], v[176:191]
  buffer_store_dwordx4 v[64:67], v0, s[36:39], s61 offen sc1
  ds_read_b128 v[148:151], v240 offset:21504
  v_rcp_f32 v33, v33
  v_rcp_f32 v34, v34
  v_mfma_f32_32x32x16_bf16 v[176:191], v[152:155], a[56:59], v[176:191]
  buffer_load_dwordx4 v0, s[36:39], s65 offen offset:3072 sc1 lds
  ds_read_b128 v[152:155], v240 offset:22528
  v_mfma_f32_32x32x16_bf16 v[176:191], v[156:159], a[60:63], v[176:191]
  ds_read_b128 v[156:159], v240 offset:23552
  v_bitop3_b32 v30, s44, v64, v65 bitop3:0x96
  v_rcp_f32 v35, v35
  v_mul_f32 v88, v88, v32
  s_waitcnt lgkmcnt(4)
  v_mfma_f32_32x32x16_bf16 v[176:191], v[128:131], a[64:67], v[176:191]
  ds_read_b128 v[128:131], v240 offset:24576
  v_bitop3_b32 v30, v30, v66, v67 bitop3:0x96
  v_cvt_pk_bf16_f32 v68, v168, v169
  v_mul_f32 v89, v89, v33
  v_mul_f32 v90, v90, v34
  v_mul_f32 v91, v91, v35
  v_mul_f32 v32, v92, v92
  s_add_u32 m0, s66, 131072
  v_mfma_f32_32x32x16_bf16 v[176:191], v[132:135], a[68:71], v[176:191]
  ds_read_b128 v[132:135], v240 offset:25600
  v_cvt_pk_bf16_f32 v69, v170, v171
  v_cvt_pk_bf16_f32 v70, v172, v173
  v_cvt_pk_bf16_f32 v71, v174, v175
  v_add_u32 v6, s82, v8
  s_add_u32 s82, s82, 65536
  s_cmp_eq_u32 s82, 458752
  s_cselect_b32 s82, 0, s82
  v_mfma_f32_32x32x16_bf16 v[176:191], v[136:139], a[72:75], v[176:191]
  ds_read_b128 v[136:139], v240 offset:26624
  v_mul_f32 v33, v93, v93
  v_mul_f32 v34, v94, v94
  v_mul_f32 v35, v95, v95
  v_fma_f32 v32, v32, v11, v12
  v_fma_f32 v33, v33, v11, v12
  v_mfma_f32_32x32x16_bf16 v[176:191], v[140:143], a[76:79], v[176:191]
  buffer_load_dwordx4 v6, s[24:27], 0 offen lds
  ds_read_b128 v[140:143], v240 offset:27648
  s_waitcnt lgkmcnt(4)
  v_mfma_f32_32x32x16_bf16 v[176:191], v[144:147], a[80:83], v[176:191]
  buffer_store_dwordx4 v[68:71], v0, s[36:39], s61 offen offset:1024 sc1
  ds_read_b128 v[144:147], v240 offset:28672
  v_fma_f32 v34, v34, v11, v12
  v_fma_f32 v35, v35, v11, v12
  v_mul_f32 v32, v32, v92
  v_mul_f32 v33, v33, v93
  v_mfma_f32_32x32x16_bf16 v[176:191], v[148:151], a[84:87], v[176:191]
  buffer_load_dwordx4 v6, s[24:27], s57 offen offset:1024 lds
  ds_read_b128 v[148:151], v240 offset:29696
  v_mfma_f32_32x32x16_bf16 v[176:191], v[152:155], a[88:91], v[176:191]
  ds_read_b128 v[152:155], v240 offset:30720
  v_bitop3_b32 v30, v30, v68, v69 bitop3:0x96
  v_bitop3_b32 v30, v30, v70, v71 bitop3:0x96
  v_mul_f32 v34, v34, v94
  v_mul_f32 v35, v35, v95
  v_exp_f32 v32, v32
  v_mfma_f32_32x32x16_bf16 v[176:191], v[156:159], a[92:95], v[176:191]
  buffer_load_dwordx4 v6, s[24:27], s58 offen offset:2048 lds
  ds_read_b128 v[156:159], v240 offset:31744
  s_waitcnt lgkmcnt(4)
  v_mfma_f32_32x32x16_bf16 v[176:191], v[128:131], a[96:99], v[176:191]
  buffer_store_dword v30, v19, s[36:39], s62 offen sc1
  v_exp_f32 v33, v33
  v_exp_f32 v34, v34
  v_mfma_f32_32x32x16_bf16 v[176:191], v[132:135], a[100:103], v[176:191]
  buffer_load_dwordx4 v6, s[24:27], s59 offen offset:3072 lds
  v_exp_f32 v35, v35
  v_mfma_f32_32x32x16_bf16 v[176:191], v[136:139], a[104:107], v[176:191]
  s_waitcnt vmcnt(20) lgkmcnt(0)
  s_barrier
  ds_read_b128 v[128:131], v240 offset:49152
  ds_read_b128 v[132:135], v240 offset:50176
  ds_read_b128 v[136:139], v240 offset:51200
  v_mfma_f32_32x32x16_bf16 v[176:191], v[140:143], a[108:111], v[176:191]
  ds_read_b128 v[140:143], v240 offset:52224
  v_fma_f32 v32, v32, v13, v13
  s_add_u32 m0, s66, 147456
  s_add_u32 s65, s69, 32768
  v_mfma_f32_32x32x16_bf16 v[176:191], v[144:147], a[112:115], v[176:191]
  ds_read_b128 v[144:147], v240 offset:53248
  v_fma_f32 v33, v33, v13, v13
  v_fma_f32 v34, v34, v13, v13
  v_fma_f32 v35, v35, v13, v13
  s_and_b32 s65, s65, 0xffff
  s_add_u32 s65, s65, s73
  v_mfma_f32_32x32x16_bf16 v[176:191], v[148:151], a[116:119], v[176:191]
  buffer_load_dwordx4 v0, s[36:39], s65 offen sc1 lds
  ds_read_b128 v[148:151], v240 offset:54272
  v_mfma_f32_32x32x16_bf16 v[176:191], v[152:155], a[120:123], v[176:191]
  ds_read_b128 v[152:155], v240 offset:55296
  v_rcp_f32 v32, v32
  v_rcp_f32 v33, v33
  v_mfma_f32_32x32x16_bf16 v[176:191], v[156:159], a[124:127], v[176:191]
  ds_read_b128 v[156:159], v240 offset:56320
  v_rcp_f32 v34, v34
  v_rcp_f32 v35, v35
  s_waitcnt lgkmcnt(4)
  v_mfma_f32_32x32x16_bf16 v[176:191], v[128:131], a[128:131], v[176:191]
  buffer_load_dwordx4 v0, s[36:39], s65 offen offset:1024 sc1 lds
  ds_read_b128 v[128:131], v240 offset:57344
  v_mfma_f32_32x32x16_bf16 v[176:191], v[132:135], a[132:135], v[176:191]
  ds_read_b128 v[132:135], v240 offset:58368
  v_mul_f32 v92, v92, v32
  v_mul_f32 v93, v93, v33
  v_mul_f32 v94, v94, v34
  v_mul_f32 v95, v95, v35
  v_mul_f32 v32, v96, v96
  v_mfma_f32_32x32x16_bf16 v[176:191], v[136:139], a[136:139], v[176:191]
  buffer_load_dwordx4 v0, s[36:39], s65 offen offset:2048 sc1 lds
  ds_read_b128 v[136:139], v240 offset:59392
  v_mfma_f32_32x32x16_bf16 v[176:191], v[140:143], a[140:143], v[176:191]
  ds_read_b128 v[140:143], v240 offset:60416
  v_lshlrev_b32 v244, 16, v244
  v_mov_b32 v224, v244
  v_mul_f32 v33, v97, v97
  v_mul_f32 v34, v98, v98
  v_mul_f32 v35, v99, v99
  s_waitcnt lgkmcnt(4)
  v_mfma_f32_32x32x16_bf16 v[176:191], v[144:147], a[144:147], v[176:191]
  buffer_load_dwordx4 v0, s[36:39], s65 offen offset:3072 sc1 lds
  ds_read_b128 v[144:147], v240 offset:61440
  v_mfma_f32_32x32x16_bf16 v[176:191], v[148:151], a[148:151], v[176:191]
  ds_read_b128 v[148:151], v240 offset:62464
  v_fma_f32 v32, v32, v11, v12
  v_fma_f32 v33, v33, v11, v12
  v_fma_f32 v34, v34, v11, v12
  v_fma_f32 v35, v35, v11, v12
  s_add_u32 m0, s66, 0
  v_mfma_f32_32x32x16_bf16 v[176:191], v[152:155], a[152:155], v[176:191]
  ds_read_b128 v[152:155], v240 offset:63488
  v_mov_b32 v225, v244
  v_mov_b32 v226, v244
  v_mul_f32 v32, v32, v96
  s_add_u32 s65, s69, 49152
  s_and_b32 s65, s65, 0xffff
  s_add_u32 s65, s65, s73
  v_mfma_f32_32x32x16_bf16 v[176:191], v[156:159], a[156:159], v[176:191]
  ds_read_b128 v[156:159], v240 offset:64512
  v_mov_b32 v227, v244
  v_mul_f32 v33, v33, v97
  v_mul_f32 v34, v34, v98
  v_mul_f32 v35, v35, v99
  s_waitcnt lgkmcnt(4)
  v_mfma_f32_32x32x16_bf16 v[176:191], v[128:131], a[160:163], v[176:191]
  buffer_load_dwordx4 v0, s[36:39], s65 offen sc1 lds
  v_add_u32 v240, 0x10000, v240
  v_mfma_f32_32x32x16_bf16 v[176:191], v[132:135], a[164:167], v[176:191]
  ds_read_b128 v[128:131], v240
  ds_read_b128 v[132:135], v240 offset:1024
  v_mov_b32 v228, v244
  v_exp_f32 v32, v32
  v_exp_f32 v33, v33
  v_mfma_f32_32x32x16_bf16 v[176:191], v[136:139], a[168:171], v[176:191]
  buffer_load_dwordx4 v0, s[36:39], s65 offen offset:1024 sc1 lds
  ds_read_b128 v[136:139], v240 offset:2048
  v_mfma_f32_32x32x16_bf16 v[176:191], v[140:143], a[172:175], v[176:191]
  ds_read_b128 v[140:143], v240 offset:3072
  v_exp_f32 v34, v34
  v_exp_f32 v35, v35
  s_waitcnt lgkmcnt(4)
  v_mfma_f32_32x32x16_bf16 v[176:191], v[144:147], a[176:179], v[176:191]
  ds_read_b128 v[144:147], v240 offset:4096
  v_mov_b32 v229, v244
  v_mov_b32 v230, v244
  v_fma_f32 v32, v32, v13, v13
  v_bfe_u32 v251, v0, 4, 4
  v_min_u32 v251, 15, v251
  v_lshlrev_b32 v251, 8, v251
  v_mfma_f32_32x32x16_bf16 v[176:191], v[148:151], a[180:183], v[176:191]
  buffer_load_dwordx4 v0, s[36:39], s65 offen offset:2048 sc1 lds
  ds_read_b128 v[148:151], v240 offset:5120
  v_mfma_f32_32x32x16_bf16 v[176:191], v[152:155], a[184:187], v[176:191]
  buffer_load_dwordx4 v0, s[36:39], s65 offen offset:3072 sc1 lds
  ds_read_b128 v[152:155], v240 offset:6144
  v_mov_b32 v231, v244
  v_mfma_f32_32x32x16_bf16 v[176:191], v[156:159], a[188:191], v[176:191]
  ds_read_b128 v[156:159], v240 offset:7168
  v_mov_b32 v232, v244
  v_fma_f32 v33, v33, v13, v13
  v_fma_f32 v34, v34, v13, v13
  v_fma_f32 v35, v35, v13, v13
  s_waitcnt lgkmcnt(4)
  v_mfma_f32_32x32x16_bf16 v[176:191], v[128:131], a[192:195], v[176:191]
  ds_read_b128 v[128:131], v240 offset:8192
  v_rcp_f32 v32, v32
  s_lshl_b32 s77, s40, 12
  s_add_u32 s77, s77, 200704
  v_add_u32 v251, s77, v251
  s_add_u32 m0, s66, 16384
  v_mfma_f32_32x32x16_bf16 v[176:191], v[132:135], a[196:199], v[176:191]
  ds_read_b128 v[132:135], v240 offset:9216
  v_mov_b32 v233, v244
  v_add_u32 v6, s82, v8
  s_add_u32 s82, s82, 65536
  s_cmp_eq_u32 s82, 458752
  s_cselect_b32 s82, 0, s82
  v_mfma_f32_32x32x16_bf16 v[176:191], v[136:139], a[200:203], v[176:191]
  buffer_load_dword v250, v251, s[36:39], 0 offen sc1
  ds_read_b128 v[136:139], v240 offset:10240
  v_mfma_f32_32x32x16_bf16 v[176:191], v[140:143], a[204:207], v[176:191]
  buffer_load_dwordx4 v6, s[24:27], 0 offen lds
  ds_read_b128 v[140:143], v240 offset:11264
  s_waitcnt lgkmcnt(4)
  v_mfma_f32_32x32x16_bf16 v[176:191], v[144:147], a[208:211], v[176:191]
  ds_read_b128 v[144:147], v240 offset:12288
  v_mov_b32 v234, v244
  v_rcp_f32 v33, v33
  v_rcp_f32 v34, v34
  v_mfma_f32_32x32x16_bf16 v[176:191], v[148:151], a[212:215], v[176:191]
  buffer_load_dwordx4 v6, s[24:27], s57 offen offset:1024 lds
  ds_read_b128 v[148:151], v240 offset:13312
  v_mfma_f32_32x32x16_bf16 v[176:191], v[152:155], a[216:219], v[176:191]
  ds_read_b128 v[152:155], v240 offset:14336
  v_mov_b32 v235, v244
  v_rcp_f32 v35, v35
  v_mul_f32 v96, v96, v32
  v_mul_f32 v97, v97, v33
  v_mfma_f32_32x32x16_bf16 v[176:191], v[156:159], a[220:223], v[176:191]
  buffer_load_dwordx4 v6, s[24:27], s58 offen offset:2048 lds
  ds_read_b128 v[156:159], v240 offset:15360
  s_waitcnt lgkmcnt(4)
  v_mfma_f32_32x32x16_bf16 v[176:191], v[128:131], a[224:227], v[176:191]
  v_mov_b32 v236, v244
  v_mov_b32 v237, v244
  v_mul_f32 v98, v98, v34
  v_mul_f32 v99, v99, v35
  v_mul_f32 v32, v100, v100
  v_mul_f32 v33, v101, v101
  v_mfma_f32_32x32x16_bf16 v[176:191], v[132:135], a[228:231], v[176:191]
  buffer_load_dwordx4 v6, s[24:27], s59 offen offset:3072 lds
  v_mul_f32 v34, v102, v102
  v_mfma_f32_32x32x16_bf16 v[176:191], v[136:139], a[232:235], v[176:191]
  v_mov_b32 v238, v244
  v_mov_b32 v239, v244
  s_waitcnt vmcnt(19) lgkmcnt(0)
  s_barrier
  ds_read_b128 v[128:131], v240 offset:32768
  ds_read_b128 v[132:135], v240 offset:33792
  ds_read_b128 v[136:139], v240 offset:34816
  v_mfma_f32_32x32x16_bf16 v[176:191], v[140:143], a[236:239], v[176:191]
  ds_read_b128 v[140:143], v240 offset:35840
  v_mul_f32 v35, v103, v103
  v_fma_f32 v32, v32, v11, v12
  v_fma_f32 v33, v33, v11, v12
  s_add_u32 m0, s66, 49152
  v_mfma_f32_32x32x16_bf16 v[176:191], v[144:147], a[240:243], v[176:191]
  ds_read_b128 v[144:147], v240 offset:36864
  v_fma_f32 v34, v34, v11, v12
  v_fma_f32 v35, v35, v11, v12
  v_mul_f32 v32, v32, v100
  v_mul_f32 v33, v33, v101
  s_add_u32 s65, s69, 0
  v_mfma_f32_32x32x16_bf16 v[176:191], v[148:151], a[244:247], v[176:191]
  ds_read_b128 v[148:151], v240 offset:37888
  v_mul_f32 v34, v34, v102
  v_mul_f32 v35, v35, v103
  s_and_b32 s65, s65, 0xffff
  s_add_u32 s65, s65, s73
  v_mfma_f32_32x32x16_bf16 v[176:191], v[152:155], a[248:251], v[176:191]
  ds_read_b128 v[152:155], v240 offset:38912
  v_exp_f32 v32, v32
  v_exp_f32 v33, v33
  v_exp_f32 v34, v34
  v_mfma_f32_32x32x16_bf16 v[176:191], v[156:159], a[252:255], v[176:191]
  buffer_load_dwordx4 v2, s[36:39], s65 offen sc1 lds
  ds_read_b128 v[156:159], v240 offset:39936
  s_waitcnt lgkmcnt(4)
  v_mfma_f32_32x32x16_bf16 v[192:207], v[128:131], a[0:3], v[224:239]
  ds_read_b128 v[128:131], v240 offset:40960
  v_exp_f32 v35, v35
  v_fma_f32 v32, v32, v13, v13
  v_mfma_f32_32x32x16_bf16 v[192:207], v[132:135], a[4:7], v[192:207]
  ds_read_b128 v[132:135], v240 offset:41984
  v_fma_f32 v33, v33, v13, v13
  v_fma_f32 v34, v34, v13, v13
  v_fma_f32 v35, v35, v13, v13
  v_rcp_f32 v32, v32
  v_mfma_f32_32x32x16_bf16 v[192:207], v[136:139], a[8:11], v[192:207]
  buffer_load_dwordx4 v2, s[36:39], s65 offen offset:1024 sc1 lds
  ds_read_b128 v[136:139], v240 offset:43008
  v_mfma_f32_32x32x16_bf16 v[192:207], v[140:143], a[12:15], v[192:207]
  ds_read_b128 v[140:143], v240 offset:44032
  v_rcp_f32 v33, v33
  s_waitcnt lgkmcnt(4)
  v_mfma_f32_32x32x16_bf16 v[192:207], v[144:147], a[16:19], v[192:207]
  ds_read_b128 v[144:147], v240 offset:45056
  v_rcp_f32 v34, v34
  v_rcp_f32 v35, v35
  v_mul_f32 v100, v100, v32
  v_mfma_f32_32x32x16_bf16 v[192:207], v[148:151], a[20:23], v[192:207]
  ds_read_b128 v[148:151], v240 offset:46080
  v_mul_f32 v101, v101, v33
  v_mul_f32 v102, v102, v34
  v_mul_f32 v103, v103, v35
  v_mul_f32 v32, v104, v104
  v_mul_f32 v33, v105, v105
  v_mfma_f32_32x32x16_bf16 v[192:207], v[152:155], a[24:27], v[192:207]
  buffer_load_dwordx4 v2, s[36:39], s65 offen offset:2048 sc1 lds
  ds_read_b128 v[152:155], v240 offset:47104
  v_mfma_f32_32x32x16_bf16 v[192:207], v[156:159], a[28:31], v[192:207]
  ds_read_b128 v[156:159], v240 offset:48128
  v_mul_f32 v34, v106, v106
  v_mul_f32 v35, v107, v107
  v_fma_f32 v32, v32, v11, v12
  v_fma_f32 v33, v33, v11, v12
  s_waitcnt lgkmcnt(4)
  v_mfma_f32_32x32x16_bf16 v[192:207], v[128:131], a[32:35], v[192:207]
  buffer_load_dword v30, v19, s[36:39], s87 offen sc1
  ds_read_b128 v[128:131], v240 offset:49152
  v_fma_f32 v34, v34, v11, v12
  v_fma_f32 v35, v35, v11, v12
  v_mul_f32 v32, v32, v104
  v_mul_f32 v33, v33, v105
  v_mfma_f32_32x32x16_bf16 v[192:207], v[132:135], a[36:39], v[192:207]
  buffer_load_dwordx4 v[64:67], v0, s[36:39], s72 offen sc1
  buffer_load_dwordx4 v2, s[36:39], s65 offen offset:3072 sc1 lds
  ds_read_b128 v[132:135], v240 offset:50176
  v_mfma_f32_32x32x16_bf16 v[192:207], v[136:139], a[40:43], v[192:207]
  ds_read_b128 v[136:139], v240 offset:51200
  v_mul_f32 v34, v34, v106
  v_mul_f32 v35, v35, v107
  v_exp_f32 v32, v32
  v_mfma_f32_32x32x16_bf16 v[192:207], v[140:143], a[44:47], v[192:207]
  ds_read_b128 v[140:143], v240 offset:52224
  v_exp_f32 v33, v33
  v_exp_f32 v34, v34
  s_add_u32 m0, s66, 65536
  s_waitcnt lgkmcnt(4)
  v_mfma_f32_32x32x16_bf16 v[192:207], v[144:147], a[48:51], v[192:207]
  buffer_load_dwordx4 v[68:71], v0, s[36:39], s72 offen offset:1024 sc1
  ds_read_b128 v[144:147], v240 offset:53248
  v_exp_f32 v35, v35
  v_fma_f32 v32, v32, v13, v13
  s_add_u32 s65, s69, 16384
  v_mfma_f32_32x32x16_bf16 v[192:207], v[148:151], a[52:55], v[192:207]
  ds_read_b128 v[148:151], v240 offset:54272
  v_cvt_pk_bf16_f32 v72, v176, v177
  v_cvt_pk_bf16_f32 v73, v178, v179
  v_cvt_pk_bf16_f32 v74, v180, v181
  v_fma_f32 v33, v33, v13, v13
  v_fma_f32 v34, v34, v13, v13
  v_fma_f32 v35, v35, v13, v13
  s_and_b32 s65, s65, 0xffff
  s_add_u32 s65, s65, s73
  v_mfma_f32_32x32x16_bf16 v[192:207], v[152:155], a[56:59], v[192:207]
  ds_read_b128 v[152:155], v240 offset:55296
  v_cvt_pk_bf16_f32 v75, v182, v183
  v_rcp_f32 v32, v32
  v_rcp_f32 v33, v33
  v_mfma_f32_32x32x16_bf16 v[192:207], v[156:159], a[60:63], v[192:207]
  buffer_store_dwordx4 v[72:75], v0, s[36:39], s61 offen offset:2048 sc1
  buffer_load_dwordx4 v2, s[36:39], s65 offen sc1 lds
  ds_read_b128 v[156:159], v240 offset:56320
  s_waitcnt lgkmcnt(4)
  v_mfma_f32_32x32x16_bf16 v[192:207], v[128:131], a[64:67], v[192:207]
  ds_read_b128 v[128:131], v240 offset:57344
  v_rcp_f32 v34, v34
  v_rcp_f32 v35, v35
  v_mfma_f32_32x32x16_bf16 v[192:207], v[132:135], a[68:71], v[192:207]
  ds_read_b128 v[132:135], v240 offset:58368
  v_bitop3_b32 v31, s44, v72, v73 bitop3:0x96
  v_bitop3_b32 v31, v31, v74, v75 bitop3:0x96
  v_cvt_pk_bf16_f32 v76, v184, v185
  v_mul_f32 v104, v104, v32
  v_mul_f32 v105, v105, v33
  v_mul_f32 v106, v106, v34
  v_mul_f32 v107, v107, v35
  v_mul_f32 v32, v108, v108
  v_mfma_f32_32x32x16_bf16 v[192:207], v[136:139], a[72:75], v[192:207]
  buffer_load_dwordx4 v2, s[36:39], s65 offen offset:1024 sc1 lds
  ds_read_b128 v[136:139], v240 offset:59392
  v_cvt_pk_bf16_f32 v77, v186, v187
  v_cvt_pk_bf16_f32 v78, v188, v189
  v_mfma_f32_32x32x16_bf16 v[192:207], v[140:143], a[76:79], v[192:207]
  ds_read_b128 v[140:143], v240 offset:60416
  v_cvt_pk_bf16_f32 v79, v190, v191
  v_mul_f32 v33, v109, v109
  v_mul_f32 v34, v110, v110
  v_mul_f32 v35, v111, v111
  s_waitcnt lgkmcnt(4)
  v_mfma_f32_32x32x16_bf16 v[192:207], v[144:147], a[80:83], v[192:207]
  buffer_store_dwordx4 v[76:79], v0, s[36:39], s61 offen offset:3072 sc1
  ds_read_b128 v[144:147], v240 offset:61440
  v_fma_f32 v32, v32, v11, v12
  v_fma_f32 v33, v33, v11, v12
  v_fma_f32 v34, v34, v11, v12
  v_fma_f32 v35, v35, v11, v12
  v_mul_f32 v32, v32, v108
  v_mfma_f32_32x32x16_bf16 v[192:207], v[148:151], a[84:87], v[192:207]
  ds_read_b128 v[148:151], v240 offset:62464
  v_bitop3_b32 v31, v31, v76, v77 bitop3:0x96
  v_mul_f32 v33, v33, v109
  v_mul_f32 v34, v34, v110
  v_mul_f32 v35, v35, v111
  v_exp_f32 v32, v32
  v_mfma_f32_32x32x16_bf16 v[192:207], v[152:155], a[88:91], v[192:207]
  buffer_load_dwordx4 v2, s[36:39], s65 offen offset:2048 sc1 lds
  ds_read_b128 v[152:155], v240 offset:63488
  v_bitop3_b32 v31, v31, v78, v79 bitop3:0x96
  v_mfma_f32_32x32x16_bf16 v[192:207], v[156:159], a[92:95], v[192:207]
  buffer_store_dword v31, v19, s[36:39], s62 offen offset:256 sc1
  ds_read_b128 v[156:159], v240 offset:64512
  v_exp_f32 v33, v33
  s_waitcnt lgkmcnt(4)
  v_mfma_f32_32x32x16_bf16 v[192:207], v[128:131], a[96:99], v[192:207]
  v_exp_f32 v34, v34
  v_exp_f32 v35, v35
  v_fma_f32 v32, v32, v13, v13
  v_fma_f32 v33, v33, v13, v13
  v_fma_f32 v34, v34, v13, v13
  v_mfma_f32_32x32x16_bf16 v[192:207], v[132:135], a[100:103], v[192:207]
  buffer_load_dwordx4 v2, s[36:39], s65 offen offset:3072 sc1 lds
  v_mfma_f32_32x32x16_bf16 v[192:207], v[136:139], a[104:107], v[192:207]
  s_waitcnt vmcnt(19) lgkmcnt(0)
  s_barrier
  v_add_u32 v240, 0x10000, v240
  ds_read_b128 v[128:131], v240 offset:16384
  ds_read_b128 v[132:135], v240 offset:17408
  ds_read_b128 v[136:139], v240 offset:18432
  v_mfma_f32_32x32x16_bf16 v[192:207], v[140:143], a[108:111], v[192:207]
  ds_read_b128 v[140:143], v240 offset:19456
  v_fma_f32 v35, v35, v13, v13
  v_rcp_f32 v32, v32
  s_add_u32 m0, s66, 98304
  v_mfma_f32_32x32x16_bf16 v[192:207], v[144:147], a[112:115], v[192:207]
  ds_read_b128 v[144:147], v240 offset:20480
  v_lshrrev_b32 v28, 7, v0
  v_lshlrev_b32 v28, 10, v28
  s_add_u32 s65, s69, 32768
  s_and_b32 s65, s65, 0xffff
  v_mfma_f32_32x32x16_bf16 v[192:207], v[148:151], a[116:119], v[192:207]
  ds_read_b128 v[148:151], v240 offset:21504
  v_rcp_f32 v33, v33
  v_and_b32 v29, 0x70, v0
  v_or_b32 v28, v28, v29
  s_add_u32 s65, s65, s73
  v_mfma_f32_32x32x16_bf16 v[192:207], v[152:155], a[120:123], v[192:207]
  ds_read_b128 v[152:155], v240 offset:22528
  s_lshl_b32 s77, s40, 17
  s_lshl_b32 s78, s42, 16
  s_add_u32 s77, s77, s78
  s_lshl_b32 s78, s43, 13
  s_add_u32 s77, s77, s78
  s_add_u32 s77, s77, s56
  v_add_u32 v28, s77, v28
  v_mfma_f32_32x32x16_bf16 v[192:207], v[156:159], a[124:127], v[192:207]
  buffer_load_dwordx4 v2, s[36:39], s65 offen sc1 lds
  ds_read_b128 v[156:159], v240 offset:23552
  s_waitcnt lgkmcnt(4)
  v_mfma_f32_32x32x16_bf16 v[192:207], v[128:131], a[128:131], v[192:207]
  ds_read_b128 v[128:131], v240 offset:24576
  v_rcp_f32 v34, v34
  v_mfma_f32_32x32x16_bf16 v[192:207], v[132:135], a[132:135], v[192:207]
  ds_read_b128 v[132:135], v240 offset:25600
  v_rcp_f32 v35, v35
  v_mul_f32 v108, v108, v32
  v_add_u32 v29, 32768, v28
  v_mfma_f32_32x32x16_bf16 v[192:207], v[136:139], a[136:139], v[192:207]
  buffer_load_dwordx4 v2, s[36:39], s65 offen offset:1024 sc1 lds
  ds_read_b128 v[136:139], v240 offset:26624
  v_mfma_f32_32x32x16_bf16 v[192:207], v[140:143], a[140:143], v[192:207]
  buffer_load_dwordx4 v[20:23], v28, s[4:7], 0 offen
  ds_read_b128 v[140:143], v240 offset:27648
  s_waitcnt lgkmcnt(4)
  v_mfma_f32_32x32x16_bf16 v[192:207], v[144:147], a[144:147], v[192:207]
  ds_read_b128 v[144:147], v240 offset:28672
  v_mul_f32 v109, v109, v33
  v_mul_f32 v110, v110, v34
  v_mul_f32 v111, v111, v35
  v_mfma_f32_32x32x16_bf16 v[192:207], v[148:151], a[148:151], v[192:207]
  buffer_load_dwordx4 v2, s[36:39], s65 offen offset:2048 sc1 lds
  ds_read_b128 v[148:151], v240 offset:29696
  v_mfma_f32_32x32x16_bf16 v[192:207], v[152:155], a[152:155], v[192:207]
  buffer_load_dwordx4 v[24:27], v29, s[4:7], 0 offen
  ds_read_b128 v[152:155], v240 offset:30720
  v_mfma_f32_32x32x16_bf16 v[192:207], v[156:159], a[156:159], v[192:207]
  s_waitcnt vmcnt(23)
  v_cmp_ne_u32 s[74:75], s44, v250
  s_nop 1
  s_cmp_lg_u64 s[74:75], 0
  s_cbranch_scc1 L_slow_20
L_back_21:
  ds_read_b128 v[156:159], v240 offset:31744
  s_waitcnt lgkmcnt(4)
  v_mfma_f32_32x32x16_bf16 v[192:207], v[128:131], a[160:163], v[192:207]
  v_add_u32 v240, 0xfffe0000, v240
  v_mfma_f32_32x32x16_bf16 v[192:207], v[132:135], a[164:167], v[192:207]
  buffer_load_dwordx4 v2, s[36:39], s65 offen offset:3072 sc1 lds
  ds_read_b128 v[128:131], v240
  ds_read_b128 v[132:135], v240 offset:1024
  v_mfma_f32_32x32x16_bf16 v[192:207], v[136:139], a[168:171], v[192:207]
  s_waitcnt vmcnt(13)
  ds_read_b128 v[136:139], v240 offset:2048
  v_bitop3_b32 v16, s44, v64, v65 bitop3:0x96
  v_bitop3_b32 v16, v16, v66, v67 bitop3:0x96
  v_bitop3_b32 v16, v16, v68, v69 bitop3:0x96
  v_mfma_f32_32x32x16_bf16 v[192:207], v[140:143], a[172:175], v[192:207]
  v_bitop3_b32 v16, v16, v70, v71 bitop3:0x96
  v_cmp_ne_u32 s[74:75], v30, v16
  s_nop 1
  s_cmp_lg_u64 s[74:75], 0
  s_cbranch_scc1 L_slow_14
L_back_15:
  ds_read_b128 v[140:143], v240 offset:3072
  s_waitcnt lgkmcnt(4)
  v_mfma_f32_32x32x16_bf16 v[192:207], v[144:147], a[176:179], v[192:207]
  ds_read_b128 v[144:147], v240 offset:4096
  v_and_b32 v161, 0xffff0000, v64
  s_add_u32 m0, s66, 114688
  s_add_u32 s65, s69, 49152
  v_mfma_f32_32x32x16_bf16 v[192:207], v[148:151], a[180:183], v[192:207]
  ds_read_b128 v[148:151], v240 offset:5120
  v_lshlrev_b32 v160, 16, v64
  v_mul_f32 v161, v161, v81
  v_mul_f32 v160, v160, v80
  s_and_b32 s65, s65, 0xffff
  s_add_u32 s65, s65, s73
  v_mfma_f32_32x32x16_bf16 v[192:207], v[152:155], a[184:187], v[192:207]
  ds_read_b128 v[152:155], v240 offset:6144
  v_and_b32 v163, 0xffff0000, v65
  v_lshlrev_b32 v162, 16, v65
  v_mul_f32 v163, v163, v83
  v_mul_f32 v162, v162, v82
  v_mfma_f32_32x32x16_bf16 v[192:207], v[156:159], a[188:191], v[192:207]
  ds_read_b128 v[156:159], v240 offset:7168
  v_and_b32 v165, 0xffff0000, v66
  v_lshlrev_b32 v164, 16, v66
  v_mul_f32 v165, v165, v85
  s_waitcnt lgkmcnt(4)
  v_mfma_f32_32x32x16_bf16 v[192:207], v[128:131], a[192:195], v[192:207]
  buffer_load_dwordx4 v2, s[36:39], s65 offen sc1 lds
  ds_read_b128 v[128:131], v240 offset:8192
  v_mfma_f32_32x32x16_bf16 v[192:207], v[132:135], a[196:199], v[192:207]
  ds_read_b128 v[132:135], v240 offset:9216
  v_mul_f32 v164, v164, v84
  v_and_b32 v167, 0xffff0000, v67
  v_lshlrev_b32 v166, 16, v67
  v_mfma_f32_32x32x16_bf16 v[192:207], v[136:139], a[200:203], v[192:207]
  buffer_load_dwordx4 v2, s[36:39], s65 offen offset:1024 sc1 lds
  ds_read_b128 v[136:139], v240 offset:10240
  v_mfma_f32_32x32x16_bf16 v[192:207], v[140:143], a[204:207], v[192:207]
  ds_read_b128 v[140:143], v240 offset:11264
  v_mul_f32 v167, v167, v87
  v_mul_f32 v166, v166, v86
  s_waitcnt lgkmcnt(4)
  v_mfma_f32_32x32x16_bf16 v[192:207], v[144:147], a[208:211], v[192:207]
  ds_read_b128 v[144:147], v240 offset:12288
  v_and_b32 v169, 0xffff0000, v68
  v_lshlrev_b32 v168, 16, v68
  v_mul_f32 v169, v169, v89
  v_mul_f32 v168, v168, v88
  v_and_b32 v171, 0xffff0000, v69
  v_mfma_f32_32x32x16_bf16 v[192:207], v[148:151], a[212:215], v[192:207]
  ds_read_b128 v[148:151], v240 offset:13312
  v_lshlrev_b32 v170, 16, v69
  v_mul_f32 v171, v171, v91
  v_mul_f32 v170, v170, v90
  v_and_b32 v173, 0xffff0000, v70
  v_mfma_f32_32x32x16_bf16 v[192:207], v[152:155], a[216:219], v[192:207]
  buffer_load_dwordx4 v2, s[36:39], s65 offen offset:2048 sc1 lds
  ds_read_b128 v[152:155], v240 offset:14336
  v_mfma_f32_32x32x16_bf16 v[192:207], v[156:159], a[220:223], v[192:207]
  ds_read_b128 v[156:159], v240 offset:15360
  v_lshlrev_b32 v172, 16, v70
  v_mul_f32 v173, v173, v93
  s_waitcnt lgkmcnt(4)
  v_mfma_f32_32x32x16_bf16 v[192:207], v[128:131], a[224:227], v[192:207]
  v_mul_f32 v172, v172, v92
  v_and_b32 v175, 0xffff0000, v71
  v_lshlrev_b32 v174, 16, v71
  v_mul_f32 v175, v175, v95
  v_mul_f32 v174, v174, v94
  v_mfma_f32_32x32x16_bf16 v[192:207], v[132:135], a[228:231], v[192:207]
  buffer_load_dwordx4 v2, s[36:39], s65 offen offset:3072 sc1 lds
  v_mfma_f32_32x32x16_bf16 v[192:207], v[136:139], a[232:235], v[192:207]
  s_waitcnt vmcnt(10) lgkmcnt(0)
  s_barrier
  ds_read_b128 v[128:131], v240 offset:49152
  ds_read_b128 v[132:135], v240 offset:50176
  ds_read_b128 v[136:139], v240 offset:51200
  v_mfma_f32_32x32x16_bf16 v[192:207], v[140:143], a[236:239], v[192:207]
  ds_read_b128 v[140:143], v240 offset:52224
  s_add_u32 m0, s66, 147456
  v_mfma_f32_32x32x16_bf16 v[192:207], v[144:147], a[240:243], v[192:207]
  ds_read_b128 v[144:147], v240 offset:53248
  v_add_u32 v6, s80, v7
  s_add_u32 s80, s80, 65536
  s_and_b32 s80, s80, 0x3ffff
  v_mfma_f32_32x32x16_bf16 v[192:207], v[148:151], a[244:247], v[192:207]
  ds_read_b128 v[148:151], v240 offset:54272
  s_or_b32 s77, s40, s41
  s_cmp_eq_u32 s77, 0
  s_cselect_b32 s77, 0, 0x80000000
  v_or_b32 v16, s77, v9
  v_mov_b32 v18, s44
  v_mfma_f32_32x32x16_bf16 v[192:207], v[152:155], a[248:251], v[192:207]
  buffer_store_dword v18, v16, s[36:39], 0 offen sc1
  ds_read_b128 v[152:155], v240 offset:55296
  v_mfma_f32_32x32x16_bf16 v[192:207], v[156:159], a[252:255], v[192:207]
  buffer_load_dwordx4 v6, s[20:23], 0 offen lds
  ds_read_b128 v[156:159], v240 offset:56320
  s_waitcnt lgkmcnt(4)
  v_mfma_f32_32x32x16_bf16 v[208:223], v[128:131], a[0:3], v[224:239]
  ds_read_b128 v[128:131], v240 offset:57344
  v_mfma_f32_32x32x16_bf16 v[208:223], v[132:135], a[4:7], v[208:223]
  ds_read_b128 v[132:135], v240 offset:58368
  v_mfma_f32_32x32x16_bf16 v[208:223], v[136:139], a[8:11], v[208:223]
  buffer_load_dwordx4 v6, s[20:23], s57 offen offset:1024 lds
  ds_read_b128 v[136:139], v240 offset:59392
  v_mfma_f32_32x32x16_bf16 v[208:223], v[140:143], a[12:15], v[208:223]
  buffer_load_dword v31, v19, s[36:39], s87 offen offset:256 sc1
  buffer_load_dwordx4 v[72:75], v0, s[36:39], s72 offen offset:2048 sc1
  ds_read_b128 v[140:143], v240 offset:60416
  s_waitcnt lgkmcnt(4)
  v_mfma_f32_32x32x16_bf16 v[208:223], v[144:147], a[16:19], v[208:223]
  buffer_load_dwordx4 v[76:79], v0, s[36:39], s72 offen offset:3072 sc1
  ds_read_b128 v[144:147], v240 offset:61440
  v_mfma_f32_32x32x16_bf16 v[208:223], v[148:151], a[20:23], v[208:223]
  buffer_load_dwordx4 v6, s[20:23], s58 offen offset:2048 lds
  ds_read_b128 v[148:151], v240 offset:62464
  v_mfma_f32_32x32x16_bf16 v[208:223], v[152:155], a[24:27], v[208:223]
  ds_read_b128 v[152:155], v240 offset:63488
  v_fma_f32 v192, v192, v80, v160
  v_fma_f32 v193, v193, v81, v161
  v_fma_f32 v194, v194, v82, v162
  v_fma_f32 v195, v195, v83, v163
  v_mfma_f32_32x32x16_bf16 v[208:223], v[156:159], a[28:31], v[208:223]
  ds_read_b128 v[156:159], v240 offset:64512
  v_fma_f32 v196, v196, v84, v164
  v_fma_f32 v197, v197, v85, v165
  v_fma_f32 v198, v198, v86, v166
  v_fma_f32 v199, v199, v87, v167
  s_waitcnt lgkmcnt(4)
  v_mfma_f32_32x32x16_bf16 v[208:223], v[128:131], a[32:35], v[208:223]
  v_cvt_pk_bf16_f32 v192, v192, v193
  v_cvt_pk_bf16_f32 v193, v194, v195
  v_cvt_pk_bf16_f32 v194, v196, v197
  v_add_u32 v240, 0x10000, v240
  v_mfma_f32_32x32x16_bf16 v[208:223], v[132:135], a[36:39], v[208:223]
  buffer_load_dwordx4 v6, s[20:23], s59 offen offset:3072 lds
  ds_read_b128 v[128:131], v240
  ds_read_b128 v[132:135], v240 offset:1024
  v_mfma_f32_32x32x16_bf16 v[208:223], v[136:139], a[40:43], v[208:223]
  ds_read_b128 v[136:139], v240 offset:2048
  v_cvt_pk_bf16_f32 v195, v198, v199
  v_mfma_f32_32x32x16_bf16 v[208:223], v[140:143], a[44:47], v[208:223]
  buffer_store_dwordx4 v[192:195], v0, s[36:39], s86 offen sc1
  ds_read_b128 v[140:143], v240 offset:3072
  v_fma_f32 v200, v200, v88, v168
  s_waitcnt lgkmcnt(4)
  v_mfma_f32_32x32x16_bf16 v[208:223], v[144:147], a[48:51], v[208:223]
  ds_read_b128 v[144:147], v240 offset:4096
  v_fma_f32 v201, v201, v89, v169
  v_fma_f32 v202, v202, v90, v170
  v_fma_f32 v203, v203, v91, v171
  s_add_u32 m0, s66, 0
  v_mfma_f32_32x32x16_bf16 v[208:223], v[148:151], a[52:55], v[208:223]
  ds_read_b128 v[148:151], v240 offset:5120
  v_fma_f32 v204, v204, v92, v172
  v_fma_f32 v205, v205, v93, v173
  v_add_u32 v6, s80, v7
  s_add_u32 s80, s80, 65536
  s_and_b32 s80, s80, 0x3ffff
  v_mfma_f32_32x32x16_bf16 v[208:223], v[152:155], a[56:59], v[208:223]
  ds_read_b128 v[152:155], v240 offset:6144
  v_fma_f32 v206, v206, v94, v174
  v_fma_f32 v207, v207, v95, v175
  v_cvt_pk_bf16_f32 v200, v200, v201
  v_cvt_pk_bf16_f32 v201, v202, v203
  v_mfma_f32_32x32x16_bf16 v[208:223], v[156:159], a[60:63], v[208:223]
  ds_read_b128 v[156:159], v240 offset:7168
  v_cvt_pk_bf16_f32 v202, v204, v205
  v_cvt_pk_bf16_f32 v203, v206, v207
  s_waitcnt lgkmcnt(4)
  v_mfma_f32_32x32x16_bf16 v[208:223], v[128:131], a[64:67], v[208:223]
  buffer_load_dwordx4 v6, s[20:23], 0 offen lds
  ds_read_b128 v[128:131], v240 offset:8192
  v_mfma_f32_32x32x16_bf16 v[208:223], v[132:135], a[68:71], v[208:223]
  buffer_store_dwordx4 v[200:203], v0, s[36:39], s86 offen offset:1024 sc1
  ds_read_b128 v[132:135], v240 offset:9216
  v_mfma_f32_32x32x16_bf16 v[208:223], v[136:139], a[72:75], v[208:223]
  buffer_load_dwordx4 v6, s[20:23], s57 offen offset:1024 lds
  ds_read_b128 v[136:139], v240 offset:10240
  v_mfma_f32_32x32x16_bf16 v[208:223], v[140:143], a[76:79], v[208:223]
  ds_read_b128 v[140:143], v240 offset:11264
  s_waitcnt lgkmcnt(4)
  v_mfma_f32_32x32x16_bf16 v[208:223], v[144:147], a[80:83], v[208:223]
  ds_read_b128 v[144:147], v240 offset:12288
  s_lshl_b32 s78, s67, 15
  s_lshl_b32 s77, s68, 14
  s_add_u32 s78, s78, s77
  s_add_u32 s84, s78, 18874368
  v_mfma_f32_32x32x16_bf16 v[208:223], v[148:151], a[84:87], v[208:223]
  ds_read_b128 v[148:151], v240 offset:13312
  s_add_u32 s79, s84, s81
  s_add_u32 s81, s81, 4096
  s_and_b32 s81, s81, 0x3fff
  v_mfma_f32_32x32x16_bf16 v[208:223], v[152:155], a[88:91], v[208:223]
  buffer_load_dwordx4 v6, s[20:23], s58 offen offset:2048 lds
  ds_read_b128 v[152:155], v240 offset:14336
  v_mfma_f32_32x32x16_bf16 v[208:223], v[156:159], a[92:95], v[208:223]
  buffer_load_dwordx4 a[0:3], v0, s[36:39], s79 offen sc1
  ds_read_b128 v[156:159], v240 offset:15360
  s_waitcnt lgkmcnt(4)
  v_mfma_f32_32x32x16_bf16 v[208:223], v[128:131], a[96:99], v[208:223]
  buffer_load_dwordx4 a[4:7], v0, s[36:39], s79 offen offset:1024 sc1
  v_mfma_f32_32x32x16_bf16 v[208:223], v[132:135], a[100:103], v[208:223]
  buffer_load_dwordx4 v6, s[20:23], s59 offen offset:3072 lds
  v_mfma_f32_32x32x16_bf16 v[208:223], v[136:139], a[104:107], v[208:223]
  s_waitcnt vmcnt(16) lgkmcnt(0)
  s_barrier
  ds_read_b128 v[128:131], v240 offset:32768
  ds_read_b128 v[132:135], v240 offset:33792
  ds_read_b128 v[136:139], v240 offset:34816
  v_mfma_f32_32x32x16_bf16 v[208:223], v[140:143], a[108:111], v[208:223]
  ds_read_b128 v[140:143], v240 offset:35840
  s_add_u32 m0, s66, 49152
  v_mfma_f32_32x32x16_bf16 v[208:223], v[144:147], a[112:115], v[208:223]
  ds_read_b128 v[144:147], v240 offset:36864
  v_add_u32 v6, s80, v7
  s_add_u32 s80, s80, 65536
  s_and_b32 s80, s80, 0x3ffff
  v_mfma_f32_32x32x16_bf16 v[208:223], v[148:151], a[116:119], v[208:223]
  buffer_load_dwordx4 v6, s[20:23], 0 offen lds
  ds_read_b128 v[148:151], v240 offset:37888
  v_mfma_f32_32x32x16_bf16 v[208:223], v[152:155], a[120:123], v[208:223]
  buffer_load_dwordx4 v6, s[20:23], s57 offen offset:1024 lds
  ds_read_b128 v[152:155], v240 offset:38912
  v_mfma_f32_32x32x16_bf16 v[208:223], v[156:159], a[124:127], v[208:223]
  ds_read_b128 v[156:159], v240 offset:39936
  s_waitcnt lgkmcnt(4)
  v_mfma_f32_32x32x16_bf16 v[208:223], v[128:131], a[128:131], v[208:223]
  buffer_load_dwordx4 v6, s[20:23], s58 offen offset:2048 lds
  ds_read_b128 v[128:131], v240 offset:40960
  v_mfma_f32_32x32x16_bf16 v[208:223], v[132:135], a[132:135], v[208:223]
  buffer_load_dwordx4 a[8:11], v0, s[36:39], s79 offen offset:2048 sc1
  ds_read_b128 v[132:135], v240 offset:41984
  v_mfma_f32_32x32x16_bf16 v[208:223], v[136:139], a[136:139], v[208:223]
  buffer_load_dwordx4 v6, s[20:23], s59 offen offset:3072 lds
  ds_read_b128 v[136:139], v240 offset:43008
  s_add_u32 m0, s66, 65536
  v_mfma_f32_32x32x16_bf16 v[208:223], v[140:143], a[140:143], v[208:223]
  ds_read_b128 v[140:143], v240 offset:44032
  v_add_u32 v6, s80, v7
  s_add_u32 s80, s80, 65536
  s_and_b32 s80, s80, 0x3ffff
  s_waitcnt lgkmcnt(4)
  v_mfma_f32_32x32x16_bf16 v[208:223], v[144:147], a[144:147], v[208:223]
  ds_read_b128 v[144:147], v240 offset:45056
  v_mfma_f32_32x32x16_bf16 v[208:223], v[148:151], a[148:151], v[208:223]
  buffer_load_dwordx4 v6, s[20:23], 0 offen lds
  ds_read_b128 v[148:151], v240 offset:46080
  v_mfma_f32_32x32x16_bf16 v[208:223], v[152:155], a[152:155], v[208:223]
  buffer_load_dwordx4 v6, s[20:23], s57 offen offset:1024 lds
  ds_read_b128 v[152:155], v240 offset:47104
  v_mfma_f32_32x32x16_bf16 v[208:223], v[156:159], a[156:159], v[208:223]
  buffer_load_dwordx4 a[12:15], v0, s[36:39], s79 offen offset:3072 sc1
  ds_read_b128 v[156:159], v240 offset:48128
  s_waitcnt lgkmcnt(4)
  v_mfma_f32_32x32x16_bf16 v[208:223], v[128:131], a[160:163], v[208:223]
  buffer_load_dwordx4 v6, s[20:23], s58 offen offset:2048 lds
  v_mfma_f32_32x32x16_bf16 v[208:223], v[132:135], a[164:167], v[208:223]
  buffer_load_dwordx4 v6, s[20:23], s59 offen offset:3072 lds
  v_mfma_f32_32x32x16_bf16 v[208:223], v[136:139], a[168:171], v[208:223]
  s_waitcnt lgkmcnt(0)
  s_barrier
  ds_read_b128 v[128:131], v240 offset:49152
  ds_read_b128 v[132:135], v240 offset:50176
  ds_read_b128 v[136:139], v240 offset:51200
  v_mfma_f32_32x32x16_bf16 v[208:223], v[140:143], a[172:175], v[208:223]
  s_waitcnt vmcnt(20)
  ds_read_b128 v[140:143], v240 offset:52224
  s_add_u32 m0, s66, 98304
  v_mfma_f32_32x32x16_bf16 v[208:223], v[144:147], a[176:179], v[208:223]
  ds_read_b128 v[144:147], v240 offset:53248
  v_bitop3_b32 v17, s44, v72, v73 bitop3:0x96
  v_bitop3_b32 v17, v17, v74, v75 bitop3:0x96
  v_bitop3_b32 v17, v17, v76, v77 bitop3:0x96
  v_bitop3_b32 v17, v17, v78, v79 bitop3:0x96
  v_mfma_f32_32x32x16_bf16 v[208:223], v[148:151], a[180:183], v[208:223]
  ds_read_b128 v[148:151], v240 offset:54272
  v_add_u32 v6, s82, v8
  s_add_u32 s82, s82, 65536
  s_cmp_eq_u32 s82, 458752
  s_cselect_b32 s82, 0, s82
  v_mfma_f32_32x32x16_bf16 v[208:223], v[152:155], a[184:187], v[208:223]
  v_cmp_ne_u32 s[74:75], v31, v17
  s_nop 1
  s_cmp_lg_u64 s[74:75], 0
  s_cbranch_scc1 L_slow_17
L_back_18:
  v_and_b32 v177, 0xffff0000, v72
  v_lshlrev_b32 v176, 16, v72
  ds_read_b128 v[152:155], v240 offset:55296
  v_mfma_f32_32x32x16_bf16 v[208:223], v[156:159], a[188:191], v[208:223]
  ds_read_b128 v[156:159], v240 offset:56320
  v_mul_f32 v177, v177, v97
  v_mul_f32 v176, v176, v96
  v_and_b32 v179, 0xffff0000, v73
  s_waitcnt lgkmcnt(4)
  v_mfma_f32_32x32x16_bf16 v[208:223], v[128:131], a[192:195], v[208:223]
  buffer_load_dwordx4 v6, s[24:27], 0 offen lds
  ds_read_b128 v[128:131], v240 offset:57344
  v_mfma_f32_32x32x16_bf16 v[208:223], v[132:135], a[196:199], v[208:223]
  ds_read_b128 v[132:135], v240 offset:58368
  v_lshlrev_b32 v178, 16, v73
  v_mul_f32 v179, v179, v99
  v_mul_f32 v178, v178, v98
  v_and_b32 v181, 0xffff0000, v74
  v_mfma_f32_32x32x16_bf16 v[208:223], v[136:139], a[200:203], v[208:223]
  ds_read_b128 v[136:139], v240 offset:59392
  v_lshlrev_b32 v180, 16, v74
  v_mul_f32 v181, v181, v101
  v_mul_f32 v180, v180, v100
  v_and_b32 v183, 0xffff0000, v75
  v_mfma_f32_32x32x16_bf16 v[208:223], v[140:143], a[204:207], v[208:223]
  buffer_load_dwordx4 v6, s[24:27], s57 offen offset:1024 lds
  ds_read_b128 v[140:143], v240 offset:60416
  s_waitcnt lgkmcnt(4)
  v_mfma_f32_32x32x16_bf16 v[208:223], v[144:147], a[208:211], v[208:223]
  ds_read_b128 v[144:147], v240 offset:61440
  v_lshlrev_b32 v182, 16, v75
  v_mul_f32 v183, v183, v103
  v_mul_f32 v182, v182, v102
  v_mfma_f32_32x32x16_bf16 v[208:223], v[148:151], a[212:215], v[208:223]
  ds_read_b128 v[148:151], v240 offset:62464
  v_and_b32 v185, 0xffff0000, v76
  v_lshlrev_b32 v184, 16, v76
  v_mul_f32 v185, v185, v105
  v_mul_f32 v184, v184, v104
  v_mfma_f32_32x32x16_bf16 v[208:223], v[152:155], a[216:219], v[208:223]
  buffer_load_dwordx4 v6, s[24:27], s58 offen offset:2048 lds
  ds_read_b128 v[152:155], v240 offset:63488
  v_mfma_f32_32x32x16_bf16 v[208:223], v[156:159], a[220:223], v[208:223]
  ds_read_b128 v[156:159], v240 offset:64512
  v_and_b32 v187, 0xffff0000, v77
  v_lshlrev_b32 v186, 16, v77
  v_mul_f32 v187, v187, v107
  s_waitcnt lgkmcnt(4)
  v_mfma_f32_32x32x16_bf16 v[208:223], v[128:131], a[224:227], v[208:223]
  v_mul_f32 v186, v186, v106
  v_and_b32 v189, 0xffff0000, v78
  v_lshlrev_b32 v188, 16, v78
  v_mul_f32 v189, v189, v109
  v_mul_f32 v188, v188, v108
  v_mfma_f32_32x32x16_bf16 v[208:223], v[132:135], a[228:231], v[208:223]
  buffer_load_dwordx4 v6, s[24:27], s59 offen offset:3072 lds
  v_mfma_f32_32x32x16_bf16 v[208:223], v[136:139], a[232:235], v[208:223]
  v_and_b32 v191, 0xffff0000, v79
  v_lshlrev_b32 v190, 16, v79
  v_mul_f32 v191, v191, v111
  s_waitcnt lgkmcnt(0)
  s_barrier
  v_mfma_f32_32x32x16_bf16 v[208:223], v[140:143], a[236:239], v[208:223]
  s_add_u32 m0, s66, 114688
  v_add_u32 v6, s82, v8
  s_add_u32 s82, s82, 65536
  s_cmp_eq_u32 s82, 458752
  s_cselect_b32 s82, 0, s82
  v_mfma_f32_32x32x16_bf16 v[208:223], v[144:147], a[240:243], v[208:223]
  s_waitcnt vmcnt(19)
  s_sub_u32 s77, s85, 1048576
  v_mov_b32 v18, s44
  v_mfma_f32_32x32x16_bf16 v[208:223], v[148:151], a[244:247], v[208:223]
  buffer_store_dword v18, v249, s[36:39], s77 offen sc1
  buffer_load_dwordx4 v6, s[24:27], 0 offen lds
  buffer_load_dwordx4 v6, s[24:27], s57 offen offset:1024 lds
  v_mfma_f32_32x32x16_bf16 v[208:223], v[152:155], a[248:251], v[208:223]
  buffer_load_dwordx4 v6, s[24:27], s58 offen offset:2048 lds
  v_mul_f32 v190, v190, v110
  v_mfma_f32_32x32x16_bf16 v[208:223], v[156:159], a[252:255], v[208:223]
  buffer_load_dwordx4 v6, s[24:27], s59 offen offset:3072 lds
  s_nop 10
  v_fma_f32 v208, v208, v96, v176
  v_fma_f32 v209, v209, v97, v177
  v_fma_f32 v210, v210, v98, v178
  v_fma_f32 v211, v211, v99, v179
  v_fma_f32 v212, v212, v100, v180
  v_fma_f32 v213, v213, v101, v181
  v_fma_f32 v214, v214, v102, v182
  v_fma_f32 v215, v215, v103, v183
  v_cvt_pk_bf16_f32 v208, v208, v209
  v_cvt_pk_bf16_f32 v209, v210, v211
  v_cvt_pk_bf16_f32 v210, v212, v213
  v_cvt_pk_bf16_f32 v211, v214, v215
  buffer_store_dwordx4 v[208:211], v0, s[36:39], s86 offen offset:2048 sc1
  v_fma_f32 v216, v216, v104, v184
  v_fma_f32 v217, v217, v105, v185
  v_fma_f32 v218, v218, v106, v186
  v_fma_f32 v219, v219, v107, v187
  v_fma_f32 v220, v220, v108, v188
  v_fma_f32 v221, v221, v109, v189
  v_fma_f32 v222, v222, v110, v190
  v_fma_f32 v223, v223, v111, v191
  v_cvt_pk_bf16_f32 v216, v216, v217
  v_cvt_pk_bf16_f32 v217, v218, v219
  v_cvt_pk_bf16_f32 v218, v220, v221
  v_cvt_pk_bf16_f32 v219, v222, v223
  buffer_store_dwordx4 v[216:219], v0, s[36:39], s86 offen offset:3072 sc1
  s_add_u32 s79, s84, s81
  s_add_u32 s81, s81, 4096
  s_and_b32 s81, s81, 0x3fff
  buffer_load_dwordx4 a[16:19], v0, s[36:39], s79 offen sc1
  buffer_load_dwordx4 a[20:23], v0, s[36:39], s79 offen offset:1024 sc1
  buffer_load_dwordx4 a[24:27], v0, s[36:39], s79 offen offset:2048 sc1
  buffer_load_dwordx4 a[28:31], v0, s[36:39], s79 offen offset:3072 sc1
  s_add_u32 s79, s84, s81
  s_add_u32 s81, s81, 4096
  s_and_b32 s81, s81, 0x3fff
  buffer_load_dwordx4 a[32:35], v0, s[36:39], s79 offen sc1
  buffer_load_dwordx4 a[36:39], v0, s[36:39], s79 offen offset:1024 sc1
  buffer_load_dwordx4 a[40:43], v0, s[36:39], s79 offen offset:2048 sc1
  buffer_load_dwordx4 a[44:47], v0, s[36:39], s79 offen offset:3072 sc1
  s_add_u32 s79, s84, s81
  s_add_u32 s81, s81, 4096
  s_and_b32 s81, s81, 0x3fff
  buffer_load_dwordx4 a[48:51], v0, s[36:39], s79 offen sc1
  buffer_load_dwordx4 a[52:55], v0, s[36:39], s79 offen offset:1024 sc1
  buffer_load_dwordx4 a[56:59], v0, s[36:39], s79 offen offset:2048 sc1
  buffer_load_dwordx4 a[60:63], v0, s[36:39], s79 offen offset:3072 sc1
L_p3:
  v_bfe_u32 v251, v0, 4, 3
  v_min_u32 v251, 6, v251
  v_lshlrev_b32 v251, 8, v251
  s_lshl_b32 s78, s67, 4
  s_mul_i32 s77, s68, 7
  s_add_u32 s78, s78, s77
  s_lshl_b32 s78, s78, 8
  s_add_u32 s84, s78, 27262976
  s_add_u32 s78, s78, 26214400
  v_add_u32 v251, s78, v251
  buffer_load_dword v250, v251, s[36:39], 0 offen sc1
  s_mul_i32 s78, s67, 56
  s_mul_i32 s77, s68, 28
  s_add_u32 s78, s78, s77
  s_lshl_b32 s78, s78, 10
  s_add_u32 s61, s78, 20971520
  s_waitcnt vmcnt(24)
  s_barrier
  v_add_u32 v5, 0x20000, v5
  ds_read_b64_tr_b16 v[128:129], v5 offset:16384
  ds_read_b64_tr_b16 v[130:131], v5 offset:17408
  ds_read_b64_tr_b16 v[132:133], v5 offset:16896
  ds_read_b64_tr_b16 v[134:135], v5 offset:17920
  ds_read_b64_tr_b16 v[136:137], v5 offset:18432
  ds_read_b64_tr_b16 v[138:139], v5 offset:19456
  ds_read_b64_tr_b16 v[140:141], v5 offset:18944
  ds_read_b64_tr_b16 v[142:143], v5 offset:19968
  ds_read_b64_tr_b16 v[144:145], v5 offset:20480
  ds_read_b64_tr_b16 v[146:147], v5 offset:21504
  ds_read_b64_tr_b16 v[148:149], v5 offset:20992
  ds_read_b64_tr_b16 v[150:151], v5 offset:22016
  ds_read_b64_tr_b16 v[152:153], v5 offset:22528
  ds_read_b64_tr_b16 v[154:155], v5 offset:23552
  ds_read_b64_tr_b16 v[156:157], v5 offset:23040
  ds_read_b64_tr_b16 v[158:159], v5 offset:24064
  s_waitcnt vmcnt(16) lgkmcnt(12)
  v_mfma_f32_32x32x16_bf16 v[48:63], v[128:131], a[0:3], 0
  v_add_u32 v5, 0xfffe0000, v5
  v_mfma_f32_32x32x16_bf16 v[64:79], v[132:135], a[0:3], 0
  ds_read_b64_tr_b16 v[128:129], v5
  ds_read_b64_tr_b16 v[130:131], v5 offset:1024
  ds_read_b64_tr_b16 v[132:133], v5 offset:512
  ds_read_b64_tr_b16 v[134:135], v5 offset:1536
  s_waitcnt vmcnt(15) lgkmcnt(12)
  v_mfma_f32_32x32x16_bf16 v[48:63], v[136:139], a[4:7], v[48:63]
  v_mfma_f32_32x32x16_bf16 v[64:79], v[140:143], a[4:7], v[64:79]
  s_waitcnt lgkmcnt(4)
  s_barrier
  s_add_u32 m0, s66, 147456
  v_add_u32 v6, s82, v8
  s_add_u32 s82, s82, 65536
  s_cmp_eq_u32 s82, 458752
  s_cselect_b32 s82, 0, s82
  buffer_load_dwordx4 v6, s[24:27], 0 offen lds
  buffer_load_dwordx4 v6, s[24:27], s57 offen offset:1024 lds
  buffer_load_dwordx4 v6, s[24:27], s58 offen offset:2048 lds
  buffer_load_dwordx4 v6, s[24:27], s59 offen offset:3072 lds
  ds_read_b64_tr_b16 v[136:137], v5 offset:2048
  ds_read_b64_tr_b16 v[138:139], v5 offset:3072
  ds_read_b64_tr_b16 v[140:141], v5 offset:2560
  ds_read_b64_tr_b16 v[142:143], v5 offset:3584
  s_waitcnt vmcnt(18)
  v_mfma_f32_32x32x16_bf16 v[48:63], v[144:147], a[8:11], v[48:63]
  ds_read_b64_tr_b16 v[144:145], v5 offset:4096
  ds_read_b64_tr_b16 v[146:147], v5 offset:5120
  v_mfma_f32_32x32x16_bf16 v[64:79], v[148:151], a[8:11], v[64:79]
  ds_read_b64_tr_b16 v[148:149], v5 offset:4608
  ds_read_b64_tr_b16 v[150:151], v5 offset:5632
  s_waitcnt vmcnt(17)
  v_mfma_f32_32x32x16_bf16 v[48:63], v[152:155], a[12:15], v[48:63]
  ds_read_b64_tr_b16 v[152:153], v5 offset:6144
  ds_read_b64_tr_b16 v[154:155], v5 offset:7168
  v_mfma_f32_32x32x16_bf16 v[64:79], v[156:159], a[12:15], v[64:79]
  ds_read_b64_tr_b16 v[156:157], v5 offset:6656
  ds_read_b64_tr_b16 v[158:159], v5 offset:7680
  s_waitcnt vmcnt(16) lgkmcnt(12)
  v_mfma_f32_32x32x16_bf16 v[48:63], v[128:131], a[16:19], v[48:63]
  ds_read_b64_tr_b16 v[128:129], v5 offset:49152
  ds_read_b64_tr_b16 v[130:131], v5 offset:50176
  v_mfma_f32_32x32x16_bf16 v[64:79], v[132:135], a[16:19], v[64:79]
  ds_read_b64_tr_b16 v[132:133], v5 offset:49664
  ds_read_b64_tr_b16 v[134:135], v5 offset:50688
  s_waitcnt vmcnt(15) lgkmcnt(12)
  v_mfma_f32_32x32x16_bf16 v[48:63], v[136:139], a[20:23], v[48:63]
  ds_read_b64_tr_b16 v[136:137], v5 offset:51200
  ds_read_b64_tr_b16 v[138:139], v5 offset:52224
  v_mfma_f32_32x32x16_bf16 v[64:79], v[140:143], a[20:23], v[64:79]
  ds_read_b64_tr_b16 v[140:141], v5 offset:51712
  ds_read_b64_tr_b16 v[142:143], v5 offset:52736
  s_sub_u32 s77, s85, 786432
  v_mov_b32 v18, s44
  s_waitcnt vmcnt(14) lgkmcnt(12)
  v_mfma_f32_32x32x16_bf16 v[48:63], v[144:147], a[24:27], v[48:63]
  buffer_store_dword v18, v249, s[36:39], s77 offen sc1
  ds_read_b64_tr_b16 v[144:145], v5 offset:53248
  ds_read_b64_tr_b16 v[146:147], v5 offset:54272
  v_mfma_f32_32x32x16_bf16 v[64:79], v[148:151], a[24:27], v[64:79]
  ds_read_b64_tr_b16 v[148:149], v5 offset:53760
  ds_read_b64_tr_b16 v[150:151], v5 offset:54784
  s_waitcnt vmcnt(5)
  v_cmp_ne_u32 s[74:75], s44, v250
  s_nop 1
  s_cmp_lg_u64 s[74:75], 0
  s_cbranch_scc1 L_slow_23
L_back_24:
  v_add_u32 v251, 262144, v251
  s_add_u32 s62, s61, s83
  s_add_u32 s83, s83, 4096
  s_cmp_eq_u32 s83, 28672
  s_cselect_b32 s83, 0, s83
  buffer_load_dwordx4 a[64:67], v0, s[36:39], s62 offen sc1
  buffer_load_dwordx4 a[68:71], v0, s[36:39], s62 offen offset:1024 sc1
  s_waitcnt lgkmcnt(12)
  v_mfma_f32_32x32x16_bf16 v[48:63], v[152:155], a[28:31], v[48:63]
  ds_read_b64_tr_b16 v[152:153], v5 offset:55296
  ds_read_b64_tr_b16 v[154:155], v5 offset:56320
  v_mfma_f32_32x32x16_bf16 v[64:79], v[156:159], a[28:31], v[64:79]
  s_add_u32 s62, s61, s83
  buffer_load_dwordx4 a[72:75], v0, s[36:39], s62 offen sc1
  buffer_load_dwordx4 a[76:79], v0, s[36:39], s62 offen offset:1024 sc1
  ds_read_b64_tr_b16 v[156:157], v5 offset:55808
  ds_read_b64_tr_b16 v[158:159], v5 offset:56832
  s_add_u32 s83, s83, 4096
  s_cmp_eq_u32 s83, 28672
  s_cselect_b32 s83, 0, s83
  s_waitcnt lgkmcnt(12)
  v_mfma_f32_32x32x16_bf16 v[48:63], v[128:131], a[32:35], v[48:63]
  v_add_u32 v5, 0x10000, v5
  v_mfma_f32_32x32x16_bf16 v[64:79], v[132:135], a[32:35], v[64:79]
  s_add_u32 s62, s61, s83
  buffer_load_dwordx4 a[80:83], v0, s[36:39], s62 offen sc1
  buffer_load_dwordx4 a[84:87], v0, s[36:39], s62 offen offset:1024 sc1
  ds_read_b64_tr_b16 v[128:129], v5
  ds_read_b64_tr_b16 v[130:131], v5 offset:1024
  ds_read_b64_tr_b16 v[132:133], v5 offset:512
  ds_read_b64_tr_b16 v[134:135], v5 offset:1536
  s_add_u32 s83, s83, 4096
  s_cmp_eq_u32 s83, 28672
  s_cselect_b32 s83, 0, s83
  s_waitcnt lgkmcnt(12)
  v_mfma_f32_32x32x16_bf16 v[48:63], v[136:139], a[36:39], v[48:63]
  ds_read_b64_tr_b16 v[136:137], v5 offset:2048
  ds_read_b64_tr_b16 v[138:139], v5 offset:3072
  v_mfma_f32_32x32x16_bf16 v[64:79], v[140:143], a[36:39], v[64:79]
  s_add_u32 s62, s61, s83
  buffer_load_dwordx4 a[88:91], v0, s[36:39], s62 offen sc1
  buffer_load_dwordx4 a[92:95], v0, s[36:39], s62 offen offset:1024 sc1
  ds_read_b64_tr_b16 v[140:141], v5 offset:2560
  ds_read_b64_tr_b16 v[142:143], v5 offset:3584
  s_add_u32 s83, s83, 4096
  s_cmp_eq_u32 s83, 28672
  s_cselect_b32 s83, 0, s83
  s_waitcnt lgkmcnt(12)
  v_mfma_f32_32x32x16_bf16 v[48:63], v[144:147], a[40:43], v[48:63]
  ds_read_b64_tr_b16 v[144:145], v5 offset:4096
  ds_read_b64_tr_b16 v[146:147], v5 offset:5120
  v_mfma_f32_32x32x16_bf16 v[64:79], v[148:151], a[40:43], v[64:79]
  s_add_u32 s62, s61, s83
  buffer_load_dwordx4 a[96:99], v0, s[36:39], s62 offen sc1
  buffer_load_dwordx4 a[100:103], v0, s[36:39], s62 offen offset:1024 sc1
  ds_read_b64_tr_b16 v[148:149], v5 offset:4608
  ds_read_b64_tr_b16 v[150:151], v5 offset:5632
  s_add_u32 s83, s83, 4096
  s_cmp_eq_u32 s83, 28672
  s_cselect_b32 s83, 0, s83
  s_waitcnt lgkmcnt(12)
  v_mfma_f32_32x32x16_bf16 v[48:63], v[152:155], a[44:47], v[48:63]
  ds_read_b64_tr_b16 v[152:153], v5 offset:6144
  ds_read_b64_tr_b16 v[154:155], v5 offset:7168
  v_mfma_f32_32x32x16_bf16 v[64:79], v[156:159], a[44:47], v[64:79]
  s_add_u32 s62, s61, s83
  buffer_load_dwordx4 a[104:107], v0, s[36:39], s62 offen sc1
  buffer_load_dwordx4 a[108:111], v0, s[36:39], s62 offen offset:1024 sc1
  ds_read_b64_tr_b16 v[156:157], v5 offset:6656
  ds_read_b64_tr_b16 v[158:159], v5 offset:7680
  s_add_u32 s83, s83, 4096
  s_cmp_eq_u32 s83, 28672
  s_cselect_b32 s83, 0, s83
  s_waitcnt lgkmcnt(12)
  v_mfma_f32_32x32x16_bf16 v[48:63], v[128:131], a[48:51], v[48:63]
  v_add_u32 v5, 0xffff0000, v5
  v_mfma_f32_32x32x16_bf16 v[64:79], v[132:135], a[48:51], v[64:79]
  s_add_u32 s62, s61, s83
  buffer_load_dwordx4 a[112:115], v0, s[36:39], s62 offen sc1
  buffer_load_dwordx4 a[116:119], v0, s[36:39], s62 offen offset:1024 sc1
  ds_read_b64_tr_b16 v[128:129], v5 offset:32768
  ds_read_b64_tr_b16 v[130:131], v5 offset:33792
  ds_read_b64_tr_b16 v[132:133], v5 offset:33280
  ds_read_b64_tr_b16 v[134:135], v5 offset:34304
  s_add_u32 s83, s83, 4096
  s_cmp_eq_u32 s83, 28672
  s_cselect_b32 s83, 0, s83
  s_waitcnt lgkmcnt(12)
  v_mfma_f32_32x32x16_bf16 v[48:63], v[136:139], a[52:55], v[48:63]
  ds_read_b64_tr_b16 v[136:137], v5 offset:34816
  ds_read_b64_tr_b16 v[138:139], v5 offset:35840
  v_mfma_f32_32x32x16_bf16 v[64:79], v[140:143], a[52:55], v[64:79]
  ds_read_b64_tr_b16 v[140:141], v5 offset:35328
  ds_read_b64_tr_b16 v[142:143], v5 offset:36352
  s_waitcnt lgkmcnt(12)
  v_mfma_f32_32x32x16_bf16 v[48:63], v[144:147], a[56:59], v[48:63]
  v_add_u32 v5, 0x10000, v5
  v_mfma_f32_32x32x16_bf16 v[64:79], v[148:151], a[56:59], v[64:79]
  ds_read_b64_tr_b16 v[144:145], v5 offset:16384
  ds_read_b64_tr_b16 v[146:147], v5 offset:17408
  ds_read_b64_tr_b16 v[148:149], v5 offset:16896
  ds_read_b64_tr_b16 v[150:151], v5 offset:17920
  s_waitcnt lgkmcnt(12)
  v_mfma_f32_32x32x16_bf16 v[48:63], v[152:155], a[60:63], v[48:63]
  ds_read_b64_tr_b16 v[152:153], v5 offset:18432
  ds_read_b64_tr_b16 v[154:155], v5 offset:19456
  v_mfma_f32_32x32x16_bf16 v[64:79], v[156:159], a[60:63], v[64:79]
  ds_read_b64_tr_b16 v[156:157], v5 offset:18944
  ds_read_b64_tr_b16 v[158:159], v5 offset:19968
  s_waitcnt vmcnt(13) lgkmcnt(12)
  v_mfma_f32_32x32x16_bf16 v[80:95], v[128:131], a[64:67], v[48:63]
  v_add_u32 v5, 0x10000, v5
  v_mfma_f32_32x32x16_bf16 v[96:111], v[132:135], a[64:67], v[64:79]
  ds_read_b64_tr_b16 v[128:129], v5
  ds_read_b64_tr_b16 v[130:131], v5 offset:1024
  ds_read_b64_tr_b16 v[132:133], v5 offset:512
  ds_read_b64_tr_b16 v[134:135], v5 offset:1536
  s_waitcnt vmcnt(12) lgkmcnt(12)
  v_mfma_f32_32x32x16_bf16 v[80:95], v[136:139], a[68:71], v[80:95]
  v_mfma_f32_32x32x16_bf16 v[96:111], v[140:143], a[68:71], v[96:111]
  s_barrier
  ds_read_b64_tr_b16 v[136:137], v5 offset:2048
  ds_read_b64_tr_b16 v[138:139], v5 offset:3072
  ds_read_b64_tr_b16 v[140:141], v5 offset:2560
  ds_read_b64_tr_b16 v[142:143], v5 offset:3584
  s_waitcnt vmcnt(11) lgkmcnt(12)
  v_mfma_f32_32x32x16_bf16 v[80:95], v[144:147], a[72:75], v[80:95]
  v_add_u32 v5, 0xfffe0000, v5
  v_mfma_f32_32x32x16_bf16 v[96:111], v[148:151], a[72:75], v[96:111]
  ds_read_b64_tr_b16 v[144:145], v5 offset:16384
  ds_read_b64_tr_b16 v[146:147], v5 offset:17408
  ds_read_b64_tr_b16 v[148:149], v5 offset:16896
  ds_read_b64_tr_b16 v[150:151], v5 offset:17920
  s_waitcnt vmcnt(10) lgkmcnt(12)
  v_mfma_f32_32x32x16_bf16 v[80:95], v[152:155], a[76:79], v[80:95]
  ds_read_b64_tr_b16 v[152:153], v5 offset:18432
  ds_read_b64_tr_b16 v[154:155], v5 offset:19456
  v_mfma_f32_32x32x16_bf16 v[96:111], v[156:159], a[76:79], v[96:111]
  ds_read_b64_tr_b16 v[156:157], v5 offset:18944
  ds_read_b64_tr_b16 v[158:159], v5 offset:19968
  s_waitcnt vmcnt(9) lgkmcnt(12)
  v_mfma_f32_32x32x16_bf16 v[80:95], v[128:131], a[80:83], v[80:95]
  v_add_u32 v5, 0x10000, v5
  v_mfma_f32_32x32x16_bf16 v[96:111], v[132:135], a[80:83], v[96:111]
  buffer_load_dword v250, v251, s[36:39], 0 offen sc1
  ds_read_b64_tr_b16 v[128:129], v5 offset:32768
  ds_read_b64_tr_b16 v[130:131], v5 offset:33792
  ds_read_b64_tr_b16 v[132:133], v5 offset:33280
  ds_read_b64_tr_b16 v[134:135], v5 offset:34304
  s_waitcnt vmcnt(9) lgkmcnt(12)
  v_mfma_f32_32x32x16_bf16 v[80:95], v[136:139], a[84:87], v[80:95]
  ds_read_b64_tr_b16 v[136:137], v5 offset:34816
  ds_read_b64_tr_b16 v[138:139], v5 offset:35840
  v_mfma_f32_32x32x16_bf16 v[96:111], v[140:143], a[84:87], v[96:111]
  ds_read_b64_tr_b16 v[140:141], v5 offset:35328
  ds_read_b64_tr_b16 v[142:143], v5 offset:36352
  s_waitcnt vmcnt(8) lgkmcnt(12)
  v_mfma_f32_32x32x16_bf16 v[80:95], v[144:147], a[88:91], v[80:95]
  ds_read_b64_tr_b16 v[144:145], v5 offset:49152
  ds_read_b64_tr_b16 v[146:147], v5 offset:50176
  v_mfma_f32_32x32x16_bf16 v[96:111], v[148:151], a[88:91], v[96:111]
  ds_read_b64_tr_b16 v[148:149], v5 offset:49664
  ds_read_b64_tr_b16 v[150:151], v5 offset:50688
  s_waitcnt vmcnt(7) lgkmcnt(12)
  v_mfma_f32_32x32x16_bf16 v[80:95], v[152:155], a[92:95], v[80:95]
  ds_read_b64_tr_b16 v[152:153], v5 offset:51200
  ds_read_b64_tr_b16 v[154:155], v5 offset:52224
  v_mfma_f32_32x32x16_bf16 v[96:111], v[156:159], a[92:95], v[96:111]
  ds_read_b64_tr_b16 v[156:157], v5 offset:51712
  ds_read_b64_tr_b16 v[158:159], v5 offset:52736
  s_waitcnt vmcnt(6) lgkmcnt(12)
  v_mfma_f32_32x32x16_bf16 v[80:95], v[128:131], a[96:99], v[80:95]
  v_add_u32 v5, 0x10000, v5
  v_mfma_f32_32x32x16_bf16 v[96:111], v[132:135], a[96:99], v[96:111]
  ds_read_b64_tr_b16 v[128:129], v5 offset:16384
  ds_read_b64_tr_b16 v[130:131], v5 offset:17408
  ds_read_b64_tr_b16 v[132:133], v5 offset:16896
  ds_read_b64_tr_b16 v[134:135], v5 offset:17920
  s_waitcnt vmcnt(0)
  v_cmp_ne_u32 s[74:75], s44, v250
  s_nop 1
  s_cmp_lg_u64 s[74:75], 0
  s_cbranch_scc1 L_slow_26
L_back_27:
  s_add_u32 s62, s61, s83
  s_add_u32 s83, s83, 4096
  s_cmp_eq_u32 s83, 28672
  s_cselect_b32 s83, 0, s83
  buffer_load_dwordx4 a[120:123], v0, s[36:39], s62 offen offset:2048 sc1
  buffer_load_dwordx4 a[124:127], v0, s[36:39], s62 offen offset:3072 sc1
  s_waitcnt lgkmcnt(12)
  v_mfma_f32_32x32x16_bf16 v[80:95], v[136:139], a[100:103], v[80:95]
  ds_read_b64_tr_b16 v[136:137], v5 offset:18432
  ds_read_b64_tr_b16 v[138:139], v5 offset:19456
  v_mfma_f32_32x32x16_bf16 v[96:111], v[140:143], a[100:103], v[96:111]
  s_add_u32 s62, s61, s83
  buffer_load_dwordx4 a[128:131], v0, s[36:39], s62 offen offset:2048 sc1
  buffer_load_dwordx4 a[132:135], v0, s[36:39], s62 offen offset:3072 sc1
  ds_read_b64_tr_b16 v[140:141], v5 offset:18944
  ds_read_b64_tr_b16 v[142:143], v5 offset:19968
  s_add_u32 s83, s83, 4096
  s_cmp_eq_u32 s83, 28672
  s_cselect_b32 s83, 0, s83
  s_waitcnt lgkmcnt(12)
  v_mfma_f32_32x32x16_bf16 v[80:95], v[144:147], a[104:107], v[80:95]
  v_add_u32 v5, 0xfffe0000, v5
  v_mfma_f32_32x32x16_bf16 v[96:111], v[148:151], a[104:107], v[96:111]
  s_add_u32 s62, s61, s83
  buffer_load_dwordx4 a[136:139], v0, s[36:39], s62 offen offset:2048 sc1
  buffer_load_dwordx4 a[140:143], v0, s[36:39], s62 offen offset:3072 sc1
  ds_read_b64_tr_b16 v[144:145], v5 offset:36864
  ds_read_b64_tr_b16 v[146:147], v5 offset:37888
  ds_read_b64_tr_b16 v[148:149], v5 offset:37376
  ds_read_b64_tr_b16 v[150:151], v5 offset:38400
  s_add_u32 s83, s83, 4096
  s_cmp_eq_u32 s83, 28672
  s_cselect_b32 s83, 0, s83
  s_waitcnt lgkmcnt(12)
  v_mfma_f32_32x32x16_bf16 v[80:95], v[152:155], a[108:111], v[80:95]
  ds_read_b64_tr_b16 v[152:153], v5 offset:38912
  ds_read_b64_tr_b16 v[154:155], v5 offset:39936
  v_mfma_f32_32x32x16_bf16 v[96:111], v[156:159], a[108:111], v[96:111]
  s_add_u32 s62, s61, s83
  buffer_load_dwordx4 a[144:147], v0, s[36:39], s62 offen offset:2048 sc1
  buffer_load_dwordx4 a[148:151], v0, s[36:39], s62 offen offset:3072 sc1
  ds_read_b64_tr_b16 v[156:157], v5 offset:39424
  ds_read_b64_tr_b16 v[158:159], v5 offset:40448
  s_add_u32 s83, s83, 4096
  s_cmp_eq_u32 s83, 28672
  s_cselect_b32 s83, 0, s83
  s_waitcnt lgkmcnt(12)
  v_mfma_f32_32x32x16_bf16 v[80:95], v[128:131], a[112:115], v[80:95]
  v_add_u32 v5, 0x10000, v5
  v_mfma_f32_32x32x16_bf16 v[96:111], v[132:135], a[112:115], v[96:111]
  s_add_u32 s62, s61, s83
  buffer_load_dwordx4 a[152:155], v0, s[36:39], s62 offen offset:2048 sc1
  buffer_load_dwordx4 a[156:159], v0, s[36:39], s62 offen offset:3072 sc1
  ds_read_b64_tr_b16 v[128:129], v5 offset:20480
  ds_read_b64_tr_b16 v[130:131], v5 offset:21504
  ds_read_b64_tr_b16 v[132:133], v5 offset:20992
  ds_read_b64_tr_b16 v[134:135], v5 offset:22016
  s_add_u32 s83, s83, 4096
  s_cmp_eq_u32 s83, 28672
  s_cselect_b32 s83, 0, s83
  s_waitcnt lgkmcnt(12)
  v_mfma_f32_32x32x16_bf16 v[80:95], v[136:139], a[116:119], v[80:95]
  ds_read_b64_tr_b16 v[136:137], v5 offset:22528
  ds_read_b64_tr_b16 v[138:139], v5 offset:23552
  v_mfma_f32_32x32x16_bf16 v[96:111], v[140:143], a[116:119], v[96:111]
  s_add_u32 s62, s61, s83
  buffer_load_dwordx4 a[160:163], v0, s[36:39], s62 offen offset:2048 sc1
  buffer_load_dwordx4 a[164:167], v0, s[36:39], s62 offen offset:3072 sc1
  ds_read_b64_tr_b16 v[140:141], v5 offset:23040
  ds_read_b64_tr_b16 v[142:143], v5 offset:24064
  s_add_u32 s83, s83, 4096
  s_cmp_eq_u32 s83, 28672
  s_cselect_b32 s83, 0, s83
  s_add_u32 s84, s84, 262144
  v_bfe_u32 v16, v0, 4, 4
  v_lshrrev_b32 v17, 9, v0
  v_xor_b32 v16, v16, v17
  v_lshlrev_b32 v16, 4, v16
  v_and_b32 v17, 0x1f0, v0
  v_lshl_add_u32 v16, v17, 4, v16
  s_and_b32 s77, s43, 1
  s_lshl_b32 s77, s77, 13
  s_mul_i32 s79, s68, 49152
  s_add_u32 s77, s77, s79
  s_add_u32 s77, s77, 0
  v_add_u32 v32, s77, v16
  v_xor_b32 v33, 32, v32
  v_xor_b32 v34, 64, v32
  v_xor_b32 v35, 96, v32
  v_xor_b32 v36, 128, v32
  v_xor_b32 v37, 160, v32
  v_xor_b32 v38, 192, v32
  v_xor_b32 v39, 224, v32
  v_lshrrev_b32 v16, 7, v0
  s_lshl_b32 s77, s43, 3
  v_add_u32 v16, s77, v16
  v_and_b32 v17, 15, v16
  v_bfe_u32 v18, v0, 4, 3
  v_lshlrev_b32 v18, 1, v18
  v_xor_b32 v17, v17, v18
  v_lshlrev_b32 v17, 4, v17
  v_lshl_add_u32 v16, v16, 8, v17
  v_add_u32 v40, 0, v16
  v_xor_b32 v41, 16, v40
  s_waitcnt vmcnt(11) lgkmcnt(12)
  v_mfma_f32_32x32x16_bf16 v[48:63], v[144:147], a[120:123], v[80:95]
  v_add_u32 v5, 0x10000, v5
  v_mfma_f32_32x32x16_bf16 v[64:79], v[148:151], a[120:123], v[96:111]
  s_add_u32 s62, s61, s83
  buffer_load_dwordx4 a[168:171], v0, s[36:39], s62 offen offset:2048 sc1
  buffer_load_dwordx4 a[172:175], v0, s[36:39], s62 offen offset:3072 sc1
  ds_read_b64_tr_b16 v[144:145], v5 offset:4096
  ds_read_b64_tr_b16 v[146:147], v5 offset:5120
  ds_read_b64_tr_b16 v[148:149], v5 offset:4608
  ds_read_b64_tr_b16 v[150:151], v5 offset:5632
  s_add_u32 s83, s83, 4096
  s_cmp_eq_u32 s83, 28672
  s_cselect_b32 s83, 0, s83
  s_waitcnt vmcnt(12) lgkmcnt(12)
  v_mfma_f32_32x32x16_bf16 v[48:63], v[152:155], a[124:127], v[48:63]
  ds_read_b64_tr_b16 v[152:153], v5 offset:6144
  ds_read_b64_tr_b16 v[154:155], v5 offset:7168
  v_mfma_f32_32x32x16_bf16 v[64:79], v[156:159], a[124:127], v[64:79]
  ds_read_b64_tr_b16 v[156:157], v5 offset:6656
  ds_read_b64_tr_b16 v[158:159], v5 offset:7680
  s_waitcnt vmcnt(11) lgkmcnt(12)
  v_mfma_f32_32x32x16_bf16 v[48:63], v[128:131], a[128:131], v[48:63]
  v_add_u32 v5, 0xfffe0000, v5
  v_mfma_f32_32x32x16_bf16 v[64:79], v[132:135], a[128:131], v[64:79]
  ds_read_b64_tr_b16 v[128:129], v5 offset:20480
  ds_read_b64_tr_b16 v[130:131], v5 offset:21504
  ds_read_b64_tr_b16 v[132:133], v5 offset:20992
  ds_read_b64_tr_b16 v[134:135], v5 offset:22016
  s_waitcnt vmcnt(10) lgkmcnt(12)
  v_mfma_f32_32x32x16_bf16 v[48:63], v[136:139], a[132:135], v[48:63]
  ds_read_b64_tr_b16 v[136:137], v5 offset:22528
  ds_read_b64_tr_b16 v[138:139], v5 offset:23552
  v_mfma_f32_32x32x16_bf16 v[64:79], v[140:143], a[132:135], v[64:79]
  ds_read_b64_tr_b16 v[140:141], v5 offset:23040
  ds_read_b64_tr_b16 v[142:143], v5 offset:24064
  s_waitcnt vmcnt(9) lgkmcnt(12)
  v_mfma_f32_32x32x16_bf16 v[48:63], v[144:147], a[136:139], v[48:63]
  v_add_u32 v5, 0x10000, v5
  v_mfma_f32_32x32x16_bf16 v[64:79], v[148:151], a[136:139], v[64:79]
  ds_read_b64_tr_b16 v[144:145], v5 offset:36864
  ds_read_b64_tr_b16 v[146:147], v5 offset:37888
  ds_read_b64_tr_b16 v[148:149], v5 offset:37376
  ds_read_b64_tr_b16 v[150:151], v5 offset:38400
  s_waitcnt vmcnt(8) lgkmcnt(12)
  v_mfma_f32_32x32x16_bf16 v[48:63], v[152:155], a[140:143], v[48:63]
  ds_read_b64_tr_b16 v[152:153], v5 offset:38912
  ds_read_b64_tr_b16 v[154:155], v5 offset:39936
  v_mfma_f32_32x32x16_bf16 v[64:79], v[156:159], a[140:143], v[64:79]
  ds_read_b64_tr_b16 v[156:157], v5 offset:39424
  ds_read_b64_tr_b16 v[158:159], v5 offset:40448
  s_waitcnt vmcnt(7) lgkmcnt(12)
  v_mfma_f32_32x32x16_bf16 v[48:63], v[128:131], a[144:147], v[48:63]
  ds_read_b64_tr_b16 v[128:129], v5 offset:53248
  ds_read_b64_tr_b16 v[130:131], v5 offset:54272
  v_mfma_f32_32x32x16_bf16 v[64:79], v[132:135], a[144:147], v[64:79]
  ds_read_b64_tr_b16 v[132:133], v5 offset:53760
  ds_read_b64_tr_b16 v[134:135], v5 offset:54784
  s_waitcnt vmcnt(6) lgkmcnt(12)
  v_mfma_f32_32x32x16_bf16 v[48:63], v[136:139], a[148:151], v[48:63]
  ds_read_b64_tr_b16 v[136:137], v5 offset:55296
  ds_read_b64_tr_b16 v[138:139], v5 offset:56320
  v_mfma_f32_32x32x16_bf16 v[64:79], v[140:143], a[148:151], v[64:79]
  ds_read_b64_tr_b16 v[140:141], v5 offset:55808
  ds_read_b64_tr_b16 v[142:143], v5 offset:56832
  s_waitcnt vmcnt(5) lgkmcnt(12)
  v_mfma_f32_32x32x16_bf16 v[48:63], v[144:147], a[152:155], v[48:63]
  v_add_u32 v5, 0x10000, v5
  v_mfma_f32_32x32x16_bf16 v[64:79], v[148:151], a[152:155], v[64:79]
  ds_read_b64_tr_b16 v[144:145], v5 offset:20480
  ds_read_b64_tr_b16 v[146:147], v5 offset:21504
  ds_read_b64_tr_b16 v[148:149], v5 offset:20992
  ds_read_b64_tr_b16 v[150:151], v5 offset:22016
  s_waitcnt vmcnt(4) lgkmcnt(12)
  v_mfma_f32_32x32x16_bf16 v[48:63], v[152:155], a[156:159], v[48:63]
  ds_read_b64_tr_b16 v[152:153], v5 offset:22528
  ds_read_b64_tr_b16 v[154:155], v5 offset:23552
  v_mfma_f32_32x32x16_bf16 v[64:79], v[156:159], a[156:159], v[64:79]
  ds_read_b64_tr_b16 v[156:157], v5 offset:23040
  ds_read_b64_tr_b16 v[158:159], v5 offset:24064
  s_waitcnt vmcnt(3) lgkmcnt(12)
  v_mfma_f32_32x32x16_bf16 v[48:63], v[128:131], a[160:163], v[48:63]
  v_mfma_f32_32x32x16_bf16 v[64:79], v[132:135], a[160:163], v[64:79]
  s_waitcnt vmcnt(2) lgkmcnt(8)
  v_mfma_f32_32x32x16_bf16 v[48:63], v[136:139], a[164:167], v[48:63]
  v_mfma_f32_32x32x16_bf16 v[64:79], v[140:143], a[164:167], v[64:79]
  s_waitcnt vmcnt(1) lgkmcnt(4)
  v_mfma_f32_32x32x16_bf16 v[48:63], v[144:147], a[168:171], v[48:63]
  v_mfma_f32_32x32x16_bf16 v[64:79], v[148:151], a[168:171], v[64:79]
  s_waitcnt vmcnt(0) lgkmcnt(0)
  v_mfma_f32_32x32x16_bf16 v[48:63], v[152:155], a[172:175], v[48:63]
  v_mfma_f32_32x32x16_bf16 v[64:79], v[156:159], a[172:175], v[64:79]
  s_nop 10
  ds_write_b128 v32, v[48:51]
  ds_write_b128 v33, v[52:55]
  ds_write_b128 v34, v[56:59]
  ds_write_b128 v35, v[60:63]
  ds_write_b128 v36, v[64:67]
  ds_write_b128 v37, v[68:71]
  ds_write_b128 v38, v[72:75]
  ds_write_b128 v39, v[76:79]
  s_waitcnt lgkmcnt(0)
  s_barrier
  ds_read_b128 v[128:131], v40
  ds_read_b128 v[132:135], v41
  ds_read_b128 v[136:139], v40 offset:49152
  ds_read_b128 v[140:143], v41 offset:49152
  ds_read_b128 v[144:147], v40 offset:8192
  ds_read_b128 v[148:151], v41 offset:8192
  ds_read_b128 v[152:155], v40 offset:57344
  ds_read_b128 v[156:159], v41 offset:57344
  s_waitcnt lgkmcnt(4)
  v_add_f32 v128, v128, v136
  v_add_f32 v129, v129, v137
  v_add_f32 v130, v130, v138
  v_add_f32 v131, v131, v139
  v_add_f32 v132, v132, v140
  v_add_f32 v133, v133, v141
  v_add_f32 v134, v134, v142
  v_add_f32 v135, v135, v143
  v_lshlrev_b32 v136, 16, v20
  v_and_b32 v137, 0xffff0000, v20
  v_lshlrev_b32 v138, 16, v21
  v_and_b32 v139, 0xffff0000, v21
  v_lshlrev_b32 v140, 16, v22
  v_and_b32 v141, 0xffff0000, v22
  v_lshlrev_b32 v142, 16, v23
  v_and_b32 v143, 0xffff0000, v23
  v_add_f32 v128, v128, v136
  v_add_f32 v129, v129, v137
  v_add_f32 v130, v130, v138
  v_add_f32 v131, v131, v139
  v_add_f32 v132, v132, v140
  v_add_f32 v133, v133, v141
  v_add_f32 v134, v134, v142
  v_add_f32 v135, v135, v143
  v_cvt_pk_bf16_f32 v128, v128, v129
  v_cvt_pk_bf16_f32 v129, v130, v131
  v_cvt_pk_bf16_f32 v130, v132, v133
  v_cvt_pk_bf16_f32 v131, v134, v135
  buffer_store_dwordx4 v[128:131], v28, s[32:35], 0 offen
  s_waitcnt lgkmcnt(0)
  v_add_f32 v144, v144, v152
  v_add_f32 v145, v145, v153
  v_add_f32 v146, v146, v154
  v_add_f32 v147, v147, v155
  v_add_f32 v148, v148, v156
  v_add_f32 v149, v149, v157
  v_add_f32 v150, v150, v158
  v_add_f32 v151, v151, v159
  v_lshlrev_b32 v152, 16, v24
  v_and_b32 v153, 0xffff0000, v24
  v_lshlrev_b32 v154, 16, v25
  v_and_b32 v155, 0xffff0000, v25
  v_lshlrev_b32 v156, 16, v26
  v_and_b32 v157, 0xffff0000, v26
  v_lshlrev_b32 v158, 16, v27
  v_and_b32 v159, 0xffff0000, v27
  v_add_f32 v144, v144, v152
  v_add_f32 v145, v145, v153
  v_add_f32 v146, v146, v154
  v_add_f32 v147, v147, v155
  v_add_f32 v148, v148, v156
  v_add_f32 v149, v149, v157
  v_add_f32 v150, v150, v158
  v_add_f32 v151, v151, v159
  v_cvt_pk_bf16_f32 v144, v144, v145
  v_cvt_pk_bf16_f32 v145, v146, v147
  v_cvt_pk_bf16_f32 v146, v148, v149
  v_cvt_pk_bf16_f32 v147, v150, v151
  buffer_store_dwordx4 v[144:147], v29, s[32:35], 0 offen
L_end:
  s_endpgm
L_fedge:
  ds_read_b128 v[128:131], v120 offset:32768
  ds_read_b128 v[132:135], v120 offset:28672
  ds_read_b128 v[136:139], v120 offset:24576
  s_mov_b64 exec, s[70:71]
  ds_read_b128 v[224:227], v120 offset:34816
  ds_read_b128 v[228:231], v120 offset:35840
  s_mov_b64 exec, -1
  s_waitcnt lgkmcnt(4)
  v_mfma_f32_32x32x16_bf16 v[144:159], v[128:131], v[112:115], v[176:191]
  v_mov_b32 v32, 0
  v_mov_b32 v33, 0
  v_mov_b32 v34, 0
  v_mov_b32 v35, 0
  v_mov_b32 v36, 0
  v_mov_b32 v37, 0
  v_mov_b32 v38, 0
  v_mov_b32 v39, 0
  v_mov_b32 v40, 0
  v_mov_b32 v41, 0
  v_mov_b32 v42, 0
  v_mov_b32 v43, 0
  v_mov_b32 v44, 0
  v_mov_b32 v45, 0
  v_mov_b32 v46, 0
  v_mov_b32 v47, 0
  s_cmp_eq_u32 s52, 8
  s_cbranch_scc1 L_cz_32
L_czb_33:
  s_waitcnt lgkmcnt(3)
  v_mfma_f32_32x32x16_bf16 v[160:175], v[132:135], v[112:115], v[32:47]
  s_mov_b64 exec, s[70:71]
  ds_read_b128 v[232:235], v120 offset:30720
  ds_read_b128 v[236:239], v120 offset:31744
  s_mov_b64 exec, -1
  ds_read_b128 v[140:143], v120 offset:20480
  v_exp_f32 v144, v144
  v_exp_f32 v145, v145
  v_exp_f32 v146, v146
  v_exp_f32 v147, v147
  v_exp_f32 v148, v148
  v_exp_f32 v149, v149
  v_exp_f32 v150, v150
  v_exp_f32 v151, v151
  v_exp_f32 v152, v152
  v_exp_f32 v153, v153
  v_exp_f32 v154, v154
  v_exp_f32 v155, v155
  v_exp_f32 v156, v156
  v_exp_f32 v157, v157
  v_exp_f32 v158, v158
  v_exp_f32 v159, v159
  v_cvt_pk_bf16_f32 v208, v144, v145
  v_cvt_pk_bf16_f32 v209, v146, v147
  v_cvt_pk_bf16_f32 v210, v148, v149
  v_cvt_pk_bf16_f32 v211, v150, v151
  v_cvt_pk_bf16_f32 v212, v152, v153
  v_cvt_pk_bf16_f32 v213, v154, v155
  v_cvt_pk_bf16_f32 v214, v156, v157
  v_cvt_pk_bf16_f32 v215, v158, v159
  ds_read_b128 a[96:99], v5
  ds_read_b128 a[100:103], v6
  ds_read_b128 a[104:107], v7
  ds_read_b128 a[108:111], v8
  s_waitcnt lgkmcnt(0)
  s_add_u32 s61, s0, s1
  s_add_u32 s62, s61, 63488
  s_add_u32 m0, s64, 0
  s_add_u32 s1, s1, 128
  s_and_b32 s1, s1, 2047
  buffer_load_dwordx4 v3, s[16:19], s61 offen lds
  buffer_load_dwordx4 v4, s[16:19], s61 offen offset:1024 lds
  buffer_load_dwordx4 v3, s[16:19], s62 offen offset:2048 lds
  buffer_load_dwordx4 v4, s[16:19], s62 offen offset:3072 lds
  ds_read_b128 a[112:115], v5 offset:4096
  ds_read_b128 a[116:119], v6 offset:4096
  ds_read_b128 a[120:123], v7 offset:4096
  ds_read_b128 a[124:127], v8 offset:4096
  v_exp_f32 v160, v160
  v_exp_f32 v161, v161
  s_cmp_eq_u32 s52, 7
  s_cbranch_scc1 L_cz_34
L_czb_35:
  v_mfma_f32_32x32x16_bf16 v[144:159], v[136:139], v[112:115], v[32:47]
  s_waitcnt lgkmcnt(0)
  s_add_u32 s61, s0, s1
  s_add_u32 s62, s61, 63488
  s_add_u32 m0, s64, 4096
  s_nop 0
  buffer_load_dwordx4 v3, s[16:19], s61 offen lds
  s_add_u32 s1, s1, 128
  s_and_b32 s1, s1, 2047
  v_exp_f32 v162, v162
  v_exp_f32 v163, v163
  v_exp_f32 v164, v164
  v_exp_f32 v165, v165
  v_exp_f32 v166, v166
  v_mfma_f32_32x32x16_bf16 v[240:255], v[224:227], v[208:211], 0
  buffer_load_dwordx4 v4, s[16:19], s61 offen offset:1024 lds
  buffer_load_dwordx4 v3, s[16:19], s62 offen offset:2048 lds
  buffer_load_dwordx4 v4, s[16:19], s62 offen offset:3072 lds
  ds_read_b128 a[128:131], v5 offset:8192
  ds_read_b128 a[132:135], v6 offset:8192
  ds_read_b128 a[136:139], v7 offset:8192
  ds_read_b128 a[140:143], v8 offset:8192
  v_exp_f32 v167, v167
  v_exp_f32 v168, v168
  v_exp_f32 v169, v169
  v_exp_f32 v170, v170
  v_exp_f32 v171, v171
  v_mfma_f32_32x32x16_bf16 v[240:255], v[228:231], v[212:215], v[240:255]
  s_mov_b64 exec, s[70:71]
  ds_read_b128 v[224:227], v120 offset:26624
  ds_read_b128 v[228:231], v120 offset:27648
  s_mov_b64 exec, -1
  ds_read_b128 v[128:131], v120 offset:16384
  v_exp_f32 v172, v172
  v_exp_f32 v173, v173
  v_exp_f32 v174, v174
  v_exp_f32 v175, v175
  v_cvt_pk_bf16_f32 v216, v160, v161
  v_cvt_pk_bf16_f32 v217, v162, v163
  v_cvt_pk_bf16_f32 v218, v164, v165
  v_cvt_pk_bf16_f32 v219, v166, v167
  v_cvt_pk_bf16_f32 v220, v168, v169
  v_cvt_pk_bf16_f32 v221, v170, v171
  v_cvt_pk_bf16_f32 v222, v172, v173
  v_cvt_pk_bf16_f32 v223, v174, v175
  v_exp_f32 v144, v144
  v_exp_f32 v145, v145
  s_cmp_eq_u32 s52, 6
  s_cbranch_scc1 L_cz_36
L_czb_37:
  v_mfma_f32_32x32x16_bf16 v[160:175], v[140:143], v[112:115], v[32:47]
  s_waitcnt lgkmcnt(3)
  s_add_u32 s61, s0, s1
  s_add_u32 s62, s61, 63488
  s_add_u32 m0, s64, 8192
  s_add_u32 s1, s1, 128
  v_exp_f32 v146, v146
  v_exp_f32 v147, v147
  v_exp_f32 v148, v148
  v_exp_f32 v149, v149
  v_exp_f32 v150, v150
  v_mfma_f32_32x32x16_bf16 v[240:255], v[232:235], v[216:219], v[240:255]
  buffer_load_dwordx4 v3, s[16:19], s61 offen lds
  buffer_load_dwordx4 v4, s[16:19], s61 offen offset:1024 lds
  buffer_load_dwordx4 v3, s[16:19], s62 offen offset:2048 lds
  buffer_load_dwordx4 v4, s[16:19], s62 offen offset:3072 lds
  s_and_b32 s1, s1, 2047
  v_exp_f32 v151, v151
  v_exp_f32 v152, v152
  v_exp_f32 v153, v153
  v_exp_f32 v154, v154
  v_exp_f32 v155, v155
  v_mfma_f32_32x32x16_bf16 v[240:255], v[236:239], v[220:223], v[240:255]
  s_mov_b64 exec, s[70:71]
  ds_read_b128 v[232:235], v120 offset:22528
  ds_read_b128 v[236:239], v120 offset:23552
  s_mov_b64 exec, -1
  ds_read_b128 v[132:135], v120 offset:12288
  v_exp_f32 v156, v156
  v_exp_f32 v157, v157
  v_exp_f32 v158, v158
  v_exp_f32 v159, v159
  v_cvt_pk_bf16_f32 v208, v144, v145
  v_cvt_pk_bf16_f32 v209, v146, v147
  v_cvt_pk_bf16_f32 v210, v148, v149
  v_cvt_pk_bf16_f32 v211, v150, v151
  v_cvt_pk_bf16_f32 v212, v152, v153
  v_cvt_pk_bf16_f32 v213, v154, v155
  v_cvt_pk_bf16_f32 v214, v156, v157
  v_cvt_pk_bf16_f32 v215, v158, v159
  v_exp_f32 v160, v160
  v_exp_f32 v161, v161
  s_cmp_eq_u32 s52, 5
  s_cbranch_scc1 L_cz_38
L_czb_39:
  s_waitcnt lgkmcnt(3)
  v_mfma_f32_32x32x16_bf16 v[144:159], v[128:131], v[112:115], v[32:47]
  s_waitcnt vmcnt(12)
  s_barrier
  s_add_u32 s77, s48, 65536
  v_mov_b32 v126, s44
  buffer_store_dword v126, v9, s[36:39], s77 offen sc1
  s_waitcnt vmcnt(9)
  v_exp_f32 v162, v162
  v_exp_f32 v163, v163
  v_exp_f32 v164, v164
  v_exp_f32 v165, v165
  v_exp_f32 v166, v166
  v_mfma_f32_32x32x16_bf16 v[240:255], v[224:227], v[208:211], v[240:255]
  ds_read_b128 a[144:147], v5
  ds_read_b128 a[148:151], v6
  ds_read_b128 a[152:155], v7
  ds_read_b128 a[156:159], v8
  v_exp_f32 v167, v167
  v_exp_f32 v168, v168
  v_exp_f32 v169, v169
  v_exp_f32 v170, v170
  v_exp_f32 v171, v171
  v_mfma_f32_32x32x16_bf16 v[240:255], v[228:231], v[212:215], v[240:255]
  s_mov_b64 exec, s[70:71]
  ds_read_b128 v[224:227], v120 offset:18432
  ds_read_b128 v[228:231], v120 offset:19456
  s_mov_b64 exec, -1
  ds_read_b128 v[136:139], v120 offset:8192
  v_exp_f32 v172, v172
  v_exp_f32 v173, v173
  v_exp_f32 v174, v174
  v_exp_f32 v175, v175
  v_cvt_pk_bf16_f32 v216, v160, v161
  v_cvt_pk_bf16_f32 v217, v162, v163
  v_cvt_pk_bf16_f32 v218, v164, v165
  v_cvt_pk_bf16_f32 v219, v166, v167
  v_cvt_pk_bf16_f32 v220, v168, v169
  v_cvt_pk_bf16_f32 v221, v170, v171
  v_cvt_pk_bf16_f32 v222, v172, v173
  v_cvt_pk_bf16_f32 v223, v174, v175
  v_exp_f32 v144, v144
  v_exp_f32 v145, v145
  s_cmp_eq_u32 s52, 4
  s_cbranch_scc1 L_cz_40
L_czb_41:
  s_waitcnt lgkmcnt(7)
  v_mfma_f32_32x32x16_bf16 v[160:175], v[132:135], v[112:115], v[32:47]
  s_waitcnt lgkmcnt(3)
  s_add_u32 s61, s0, s1
  s_add_u32 s62, s61, 63488
  s_add_u32 m0, s64, 0
  s_nop 0
  buffer_load_dwordx4 v3, s[16:19], s61 offen lds
  s_add_u32 s1, s1, 128
  s_and_b32 s1, s1, 2047
  v_exp_f32 v146, v146
  v_exp_f32 v147, v147
  v_exp_f32 v148, v148
  v_exp_f32 v149, v149
  v_exp_f32 v150, v150
  v_mfma_f32_32x32x16_bf16 v[240:255], v[232:235], v[216:219], v[240:255]
  buffer_load_dwordx4 v4, s[16:19], s61 offen offset:1024 lds
  buffer_load_dwordx4 v3, s[16:19], s62 offen offset:2048 lds
  buffer_load_dwordx4 v4, s[16:19], s62 offen offset:3072 lds
  s_waitcnt vmcnt(9)
  ds_read_b128 a[160:163], v5 offset:4096
  ds_read_b128 a[164:167], v6 offset:4096
  ds_read_b128 a[168:171], v7 offset:4096
  ds_read_b128 a[172:175], v8 offset:4096
  v_exp_f32 v151, v151
  v_exp_f32 v152, v152
  v_exp_f32 v153, v153
  v_exp_f32 v154, v154
  v_exp_f32 v155, v155
  v_mfma_f32_32x32x16_bf16 v[240:255], v[236:239], v[220:223], v[240:255]
  s_mov_b64 exec, s[70:71]
  ds_read_b128 v[232:235], v120 offset:14336
  ds_read_b128 v[236:239], v120 offset:15360
  s_mov_b64 exec, -1
  ds_read_b128 v[140:143], v120 offset:4096
  v_exp_f32 v156, v156
  v_exp_f32 v157, v157
  v_exp_f32 v158, v158
  v_exp_f32 v159, v159
  v_cvt_pk_bf16_f32 v208, v144, v145
  v_cvt_pk_bf16_f32 v209, v146, v147
  v_cvt_pk_bf16_f32 v210, v148, v149
  v_cvt_pk_bf16_f32 v211, v150, v151
  v_cvt_pk_bf16_f32 v212, v152, v153
  v_cvt_pk_bf16_f32 v213, v154, v155
  v_cvt_pk_bf16_f32 v214, v156, v157
  v_cvt_pk_bf16_f32 v215, v158, v159
  v_exp_f32 v160, v160
  v_exp_f32 v161, v161
  s_cmp_eq_u32 s52, 3
  s_cbranch_scc1 L_cz_42
L_czb_43:
  s_waitcnt lgkmcnt(7)
  v_mfma_f32_32x32x16_bf16 v[144:159], v[136:139], v[112:115], v[32:47]
  s_waitcnt lgkmcnt(3)
  s_add_u32 s61, s0, s1
  s_add_u32 s62, s61, 63488
  s_add_u32 m0, s64, 4096
  s_add_u32 s1, s1, 128
  v_exp_f32 v162, v162
  v_exp_f32 v163, v163
  v_exp_f32 v164, v164
  v_exp_f32 v165, v165
  v_exp_f32 v166, v166
  v_mfma_f32_32x32x16_bf16 v[240:255], v[224:227], v[208:211], v[240:255]
  buffer_load_dwordx4 v3, s[16:19], s61 offen lds
  buffer_load_dwordx4 v4, s[16:19], s61 offen offset:1024 lds
  buffer_load_dwordx4 v3, s[16:19], s62 offen offset:2048 lds
  buffer_load_dwordx4 v4, s[16:19], s62 offen offset:3072 lds
  s_and_b32 s1, s1, 2047
  v_exp_f32 v167, v167
  v_exp_f32 v168, v168
  v_exp_f32 v169, v169
  v_exp_f32 v170, v170
  v_exp_f32 v171, v171
  v_mfma_f32_32x32x16_bf16 v[240:255], v[228:231], v[212:215], v[240:255]
  s_mov_b64 exec, s[70:71]
  ds_read_b128 v[224:227], v120 offset:10240
  ds_read_b128 v[228:231], v120 offset:11264
  s_mov_b64 exec, -1
  ds_read_b128 v[128:131], v120 offset:33792
  v_exp_f32 v172, v172
  v_exp_f32 v173, v173
  v_exp_f32 v174, v174
  v_exp_f32 v175, v175
  v_cvt_pk_bf16_f32 v216, v160, v161
  v_cvt_pk_bf16_f32 v217, v162, v163
  v_cvt_pk_bf16_f32 v218, v164, v165
  v_cvt_pk_bf16_f32 v219, v166, v167
  v_cvt_pk_bf16_f32 v220, v168, v169
  v_cvt_pk_bf16_f32 v221, v170, v171
  v_cvt_pk_bf16_f32 v222, v172, v173
  v_cvt_pk_bf16_f32 v223, v174, v175
  v_exp_f32 v144, v144
  v_exp_f32 v145, v145
  s_cmp_eq_u32 s52, 2
  s_cbranch_scc1 L_cz_44
L_czb_45:
  s_waitcnt lgkmcnt(3)
  v_mfma_f32_32x32x16_bf16 v[160:175], v[140:143], v[112:115], v[32:47]
  s_waitcnt vmcnt(9)
  ds_read_b128 a[176:179], v5 offset:8192
  v_exp_f32 v146, v146
  v_exp_f32 v147, v147
  v_exp_f32 v148, v148
  v_exp_f32 v149, v149
  v_exp_f32 v150, v150
  v_mfma_f32_32x32x16_bf16 v[240:255], v[232:235], v[216:219], v[240:255]
  ds_read_b128 a[180:183], v6 offset:8192
  ds_read_b128 a[184:187], v7 offset:8192
  ds_read_b128 a[188:191], v8 offset:8192
  v_exp_f32 v151, v151
  v_exp_f32 v152, v152
  v_exp_f32 v153, v153
  v_exp_f32 v154, v154
  v_exp_f32 v155, v155
  v_mfma_f32_32x32x16_bf16 v[240:255], v[236:239], v[220:223], v[240:255]
  s_mov_b64 exec, s[70:71]
  ds_read_b128 v[232:235], v120 offset:6144
  ds_read_b128 v[236:239], v120 offset:7168
  s_mov_b64 exec, -1
  ds_read_b128 v[132:135], v120 offset:29696
  v_exp_f32 v156, v156
  v_exp_f32 v157, v157
  v_exp_f32 v158, v158
  v_exp_f32 v159, v159
  v_cvt_pk_bf16_f32 v208, v144, v145
  v_cvt_pk_bf16_f32 v209, v146, v147
  v_cvt_pk_bf16_f32 v210, v148, v149
  v_cvt_pk_bf16_f32 v211, v150, v151
  v_cvt_pk_bf16_f32 v212, v152, v153
  v_cvt_pk_bf16_f32 v213, v154, v155
  v_cvt_pk_bf16_f32 v214, v156, v157
  v_cvt_pk_bf16_f32 v215, v158, v159
  v_exp_f32 v160, v160
  v_exp_f32 v161, v161
  s_waitcnt lgkmcnt(7)
  v_mfma_f32_32x32x16_bf16 v[144:159], v[128:131], v[116:119], v[176:191]
  s_waitcnt lgkmcnt(3)
  s_add_u32 s61, s0, s1
  s_add_u32 s62, s61, 63488
  s_add_u32 m0, s64, 8192
  s_nop 0
  buffer_load_dwordx4 v3, s[16:19], s61 offen lds
  s_add_u32 s1, s1, 128
  s_and_b32 s1, s1, 2047
  v_exp_f32 v162, v162
  v_exp_f32 v163, v163
  v_exp_f32 v164, v164
  v_exp_f32 v165, v165
  v_exp_f32 v166, v166
  v_mfma_f32_32x32x16_bf16 v[240:255], v[224:227], v[208:211], v[240:255]
  buffer_load_dwordx4 v4, s[16:19], s61 offen offset:1024 lds
  buffer_load_dwordx4 v3, s[16:19], s62 offen offset:2048 lds
  buffer_load_dwordx4 v4, s[16:19], s62 offen offset:3072 lds
  s_waitcnt vmcnt(8)
  ds_read_b128 a[192:195], v5
  ds_read_b128 a[196:199], v6
  ds_read_b128 a[200:203], v7
  ds_read_b128 a[204:207], v8
  v_exp_f32 v167, v167
  v_exp_f32 v168, v168
  v_exp_f32 v169, v169
  v_exp_f32 v170, v170
  v_exp_f32 v171, v171
  v_mfma_f32_32x32x16_bf16 v[240:255], v[228:231], v[212:215], v[240:255]
  s_mov_b64 exec, s[70:71]
  ds_read_b128 v[224:227], v120 offset:35072
  ds_read_b128 v[228:231], v120 offset:36096
  s_mov_b64 exec, -1
  ds_read_b128 v[136:139], v120 offset:25600
  v_exp_f32 v172, v172
  v_exp_f32 v173, v173
  v_exp_f32 v174, v174
  v_exp_f32 v175, v175
  v_cvt_pk_bf16_f32 v216, v160, v161
  v_cvt_pk_bf16_f32 v217, v162, v163
  v_cvt_pk_bf16_f32 v218, v164, v165
  v_cvt_pk_bf16_f32 v219, v166, v167
  v_cvt_pk_bf16_f32 v220, v168, v169
  v_cvt_pk_bf16_f32 v221, v170, v171
  v_cvt_pk_bf16_f32 v222, v172, v173
  v_cvt_pk_bf16_f32 v223, v174, v175
  v_exp_f32 v144, v144
  v_exp_f32 v145, v145
  v_mov_b32 v32, 0
  v_mov_b32 v33, 0
  v_mov_b32 v34, 0
  v_mov_b32 v35, 0
  v_mov_b32 v36, 0
  v_mov_b32 v37, 0
  v_mov_b32 v38, 0
  v_mov_b32 v39, 0
  v_mov_b32 v40, 0
  v_mov_b32 v41, 0
  v_mov_b32 v42, 0
  v_mov_b32 v43, 0
  v_mov_b32 v44, 0
  v_mov_b32 v45, 0
  v_mov_b32 v46, 0
  v_mov_b32 v47, 0
  s_cmp_eq_u32 s52, 8
  s_cbranch_scc1 L_cz_46
L_czb_47:
  s_waitcnt lgkmcnt(7)
  v_mfma_f32_32x32x16_bf16 v[160:175], v[132:135], v[116:119], v[32:47]
  s_waitcnt lgkmcnt(3)
  s_add_u32 s61, s0, s1
  s_add_u32 s62, s61, 63488
  s_add_u32 m0, s64, 0
  s_nop 0
  buffer_load_dwordx4 v3, s[16:19], s61 offen lds
  buffer_load_dwordx4 v4, s[16:19], s61 offen offset:1024 lds
  buffer_load_dwordx4 v3, s[16:19], s62 offen offset:2048 lds
  buffer_load_dwordx4 v4, s[16:19], s62 offen offset:3072 lds
  s_add_u32 s1, s1, 128
  s_and_b32 s1, s1, 2047
  s_waitcnt vmcnt(8)
  v_exp_f32 v146, v146
  v_exp_f32 v147, v147
  v_exp_f32 v148, v148
  v_exp_f32 v149, v149
  v_exp_f32 v150, v150
  v_mfma_f32_32x32x16_bf16 v[240:255], v[232:235], v[216:219], v[240:255]
  ds_read_b128 a[208:211], v5 offset:4096
  ds_read_b128 a[212:215], v6 offset:4096
  ds_read_b128 a[216:219], v7 offset:4096
  ds_read_b128 a[220:223], v8 offset:4096
  s_lshl_b32 s66, s43, 12
  s_xor_b32 s77, s41, 1
  s_lshl_b32 s77, s77, 18
  s_lshl_b32 s78, s42, 16
  s_add_u32 s77, s77, s78
  s_add_u32 s77, s77, s66
  s_add_u32 s60, s77, 6291456
  s_xor_b32 s73, s60, 262144
  v_add_u32 v2, 131072, v0
  s_and_b32 s77, s40, 3
  s_lshl_b32 s69, s77, 14
  v_bfe_u32 v124, v0, 7, 1
  v_xor_b32 v124, s41, v124
  v_and_b32 v125, 0x70, v0
  v_add_u32 v124, v124, v125
  v_lshlrev_b32 v124, 8, v124
  s_lshl_b32 s77, s42, 15
  s_add_u32 s77, s77, 69632
  v_add_u32 v124, s77, v124
  v_exp_f32 v151, v151
  v_exp_f32 v152, v152
  v_exp_f32 v153, v153
  v_exp_f32 v154, v154
  v_exp_f32 v155, v155
  v_mfma_f32_32x32x16_bf16 v[240:255], v[236:239], v[220:223], v[240:255]
  buffer_load_dword v123, v124, s[36:39], 0 offen sc1
  s_mov_b64 exec, s[70:71]
  ds_read_b128 v[232:235], v120 offset:30976
  ds_read_b128 v[236:239], v120 offset:32000
  s_mov_b64 exec, -1
  ds_read_b128 v[140:143], v120 offset:21504
  v_exp_f32 v156, v156
  v_exp_f32 v157, v157
  v_exp_f32 v158, v158
  v_exp_f32 v159, v159
  v_cvt_pk_bf16_f32 v208, v144, v145
  v_cvt_pk_bf16_f32 v209, v146, v147
  v_cvt_pk_bf16_f32 v210, v148, v149
  v_cvt_pk_bf16_f32 v211, v150, v151
  v_cvt_pk_bf16_f32 v212, v152, v153
  v_cvt_pk_bf16_f32 v213, v154, v155
  v_cvt_pk_bf16_f32 v214, v156, v157
  v_cvt_pk_bf16_f32 v215, v158, v159
  v_exp_f32 v160, v160
  v_exp_f32 v161, v161
  s_cmp_eq_u32 s52, 7
  s_cbranch_scc1 L_cz_48
L_czb_49:
  s_waitcnt lgkmcnt(7)
  v_mfma_f32_32x32x16_bf16 v[144:159], v[136:139], v[116:119], v[32:47]
  s_waitcnt vmcnt(5)
  ds_read_b128 a[224:227], v5 offset:8192
  v_exp_f32 v162, v162
  v_exp_f32 v163, v163
  v_exp_f32 v164, v164
  v_exp_f32 v165, v165
  v_exp_f32 v166, v166
  v_mfma_f32_32x32x16_bf16 v[16:31], v[224:227], v[208:211], 0
  ds_read_b128 a[228:231], v6 offset:8192
  ds_read_b128 a[232:235], v7 offset:8192
  ds_read_b128 a[236:239], v8 offset:8192
  v_exp_f32 v167, v167
  v_exp_f32 v168, v168
  v_exp_f32 v169, v169
  v_exp_f32 v170, v170
  v_exp_f32 v171, v171
  v_mfma_f32_32x32x16_bf16 v[16:31], v[228:231], v[212:215], v[16:31]
  s_mov_b64 exec, s[70:71]
  ds_read_b128 v[224:227], v120 offset:26880
  ds_read_b128 v[228:231], v120 offset:27904
  s_mov_b64 exec, -1
  ds_read_b128 v[128:131], v120 offset:17408
  v_exp_f32 v172, v172
  v_exp_f32 v173, v173
  v_exp_f32 v174, v174
  v_exp_f32 v175, v175
  v_cvt_pk_bf16_f32 v216, v160, v161
  v_cvt_pk_bf16_f32 v217, v162, v163
  v_cvt_pk_bf16_f32 v218, v164, v165
  v_cvt_pk_bf16_f32 v219, v166, v167
  v_cvt_pk_bf16_f32 v220, v168, v169
  v_cvt_pk_bf16_f32 v221, v170, v171
  v_cvt_pk_bf16_f32 v222, v172, v173
  v_cvt_pk_bf16_f32 v223, v174, v175
  v_max3_f32 v122, |v240|, |v241|, |v242|
  v_max3_f32 v122, v122, |v243|, |v244|
  v_max3_f32 v122, v122, |v245|, |v246|
  v_max3_f32 v122, v122, |v247|, |v247|
  v_cmp_nge_f32 vcc, 0x5d800000, v248
  s_nop 1
  s_mov_b64 s[86:87], vcc
  v_cmp_nle_f32 vcc, 0x21800000, v248
  s_nop 1
  s_or_b64 s[86:87], s[86:87], vcc
  v_cmp_nge_f32 vcc, 0x7e800000, v122
  s_nop 1
  s_or_b64 s[86:87], s[86:87], vcc
  v_rcp_f32 v121, v248
  s_nop 0
  v_mul_f32 v240, v240, v121
  v_mul_f32 v241, v241, v121
  v_mul_f32 v242, v242, v121
  v_mul_f32 v243, v243, v121
  v_mul_f32 v244, v244, v121
  v_mul_f32 v245, v245, v121
  v_mul_f32 v246, v246, v121
  v_mul_f32 v247, v247, v121
  v_cvt_pk_bf16_f32 v48, v240, v241
  v_cvt_pk_bf16_f32 v49, v242, v243
  v_cvt_pk_bf16_f32 v50, v244, v245
  v_cvt_pk_bf16_f32 v51, v246, v247
  v_exp_f32 v144, v144
  v_exp_f32 v145, v145
  s_cmp_eq_u32 s52, 6
  s_cbranch_scc1 L_cz_50
L_czb_51:
  s_waitcnt lgkmcnt(7)
  v_mfma_f32_32x32x16_bf16 v[160:175], v[140:143], v[116:119], v[32:47]
  s_waitcnt vmcnt(1)
  ds_read_b128 a[240:243], v5
  v_exp_f32 v146, v146
  v_exp_f32 v147, v147
  v_exp_f32 v148, v148
  v_exp_f32 v149, v149
  v_exp_f32 v150, v150
  v_mfma_f32_32x32x16_bf16 v[16:31], v[232:235], v[216:219], v[16:31]
  ds_read_b128 a[244:247], v6
  ds_read_b128 a[248:251], v7
  ds_read_b128 a[252:255], v8
  v_exp_f32 v151, v151
  v_exp_f32 v152, v152
  v_exp_f32 v153, v153
  v_exp_f32 v154, v154
  v_exp_f32 v155, v155
  v_mfma_f32_32x32x16_bf16 v[16:31], v[236:239], v[220:223], v[16:31]
  s_mov_b64 exec, s[70:71]
  ds_read_b128 v[232:235], v120 offset:22784
  ds_read_b128 v[236:239], v120 offset:23808
  s_mov_b64 exec, -1
  ds_read_b128 v[132:135], v120 offset:13312
  v_exp_f32 v156, v156
  v_exp_f32 v157, v157
  v_exp_f32 v158, v158
  v_exp_f32 v159, v159
  v_cvt_pk_bf16_f32 v208, v144, v145
  v_cvt_pk_bf16_f32 v209, v146, v147
  v_cvt_pk_bf16_f32 v210, v148, v149
  v_cvt_pk_bf16_f32 v211, v150, v151
  v_cvt_pk_bf16_f32 v212, v152, v153
  v_cvt_pk_bf16_f32 v213, v154, v155
  v_cvt_pk_bf16_f32 v214, v156, v157
  v_cvt_pk_bf16_f32 v215, v158, v159
  v_exp_f32 v160, v160
  v_exp_f32 v161, v161
  s_cmp_eq_u32 s52, 5
  s_cbranch_scc1 L_cz_52
L_czb_53:
  s_waitcnt lgkmcnt(7)
  v_mfma_f32_32x32x16_bf16 v[144:159], v[128:131], v[116:119], v[32:47]
  s_waitcnt vmcnt(0)
  v_cmp_ne_u32 s[74:75], s44, v123
  s_nop 1
  s_cmp_lg_u64 s[74:75], 0
  s_cbranch_scc1 L_slow_29
L_back_30:
  s_add_u32 m0, s66, 98304
  s_add_u32 s65, s69, 0
  s_and_b32 s65, s65, 0xffff
  v_exp_f32 v162, v162
  v_exp_f32 v163, v163
  v_exp_f32 v164, v164
  v_exp_f32 v165, v165
  v_exp_f32 v166, v166
  v_mfma_f32_32x32x16_bf16 v[16:31], v[224:227], v[208:211], v[16:31]
  s_add_u32 s65, s65, s60
  buffer_load_dwordx4 v0, s[36:39], s65 offen sc1 lds
  buffer_load_dwordx4 v0, s[36:39], s65 offen offset:1024 sc1 lds
  buffer_load_dwordx4 v0, s[36:39], s65 offen offset:2048 sc1 lds
  buffer_load_dwordx4 v0, s[36:39], s65 offen offset:3072 sc1 lds
  v_exp_f32 v167, v167
  v_exp_f32 v168, v168
  v_exp_f32 v169, v169
  v_exp_f32 v170, v170
  v_exp_f32 v171, v171
  v_mfma_f32_32x32x16_bf16 v[16:31], v[228:231], v[212:215], v[16:31]
  s_mov_b64 exec, s[70:71]
  ds_read_b128 v[224:227], v120 offset:18688
  ds_read_b128 v[228:231], v120 offset:19712
  s_mov_b64 exec, -1
  ds_read_b128 v[136:139], v120 offset:9216
  v_exp_f32 v172, v172
  v_exp_f32 v173, v173
  v_exp_f32 v174, v174
  v_exp_f32 v175, v175
  v_cvt_pk_bf16_f32 v216, v160, v161
  v_cvt_pk_bf16_f32 v217, v162, v163
  v_cvt_pk_bf16_f32 v218, v164, v165
  v_cvt_pk_bf16_f32 v219, v166, v167
  v_cvt_pk_bf16_f32 v220, v168, v169
  v_cvt_pk_bf16_f32 v221, v170, v171
  v_cvt_pk_bf16_f32 v222, v172, v173
  v_cvt_pk_bf16_f32 v223, v174, v175
  v_exp_f32 v144, v144
  v_exp_f32 v145, v145
  s_cmp_eq_u32 s52, 4
  s_cbranch_scc1 L_cz_54
L_czb_55:
  s_waitcnt lgkmcnt(3)
  v_mfma_f32_32x32x16_bf16 v[160:175], v[132:135], v[116:119], v[32:47]
  s_add_u32 m0, s66, 114688
  s_add_u32 s65, s69, 16384
  s_and_b32 s65, s65, 0xffff
  s_add_u32 s65, s65, s60
  v_exp_f32 v146, v146
  v_exp_f32 v147, v147
  v_exp_f32 v148, v148
  v_exp_f32 v149, v149
  v_exp_f32 v150, v150
  v_mfma_f32_32x32x16_bf16 v[16:31], v[232:235], v[216:219], v[16:31]
  buffer_load_dwordx4 v0, s[36:39], s65 offen sc1 lds
  buffer_load_dwordx4 v0, s[36:39], s65 offen offset:1024 sc1 lds
  buffer_load_dwordx4 v0, s[36:39], s65 offen offset:2048 sc1 lds
  buffer_load_dwordx4 v0, s[36:39], s65 offen offset:3072 sc1 lds
  v_exp_f32 v151, v151
  v_exp_f32 v152, v152
  v_exp_f32 v153, v153
  v_exp_f32 v154, v154
  v_exp_f32 v155, v155
  v_mfma_f32_32x32x16_bf16 v[16:31], v[236:239], v[220:223], v[16:31]
  s_mov_b64 exec, s[70:71]
  ds_read_b128 v[232:235], v120 offset:14592
  ds_read_b128 v[236:239], v120 offset:15616
  s_mov_b64 exec, -1
  ds_read_b128 v[140:143], v120 offset:5120
  v_exp_f32 v156, v156
  v_exp_f32 v157, v157
  v_exp_f32 v158, v158
  v_exp_f32 v159, v159
  v_cvt_pk_bf16_f32 v208, v144, v145
  v_cvt_pk_bf16_f32 v209, v146, v147
  v_cvt_pk_bf16_f32 v210, v148, v149
  v_cvt_pk_bf16_f32 v211, v150, v151
  v_cvt_pk_bf16_f32 v212, v152, v153
  v_cvt_pk_bf16_f32 v213, v154, v155
  v_cvt_pk_bf16_f32 v214, v156, v157
  v_cvt_pk_bf16_f32 v215, v158, v159
  v_exp_f32 v160, v160
  v_exp_f32 v161, v161
  s_cmp_eq_u32 s52, 3
  s_cbranch_scc1 L_cz_56
L_czb_57:
  s_waitcnt lgkmcnt(3)
  v_mfma_f32_32x32x16_bf16 v[144:159], v[136:139], v[116:119], v[32:47]
  s_add_u32 m0, s66, 131072
  s_add_u32 s65, s69, 32768
  s_and_b32 s65, s65, 0xffff
  s_add_u32 s65, s65, s60
  v_exp_f32 v162, v162
  v_exp_f32 v163, v163
  v_exp_f32 v164, v164
  v_exp_f32 v165, v165
  v_exp_f32 v166, v166
  v_mfma_f32_32x32x16_bf16 v[16:31], v[224:227], v[208:211], v[16:31]
  buffer_load_dwordx4 v0, s[36:39], s65 offen sc1 lds
  buffer_load_dwordx4 v0, s[36:39], s65 offen offset:1024 sc1 lds
  buffer_load_dwordx4 v0, s[36:39], s65 offen offset:2048 sc1 lds
  buffer_load_dwordx4 v0, s[36:39], s65 offen offset:3072 sc1 lds
  v_exp_f32 v167, v167
  v_exp_f32 v168, v168
  v_exp_f32 v169, v169
  v_exp_f32 v170, v170
  v_exp_f32 v171, v171
  v_mfma_f32_32x32x16_bf16 v[16:31], v[228:231], v[212:215], v[16:31]
  s_mov_b64 exec, s[70:71]
  ds_read_b128 v[224:227], v120 offset:10496
  ds_read_b128 v[228:231], v120 offset:11520
  s_mov_b64 exec, -1
  v_exp_f32 v172, v172
  v_exp_f32 v173, v173
  v_exp_f32 v174, v174
  v_exp_f32 v175, v175
  v_cvt_pk_bf16_f32 v216, v160, v161
  v_cvt_pk_bf16_f32 v217, v162, v163
  v_cvt_pk_bf16_f32 v218, v164, v165
  v_cvt_pk_bf16_f32 v219, v166, v167
  v_cvt_pk_bf16_f32 v220, v168, v169
  v_cvt_pk_bf16_f32 v221, v170, v171
  v_cvt_pk_bf16_f32 v222, v172, v173
  v_cvt_pk_bf16_f32 v223, v174, v175
  v_exp_f32 v144, v144
  v_exp_f32 v145, v145
  s_cmp_eq_u32 s52, 2
  s_cbranch_scc1 L_cz_58
L_czb_59:
  s_waitcnt lgkmcnt(2)
  v_mfma_f32_32x32x16_bf16 v[160:175], v[140:143], v[116:119], v[32:47]
  s_add_u32 m0, s66, 147456
  s_add_u32 s65, s69, 49152
  s_and_b32 s65, s65, 0xffff
  s_add_u32 s65, s65, s60
  v_exp_f32 v146, v146
  v_exp_f32 v147, v147
  v_exp_f32 v148, v148
  v_exp_f32 v149, v149
  v_exp_f32 v150, v150
  v_mfma_f32_32x32x16_bf16 v[16:31], v[232:235], v[216:219], v[16:31]
  buffer_load_dwordx4 v0, s[36:39], s65 offen sc1 lds
  buffer_load_dwordx4 v0, s[36:39], s65 offen offset:1024 sc1 lds
  buffer_load_dwordx4 v0, s[36:39], s65 offen offset:2048 sc1 lds
  buffer_load_dwordx4 v0, s[36:39], s65 offen offset:3072 sc1 lds
  v_exp_f32 v151, v151
  v_exp_f32 v152, v152
  v_exp_f32 v153, v153
  v_exp_f32 v154, v154
  v_exp_f32 v155, v155
  v_mfma_f32_32x32x16_bf16 v[16:31], v[236:239], v[220:223], v[16:31]
  s_mov_b64 exec, s[70:71]
  ds_read_b128 v[232:235], v120 offset:6400
  ds_read_b128 v[236:239], v120 offset:7424
  s_mov_b64 exec, -1
  v_exp_f32 v156, v156
  v_exp_f32 v157, v157
  v_exp_f32 v158, v158
  v_exp_f32 v159, v159
  v_cvt_pk_bf16_f32 v208, v144, v145
  v_cvt_pk_bf16_f32 v209, v146, v147
  v_cvt_pk_bf16_f32 v210, v148, v149
  v_cvt_pk_bf16_f32 v211, v150, v151
  v_cvt_pk_bf16_f32 v212, v152, v153
  v_cvt_pk_bf16_f32 v213, v154, v155
  v_cvt_pk_bf16_f32 v214, v156, v157
  v_cvt_pk_bf16_f32 v215, v158, v159
  v_exp_f32 v160, v160
  v_exp_f32 v161, v161
  v_exp_f32 v162, v162
  v_exp_f32 v163, v163
  v_exp_f32 v164, v164
  v_exp_f32 v165, v165
  v_exp_f32 v166, v166
  s_waitcnt lgkmcnt(2)
  v_mfma_f32_32x32x16_bf16 v[16:31], v[224:227], v[208:211], v[16:31]
  v_exp_f32 v167, v167
  v_exp_f32 v168, v168
  v_exp_f32 v169, v169
  v_exp_f32 v170, v170
  v_exp_f32 v171, v171
  v_mfma_f32_32x32x16_bf16 v[16:31], v[228:231], v[212:215], v[16:31]
  v_exp_f32 v172, v172
  v_exp_f32 v173, v173
  v_exp_f32 v174, v174
  v_exp_f32 v175, v175
  v_cvt_pk_bf16_f32 v216, v160, v161
  v_cvt_pk_bf16_f32 v217, v162, v163
  v_cvt_pk_bf16_f32 v218, v164, v165
  v_cvt_pk_bf16_f32 v219, v166, v167
  v_cvt_pk_bf16_f32 v220, v168, v169
  v_cvt_pk_bf16_f32 v221, v170, v171
  v_cvt_pk_bf16_f32 v222, v172, v173
  v_cvt_pk_bf16_f32 v223, v174, v175
  s_waitcnt lgkmcnt(0)
  v_mfma_f32_32x32x16_bf16 v[16:31], v[232:235], v[216:219], v[16:31]
  v_mfma_f32_32x32x16_bf16 v[16:31], v[236:239], v[220:223], v[16:31]
  s_lshl_b32 s79, s46, 4
  s_add_u32 s79, s79, s45
  s_lshl_b32 s79, s79, 11
  s_add_u32 s79, s79, 18874368
  s_nop 7
  v_max3_f32 v122, |v16|, |v17|, |v18|
  v_max3_f32 v122, v122, |v19|, |v20|
  v_max3_f32 v122, v122, |v21|, |v22|
  v_max3_f32 v122, v122, |v23|, |v23|
  v_cmp_nge_f32 vcc, 0x5d800000, v24
  s_nop 1
  s_or_b64 s[86:87], s[86:87], vcc
  v_cmp_nle_f32 vcc, 0x21800000, v24
  s_nop 1
  s_or_b64 s[86:87], s[86:87], vcc
  v_cmp_nge_f32 vcc, 0x7e800000, v122
  s_nop 1
  s_or_b64 s[86:87], s[86:87], vcc
  v_rcp_f32 v121, v24
  s_nop 0
  v_mul_f32 v16, v16, v121
  v_mul_f32 v17, v17, v121
  v_mul_f32 v18, v18, v121
  v_mul_f32 v19, v19, v121
  v_mul_f32 v20, v20, v121
  v_mul_f32 v21, v21, v121
  v_mul_f32 v22, v22, v121
  v_mul_f32 v23, v23, v121
  v_cvt_pk_bf16_f32 v52, v16, v17
  v_cvt_pk_bf16_f32 v53, v18, v19
  v_cvt_pk_bf16_f32 v54, v20, v21
  v_cvt_pk_bf16_f32 v55, v22, v23
  s_cmp_eq_u64 s[86:87], 0
  s_cbranch_scc1 L_ok_60
  s_call_b64 s[84:85], L_attslow
L_ok_60:
  buffer_store_dwordx4 v[48:51], v0, s[36:39], s79 offen sc1
  buffer_store_dwordx4 v[52:55], v0, s[36:39], s79 offen offset:1024 sc1
  s_branch L_p2
L_light:
  s_waitcnt vmcnt(8)
  ds_read_b128 v[192:195], v24 offset:16384
  ds_read_b128 v[196:199], v25 offset:16384
  ds_read_b128 v[200:203], v26 offset:16384
  ds_read_b128 v[204:207], v27 offset:16384
  ds_read_b128 v[208:211], v28 offset:16384
  ds_read_b128 v[212:215], v29 offset:16384
  ds_read_b128 v[216:219], v30 offset:16384
  ds_read_b128 v[220:223], v31 offset:16384
  s_mul_i32 s80, s84, 458752
  s_waitcnt lgkmcnt(7)
  v_dot2c_f32_bf16 v36, s72, v192
  v_dot2c_f32_bf16 v38, v192, v192
  v_dot2c_f32_bf16 v37, s72, v193
  s_mul_i32 s84, s84, 393216
  v_dot2c_f32_bf16 v39, v193, v193
  v_dot2c_f32_bf16 v36, s72, v194
  v_dot2c_f32_bf16 v38, v194, v194
  s_mul_i32 s81, s85, 458752
  v_dot2c_f32_bf16 v37, s72, v195
  v_dot2c_f32_bf16 v39, v195, v195
  s_waitcnt lgkmcnt(6)
  s_mul_i32 s85, s85, 393216
  v_dot2c_f32_bf16 v36, s72, v196
  v_dot2c_f32_bf16 v38, v196, v196
  v_dot2c_f32_bf16 v37, s72, v197
  s_mul_i32 s82, s86, 458752
  v_dot2c_f32_bf16 v39, v197, v197
  v_dot2c_f32_bf16 v36, s72, v198
  v_dot2c_f32_bf16 v38, v198, v198
  s_mul_i32 s86, s86, 393216
  v_dot2c_f32_bf16 v37, s72, v199
  v_dot2c_f32_bf16 v39, v199, v199
  s_waitcnt lgkmcnt(5)
  s_mul_i32 s83, s87, 458752
  v_dot2c_f32_bf16 v36, s72, v200
  v_dot2c_f32_bf16 v38, v200, v200
  v_dot2c_f32_bf16 v37, s72, v201
  s_mul_i32 s87, s87, 393216
  v_dot2c_f32_bf16 v39, v201, v201
  v_dot2c_f32_bf16 v36, s72, v202
  v_dot2c_f32_bf16 v38, v202, v202
  v_dot2c_f32_bf16 v37, s72, v203
  v_cmp_lt_u32 vcc, 511, v0
  v_dot2c_f32_bf16 v39, v203, v203
  s_waitcnt lgkmcnt(4)
  v_dot2c_f32_bf16 v36, s72, v204
  v_mov_b32 v32, s85
  v_dot2c_f32_bf16 v38, v204, v204
  v_dot2c_f32_bf16 v37, s72, v205
  v_dot2c_f32_bf16 v39, v205, v205
  v_mov_b32 v33, s87
  v_dot2c_f32_bf16 v36, s72, v206
  v_dot2c_f32_bf16 v38, v206, v206
  v_dot2c_f32_bf16 v37, s72, v207
  v_cndmask_b32 v32, v32, v33, vcc
  v_dot2c_f32_bf16 v39, v207, v207
  s_waitcnt lgkmcnt(3)
  v_dot2c_f32_bf16 v36, s72, v208
  v_add_u32 v44, v32, v43
  v_dot2c_f32_bf16 v38, v208, v208
  v_dot2c_f32_bf16 v37, s72, v209
  v_dot2c_f32_bf16 v39, v209, v209
  v_mov_b32 v32, s84
  v_dot2c_f32_bf16 v36, s72, v210
  v_dot2c_f32_bf16 v38, v210, v210
  v_dot2c_f32_bf16 v37, s72, v211
  v_mov_b32 v33, s86
  v_dot2c_f32_bf16 v39, v211, v211
  s_waitcnt lgkmcnt(2)
  v_dot2c_f32_bf16 v36, s72, v212
  v_cndmask_b32 v32, v32, v33, vcc
  v_dot2c_f32_bf16 v38, v212, v212
  v_dot2c_f32_bf16 v37, s72, v213
  v_dot2c_f32_bf16 v39, v213, v213
  v_dot2c_f32_bf16 v36, s72, v214
  v_add_u32 v43, v32, v43
  v_dot2c_f32_bf16 v38, v214, v214
  v_dot2c_f32_bf16 v37, s72, v215
  v_dot2c_f32_bf16 v39, v215, v215
  s_add_u32 m0, s63, 32768
  s_waitcnt lgkmcnt(1)
  v_dot2c_f32_bf16 v36, s72, v216
  v_dot2c_f32_bf16 v38, v216, v216
  v_add_u32 v2, s84, v46
  v_dot2c_f32_bf16 v37, s72, v217
  v_dot2c_f32_bf16 v39, v217, v217
  v_dot2c_f32_bf16 v36, s72, v218
  buffer_load_dwordx4 v2, s[8:11], 0 offen lds
  v_dot2c_f32_bf16 v38, v218, v218
  v_dot2c_f32_bf16 v37, s72, v219
  v_dot2c_f32_bf16 v39, v219, v219
  buffer_load_dwordx4 v2, s[8:11], s53 offen offset:1024 lds
  s_waitcnt lgkmcnt(0)
  v_dot2c_f32_bf16 v36, s72, v220
  v_dot2c_f32_bf16 v38, v220, v220
  buffer_load_dwordx4 v2, s[8:11], s54 offen offset:2048 lds
  v_dot2c_f32_bf16 v37, s72, v221
  v_dot2c_f32_bf16 v39, v221, v221
  v_dot2c_f32_bf16 v36, s72, v222
  buffer_load_dwordx4 v2, s[8:11], s55 offen offset:3072 lds
  v_dot2c_f32_bf16 v38, v222, v222
  v_dot2c_f32_bf16 v37, s72, v223
  v_dot2c_f32_bf16 v39, v223, v223
  s_waitcnt vmcnt(4)
  ds_read_b128 v[224:227], v24 offset:24576
  ds_read_b128 v[228:231], v25 offset:24576
  ds_read_b128 v[232:235], v26 offset:24576
  ds_read_b128 v[236:239], v27 offset:24576
  ds_read_b128 v[240:243], v28 offset:24576
  ds_read_b128 v[244:247], v29 offset:24576
  ds_read_b128 v[248:251], v30 offset:24576
  ds_read_b128 v[252:255], v31 offset:24576
  s_add_u32 m0, s63, 49152
  s_waitcnt lgkmcnt(7)
  v_dot2c_f32_bf16 v36, s72, v224
  v_dot2c_f32_bf16 v38, v224, v224
  v_dot2c_f32_bf16 v37, s72, v225
  v_dot2c_f32_bf16 v39, v225, v225
  v_dot2c_f32_bf16 v36, s72, v226
  v_dot2c_f32_bf16 v38, v226, v226
  v_dot2c_f32_bf16 v37, s72, v227
  v_dot2c_f32_bf16 v39, v227, v227
  s_waitcnt lgkmcnt(6)
  v_dot2c_f32_bf16 v36, s72, v228
  v_dot2c_f32_bf16 v38, v228, v228
  v_add_u32 v2, s85, v46
  v_dot2c_f32_bf16 v37, s72, v229
  v_dot2c_f32_bf16 v39, v229, v229
  v_dot2c_f32_bf16 v36, s72, v230
  v_dot2c_f32_bf16 v38, v230, v230
  v_dot2c_f32_bf16 v37, s72, v231
  v_dot2c_f32_bf16 v39, v231, v231
  s_waitcnt lgkmcnt(5)
  v_dot2c_f32_bf16 v36, s72, v232
  v_dot2c_f32_bf16 v38, v232, v232
  v_dot2c_f32_bf16 v37, s72, v233
  v_dot2c_f32_bf16 v39, v233, v233
  v_dot2c_f32_bf16 v36, s72, v234
  buffer_load_dwordx4 v2, s[8:11], 0 offen lds
  v_dot2c_f32_bf16 v38, v234, v234
  v_dot2c_f32_bf16 v37, s72, v235
  v_dot2c_f32_bf16 v39, v235, v235
  s_waitcnt lgkmcnt(4)
  v_dot2c_f32_bf16 v36, s72, v236
  v_dot2c_f32_bf16 v38, v236, v236
  v_dot2c_f32_bf16 v37, s72, v237
  v_dot2c_f32_bf16 v39, v237, v237
  v_dot2c_f32_bf16 v36, s72, v238
  v_dot2c_f32_bf16 v38, v238, v238
  v_dot2c_f32_bf16 v37, s72, v239
  v_dot2c_f32_bf16 v39, v239, v239
  buffer_load_dwordx4 v2, s[8:11], s53 offen offset:1024 lds
  s_waitcnt lgkmcnt(3)
  v_dot2c_f32_bf16 v36, s72, v240
  v_dot2c_f32_bf16 v38, v240, v240
  v_dot2c_f32_bf16 v37, s72, v241
  v_dot2c_f32_bf16 v39, v241, v241
  v_dot2c_f32_bf16 v36, s72, v242
  v_dot2c_f32_bf16 v38, v242, v242
  v_dot2c_f32_bf16 v37, s72, v243
  v_dot2c_f32_bf16 v39, v243, v243
  s_waitcnt lgkmcnt(2)
  v_dot2c_f32_bf16 v36, s72, v244
  v_dot2c_f32_bf16 v38, v244, v244
  buffer_load_dwordx4 v2, s[8:11], s54 offen offset:2048 lds
  v_dot2c_f32_bf16 v37, s72, v245
  v_dot2c_f32_bf16 v39, v245, v245
  v_dot2c_f32_bf16 v36, s72, v246
  v_dot2c_f32_bf16 v38, v246, v246
  v_dot2c_f32_bf16 v37, s72, v247
  v_dot2c_f32_bf16 v39, v247, v247
  s_waitcnt lgkmcnt(1)
  v_dot2c_f32_bf16 v36, s72, v248
  v_dot2c_f32_bf16 v38, v248, v248
  v_dot2c_f32_bf16 v37, s72, v249
  v_dot2c_f32_bf16 v39, v249, v249
  v_dot2c_f32_bf16 v36, s72, v250
  buffer_load_dwordx4 v2, s[8:11], s55 offen offset:3072 lds
  v_dot2c_f32_bf16 v38, v250, v250
  v_dot2c_f32_bf16 v37, s72, v251
  v_dot2c_f32_bf16 v39, v251, v251
  s_waitcnt lgkmcnt(0)
  v_dot2c_f32_bf16 v36, s72, v252
  v_dot2c_f32_bf16 v38, v252, v252
  v_dot2c_f32_bf16 v37, s72, v253
  v_dot2c_f32_bf16 v39, v253, v253
  v_dot2c_f32_bf16 v36, s72, v254
  v_dot2c_f32_bf16 v38, v254, v254
  v_dot2c_f32_bf16 v37, s72, v255
  v_dot2c_f32_bf16 v39, v255, v255
  s_barrier
  s_nop 0
  v_add_f32 v36, v36, v37
  v_add_f32 v38, v38, v39
  v_mov_b32 v37, v36
  s_nop 1
  v_permlane32_swap_b32 v36, v37
  v_add_f32 v36, v36, v37
  v_mov_b32 v39, v38
  s_nop 1
  v_permlane32_swap_b32 v38, v39
  v_add_f32 v38, v38, v39
  v_mul_f32 v36, 0x3b000000, v36
  v_mul_f32 v38, 0x3b000000, v38
  v_fma_f32 v38, -v36, v36, v38
  v_max_f32 v38, 0, v38
  v_cvt_pk_bf16_f32 v36, v36, v36
  v_and_b32 v36, 0xffff0000, v36
  v_cvt_pk_bf16_f32 v38, v38, v38
  v_and_b32 v38, 0xffff0000, v38
  v_add_f32 v38, 0x3727c5ac, v38
  v_cvt_pk_bf16_f32 v38, v38, v38
  v_and_b32 v38, 0xffff0000, v38
  v_sqrt_f32 v38, v38
  v_xor_b32 v36, 0x80000000, v36
  v_cvt_pk_bf16_f32 v13, v38, v38
  v_and_b32 v13, 0xffff0000, v13
  v_rcp_f32 v10, v13
  s_nop 0
  v_mul_f32 v12, 0xc0135761, v10
  v_mul_f32 v37, v10, v10
  v_mul_f32 v37, 0x3d372713, v37
  v_mul_f32 v11, v37, v12
  s_add_u32 m0, s63, 0
  v_dot2_f32_bf16 v16, v128, s70, v36
  v_dot2_f32_bf16 v17, v128, s71, v36
  v_dot2_f32_bf16 v18, v129, s70, v36
  v_dot2_f32_bf16 v19, v129, s71, v36
  v_dot2_f32_bf16 v20, v130, s70, v36
  v_dot2_f32_bf16 v21, v130, s71, v36
  v_dot2_f32_bf16 v22, v131, s70, v36
  v_dot2_f32_bf16 v23, v131, s71, v36
  v_cvt_pk_bf16_f32 v128, v16, v17
  v_cvt_pk_bf16_f32 v129, v18, v19
  v_cvt_pk_bf16_f32 v130, v20, v21
  v_cvt_pk_bf16_f32 v131, v22, v23
  v_dot2_f32_bf16 v16, v132, s70, v36
  v_dot2_f32_bf16 v17, v132, s71, v36
  v_dot2_f32_bf16 v18, v133, s70, v36
  v_dot2_f32_bf16 v19, v133, s71, v36
  v_dot2_f32_bf16 v20, v134, s70, v36
  v_dot2_f32_bf16 v21, v134, s71, v36
  v_dot2_f32_bf16 v22, v135, s70, v36
  v_dot2_f32_bf16 v23, v135, s71, v36
  v_cvt_pk_bf16_f32 v132, v16, v17
  v_cvt_pk_bf16_f32 v133, v18, v19
  v_cvt_pk_bf16_f32 v134, v20, v21
  v_cvt_pk_bf16_f32 v135, v22, v23
  v_dot2_f32_bf16 v16, v136, s70, v36
  v_dot2_f32_bf16 v17, v136, s71, v36
  v_dot2_f32_bf16 v18, v137, s70, v36
  v_dot2_f32_bf16 v19, v137, s71, v36
  v_dot2_f32_bf16 v20, v138, s70, v36
  v_dot2_f32_bf16 v21, v138, s71, v36
  v_dot2_f32_bf16 v22, v139, s70, v36
  v_dot2_f32_bf16 v23, v139, s71, v36
  v_add_u32 v2, s86, v46
  v_cvt_pk_bf16_f32 v136, v16, v17
  v_cvt_pk_bf16_f32 v137, v18, v19
  v_cvt_pk_bf16_f32 v138, v20, v21
  v_cvt_pk_bf16_f32 v139, v22, v23
  v_dot2_f32_bf16 v16, v140, s70, v36
  v_dot2_f32_bf16 v17, v140, s71, v36
  v_dot2_f32_bf16 v18, v141, s70, v36
  v_dot2_f32_bf16 v19, v141, s71, v36
  v_dot2_f32_bf16 v20, v142, s70, v36
  v_dot2_f32_bf16 v21, v142, s71, v36
  v_dot2_f32_bf16 v22, v143, s70, v36
  v_dot2_f32_bf16 v23, v143, s71, v36
  v_cvt_pk_bf16_f32 v140, v16, v17
  v_cvt_pk_bf16_f32 v141, v18, v19
  v_cvt_pk_bf16_f32 v142, v20, v21
  v_cvt_pk_bf16_f32 v143, v22, v23
  v_dot2_f32_bf16 v16, v144, s70, v36
  v_dot2_f32_bf16 v17, v144, s71, v36
  v_dot2_f32_bf16 v18, v145, s70, v36
  v_dot2_f32_bf16 v19, v145, s71, v36
  v_dot2_f32_bf16 v20, v146, s70, v36
  v_dot2_f32_bf16 v21, v146, s71, v36
  v_dot2_f32_bf16 v22, v147, s70, v36
  v_dot2_f32_bf16 v23, v147, s71, v36
  v_cvt_pk_bf16_f32 v144, v16, v17
  v_cvt_pk_bf16_f32 v145, v18, v19
  v_cvt_pk_bf16_f32 v146, v20, v21
  v_cvt_pk_bf16_f32 v147, v22, v23
  v_dot2_f32_bf16 v16, v148, s70, v36
  v_dot2_f32_bf16 v17, v148, s71, v36
  v_dot2_f32_bf16 v18, v149, s70, v36
  v_dot2_f32_bf16 v19, v149, s71, v36
  buffer_load_dwordx4 v2, s[8:11], 0 offen lds
  v_dot2_f32_bf16 v20, v150, s70, v36
  v_dot2_f32_bf16 v21, v150, s71, v36
  v_dot2_f32_bf16 v22, v151, s70, v36
  v_dot2_f32_bf16 v23, v151, s71, v36
  v_cvt_pk_bf16_f32 v148, v16, v17
  v_cvt_pk_bf16_f32 v149, v18, v19
  v_cvt_pk_bf16_f32 v150, v20, v21
  v_cvt_pk_bf16_f32 v151, v22, v23
  v_dot2_f32_bf16 v16, v152, s70, v36
  v_dot2_f32_bf16 v17, v152, s71, v36
  v_dot2_f32_bf16 v18, v153, s70, v36
  v_dot2_f32_bf16 v19, v153, s71, v36
  v_dot2_f32_bf16 v20, v154, s70, v36
  v_dot2_f32_bf16 v21, v154, s71, v36
  v_dot2_f32_bf16 v22, v155, s70, v36
  v_dot2_f32_bf16 v23, v155, s71, v36
  v_cvt_pk_bf16_f32 v152, v16, v17
  v_cvt_pk_bf16_f32 v153, v18, v19
  v_cvt_pk_bf16_f32 v154, v20, v21
  v_cvt_pk_bf16_f32 v155, v22, v23
  v_dot2_f32_bf16 v16, v156, s70, v36
  v_dot2_f32_bf16 v17, v156, s71, v36
  v_dot2_f32_bf16 v18, v157, s70, v36
  v_dot2_f32_bf16 v19, v157, s71, v36
  v_dot2_f32_bf16 v20, v158, s70, v36
  v_dot2_f32_bf16 v21, v158, s71, v36
  v_dot2_f32_bf16 v22, v159, s70, v36
  v_dot2_f32_bf16 v23, v159, s71, v36
  v_cvt_pk_bf16_f32 v156, v16, v17
  v_cvt_pk_bf16_f32 v157, v18, v19
  v_cvt_pk_bf16_f32 v158, v20, v21
  v_cvt_pk_bf16_f32 v159, v22, v23
  buffer_load_dwordx4 v2, s[8:11], s53 offen offset:1024 lds
  v_dot2_f32_bf16 v16, v160, s70, v36
  v_dot2_f32_bf16 v17, v160, s71, v36
  v_dot2_f32_bf16 v18, v161, s70, v36
  v_dot2_f32_bf16 v19, v161, s71, v36
  v_dot2_f32_bf16 v20, v162, s70, v36
  v_dot2_f32_bf16 v21, v162, s71, v36
  v_dot2_f32_bf16 v22, v163, s70, v36
  v_dot2_f32_bf16 v23, v163, s71, v36
  v_cvt_pk_bf16_f32 v160, v16, v17
  v_cvt_pk_bf16_f32 v161, v18, v19
  v_cvt_pk_bf16_f32 v162, v20, v21
  v_cvt_pk_bf16_f32 v163, v22, v23
  v_dot2_f32_bf16 v16, v164, s70, v36
  v_dot2_f32_bf16 v17, v164, s71, v36
  v_dot2_f32_bf16 v18, v165, s70, v36
  v_dot2_f32_bf16 v19, v165, s71, v36
  v_dot2_f32_bf16 v20, v166, s70, v36
  v_dot2_f32_bf16 v21, v166, s71, v36
  v_dot2_f32_bf16 v22, v167, s70, v36
  v_dot2_f32_bf16 v23, v167, s71, v36
  v_cvt_pk_bf16_f32 v164, v16, v17
  v_cvt_pk_bf16_f32 v165, v18, v19
  v_cvt_pk_bf16_f32 v166, v20, v21
  v_cvt_pk_bf16_f32 v167, v22, v23
  v_dot2_f32_bf16 v16, v168, s70, v36
  v_dot2_f32_bf16 v17, v168, s71, v36
  v_dot2_f32_bf16 v18, v169, s70, v36
  v_dot2_f32_bf16 v19, v169, s71, v36
  v_dot2_f32_bf16 v20, v170, s70, v36
  v_dot2_f32_bf16 v21, v170, s71, v36
  v_dot2_f32_bf16 v22, v171, s70, v36
  v_dot2_f32_bf16 v23, v171, s71, v36
  buffer_load_dwordx4 v2, s[8:11], s54 offen offset:2048 lds
  v_cvt_pk_bf16_f32 v168, v16, v17
  v_cvt_pk_bf16_f32 v169, v18, v19
  v_cvt_pk_bf16_f32 v170, v20, v21
  v_cvt_pk_bf16_f32 v171, v22, v23
  v_dot2_f32_bf16 v16, v172, s70, v36
  v_dot2_f32_bf16 v17, v172, s71, v36
  v_dot2_f32_bf16 v18, v173, s70, v36
  v_dot2_f32_bf16 v19, v173, s71, v36
  v_dot2_f32_bf16 v20, v174, s70, v36
  v_dot2_f32_bf16 v21, v174, s71, v36
  v_dot2_f32_bf16 v22, v175, s70, v36
  v_dot2_f32_bf16 v23, v175, s71, v36
  v_cvt_pk_bf16_f32 v172, v16, v17
  v_cvt_pk_bf16_f32 v173, v18, v19
  v_cvt_pk_bf16_f32 v174, v20, v21
  v_cvt_pk_bf16_f32 v175, v22, v23
  v_dot2_f32_bf16 v16, v176, s70, v36
  v_dot2_f32_bf16 v17, v176, s71, v36
  v_dot2_f32_bf16 v18, v177, s70, v36
  v_dot2_f32_bf16 v19, v177, s71, v36
  v_dot2_f32_bf16 v20, v178, s70, v36
  v_dot2_f32_bf16 v21, v178, s71, v36
  v_dot2_f32_bf16 v22, v179, s70, v36
  v_dot2_f32_bf16 v23, v179, s71, v36
  v_cvt_pk_bf16_f32 v176, v16, v17
  v_cvt_pk_bf16_f32 v177, v18, v19
  v_cvt_pk_bf16_f32 v178, v20, v21
  v_cvt_pk_bf16_f32 v179, v22, v23
  v_dot2_f32_bf16 v16, v180, s70, v36
  v_dot2_f32_bf16 v17, v180, s71, v36
  v_dot2_f32_bf16 v18, v181, s70, v36
  v_dot2_f32_bf16 v19, v181, s71, v36
  buffer_load_dwordx4 v2, s[8:11], s55 offen offset:3072 lds
  v_dot2_f32_bf16 v20, v182, s70, v36
  v_dot2_f32_bf16 v21, v182, s71, v36
  v_dot2_f32_bf16 v22, v183, s70, v36
  v_dot2_f32_bf16 v23, v183, s71, v36
  v_cvt_pk_bf16_f32 v180, v16, v17
  v_cvt_pk_bf16_f32 v181, v18, v19
  v_cvt_pk_bf16_f32 v182, v20, v21
  v_cvt_pk_bf16_f32 v183, v22, v23
  v_dot2_f32_bf16 v16, v184, s70, v36
  v_dot2_f32_bf16 v17, v184, s71, v36
  v_dot2_f32_bf16 v18, v185, s70, v36
  v_dot2_f32_bf16 v19, v185, s71, v36
  v_dot2_f32_bf16 v20, v186, s70, v36
  v_dot2_f32_bf16 v21, v186, s71, v36
  v_dot2_f32_bf16 v22, v187, s70, v36
  v_dot2_f32_bf16 v23, v187, s71, v36
  v_cvt_pk_bf16_f32 v184, v16, v17
  v_cvt_pk_bf16_f32 v185, v18, v19
  v_cvt_pk_bf16_f32 v186, v20, v21
  v_cvt_pk_bf16_f32 v187, v22, v23
  v_dot2_f32_bf16 v16, v188, s70, v36
  v_dot2_f32_bf16 v17, v188, s71, v36
  v_dot2_f32_bf16 v18, v189, s70, v36
  v_dot2_f32_bf16 v19, v189, s71, v36
  v_dot2_f32_bf16 v20, v190, s70, v36
  v_dot2_f32_bf16 v21, v190, s71, v36
  v_dot2_f32_bf16 v22, v191, s70, v36
  v_dot2_f32_bf16 v23, v191, s71, v36
  v_cvt_pk_bf16_f32 v188, v16, v17
  v_cvt_pk_bf16_f32 v189, v18, v19
  v_cvt_pk_bf16_f32 v190, v20, v21
  v_cvt_pk_bf16_f32 v191, v22, v23
  s_add_u32 m0, s63, 16384
  v_dot2_f32_bf16 v16, v192, s70, v36
  v_dot2_f32_bf16 v17, v192, s71, v36
  v_dot2_f32_bf16 v18, v193, s70, v36
  v_dot2_f32_bf16 v19, v193, s71, v36
  v_dot2_f32_bf16 v20, v194, s70, v36
  v_dot2_f32_bf16 v21, v194, s71, v36
  v_dot2_f32_bf16 v22, v195, s70, v36
  v_dot2_f32_bf16 v23, v195, s71, v36
  v_cvt_pk_bf16_f32 v192, v16, v17
  v_cvt_pk_bf16_f32 v193, v18, v19
  v_cvt_pk_bf16_f32 v194, v20, v21
  v_cvt_pk_bf16_f32 v195, v22, v23
  v_dot2_f32_bf16 v16, v196, s70, v36
  v_dot2_f32_bf16 v17, v196, s71, v36
  v_dot2_f32_bf16 v18, v197, s70, v36
  v_dot2_f32_bf16 v19, v197, s71, v36
  v_dot2_f32_bf16 v20, v198, s70, v36
  v_dot2_f32_bf16 v21, v198, s71, v36
  v_dot2_f32_bf16 v22, v199, s70, v36
  v_dot2_f32_bf16 v23, v199, s71, v36
  v_cvt_pk_bf16_f32 v196, v16, v17
  v_cvt_pk_bf16_f32 v197, v18, v19
  v_cvt_pk_bf16_f32 v198, v20, v21
  v_cvt_pk_bf16_f32 v199, v22, v23
  v_dot2_f32_bf16 v16, v200, s70, v36
  v_dot2_f32_bf16 v17, v200, s71, v36
  v_dot2_f32_bf16 v18, v201, s70, v36
  v_dot2_f32_bf16 v19, v201, s71, v36
  v_dot2_f32_bf16 v20, v202, s70, v36
  v_dot2_f32_bf16 v21, v202, s71, v36
  v_dot2_f32_bf16 v22, v203, s70, v36
  v_dot2_f32_bf16 v23, v203, s71, v36
  v_add_u32 v2, s87, v46
  v_cvt_pk_bf16_f32 v200, v16, v17
  v_cvt_pk_bf16_f32 v201, v18, v19
  v_cvt_pk_bf16_f32 v202, v20, v21
  v_cvt_pk_bf16_f32 v203, v22, v23
  v_dot2_f32_bf16 v16, v204, s70, v36
  v_dot2_f32_bf16 v17, v204, s71, v36
  v_dot2_f32_bf16 v18, v205, s70, v36
  v_dot2_f32_bf16 v19, v205, s71, v36
  v_dot2_f32_bf16 v20, v206, s70, v36
  v_dot2_f32_bf16 v21, v206, s71, v36
  v_dot2_f32_bf16 v22, v207, s70, v36
  v_dot2_f32_bf16 v23, v207, s71, v36
  v_cvt_pk_bf16_f32 v204, v16, v17
  v_cvt_pk_bf16_f32 v205, v18, v19
  v_cvt_pk_bf16_f32 v206, v20, v21
  v_cvt_pk_bf16_f32 v207, v22, v23
  v_dot2_f32_bf16 v16, v208, s70, v36
  v_dot2_f32_bf16 v17, v208, s71, v36
  v_dot2_f32_bf16 v18, v209, s70, v36
  v_dot2_f32_bf16 v19, v209, s71, v36
  v_dot2_f32_bf16 v20, v210, s70, v36
  v_dot2_f32_bf16 v21, v210, s71, v36
  v_dot2_f32_bf16 v22, v211, s70, v36
  v_dot2_f32_bf16 v23, v211, s71, v36
  v_cvt_pk_bf16_f32 v208, v16, v17
  v_cvt_pk_bf16_f32 v209, v18, v19
  v_cvt_pk_bf16_f32 v210, v20, v21
  v_cvt_pk_bf16_f32 v211, v22, v23
  v_dot2_f32_bf16 v16, v212, s70, v36
  v_dot2_f32_bf16 v17, v212, s71, v36
  v_dot2_f32_bf16 v18, v213, s70, v36
  v_dot2_f32_bf16 v19, v213, s71, v36
  buffer_load_dwordx4 v2, s[8:11], 0 offen lds
  v_dot2_f32_bf16 v20, v214, s70, v36
  v_dot2_f32_bf16 v21, v214, s71, v36
  v_dot2_f32_bf16 v22, v215, s70, v36
  v_dot2_f32_bf16 v23, v215, s71, v36
  v_cvt_pk_bf16_f32 v212, v16, v17
  v_cvt_pk_bf16_f32 v213, v18, v19
  v_cvt_pk_bf16_f32 v214, v20, v21
  v_cvt_pk_bf16_f32 v215, v22, v23
  v_dot2_f32_bf16 v16, v216, s70, v36
  v_dot2_f32_bf16 v17, v216, s71, v36
  v_dot2_f32_bf16 v18, v217, s70, v36
  v_dot2_f32_bf16 v19, v217, s71, v36
  v_dot2_f32_bf16 v20, v218, s70, v36
  v_dot2_f32_bf16 v21, v218, s71, v36
  v_dot2_f32_bf16 v22, v219, s70, v36
  v_dot2_f32_bf16 v23, v219, s71, v36
  v_cvt_pk_bf16_f32 v216, v16, v17
  v_cvt_pk_bf16_f32 v217, v18, v19
  v_cvt_pk_bf16_f32 v218, v20, v21
  v_cvt_pk_bf16_f32 v219, v22, v23
  v_dot2_f32_bf16 v16, v220, s70, v36
  v_dot2_f32_bf16 v17, v220, s71, v36
  v_dot2_f32_bf16 v18, v221, s70, v36
  v_dot2_f32_bf16 v19, v221, s71, v36
  v_dot2_f32_bf16 v20, v222, s70, v36
  v_dot2_f32_bf16 v21, v222, s71, v36
  v_dot2_f32_bf16 v22, v223, s70, v36
  v_dot2_f32_bf16 v23, v223, s71, v36
  v_cvt_pk_bf16_f32 v220, v16, v17
  v_cvt_pk_bf16_f32 v221, v18, v19
  v_cvt_pk_bf16_f32 v222, v20, v21
  v_cvt_pk_bf16_f32 v223, v22, v23
  buffer_load_dwordx4 v2, s[8:11], s53 offen offset:1024 lds
  v_dot2_f32_bf16 v16, v224, s70, v36
  v_dot2_f32_bf16 v17, v224, s71, v36
  v_dot2_f32_bf16 v18, v225, s70, v36
  v_dot2_f32_bf16 v19, v225, s71, v36
  v_dot2_f32_bf16 v20, v226, s70, v36
  v_dot2_f32_bf16 v21, v226, s71, v36
  v_dot2_f32_bf16 v22, v227, s70, v36
  v_dot2_f32_bf16 v23, v227, s71, v36
  v_cvt_pk_bf16_f32 v224, v16, v17
  v_cvt_pk_bf16_f32 v225, v18, v19
  v_cvt_pk_bf16_f32 v226, v20, v21
  v_cvt_pk_bf16_f32 v227, v22, v23
  v_dot2_f32_bf16 v16, v228, s70, v36
  v_dot2_f32_bf16 v17, v228, s71, v36
  v_dot2_f32_bf16 v18, v229, s70, v36
  v_dot2_f32_bf16 v19, v229, s71, v36
  v_dot2_f32_bf16 v20, v230, s70, v36
  v_dot2_f32_bf16 v21, v230, s71, v36
  v_dot2_f32_bf16 v22, v231, s70, v36
  v_dot2_f32_bf16 v23, v231, s71, v36
  v_cvt_pk_bf16_f32 v228, v16, v17
  v_cvt_pk_bf16_f32 v229, v18, v19
  v_cvt_pk_bf16_f32 v230, v20, v21
  v_cvt_pk_bf16_f32 v231, v22, v23
  v_dot2_f32_bf16 v16, v232, s70, v36
  v_dot2_f32_bf16 v17, v232, s71, v36
  v_dot2_f32_bf16 v18, v233, s70, v36
  v_dot2_f32_bf16 v19, v233, s71, v36
  v_dot2_f32_bf16 v20, v234, s70, v36
  v_dot2_f32_bf16 v21, v234, s71, v36
  v_dot2_f32_bf16 v22, v235, s70, v36
  v_dot2_f32_bf16 v23, v235, s71, v36
  buffer_load_dwordx4 v2, s[8:11], s54 offen offset:2048 lds
  v_cvt_pk_bf16_f32 v232, v16, v17
  v_cvt_pk_bf16_f32 v233, v18, v19
  v_cvt_pk_bf16_f32 v234, v20, v21
  v_cvt_pk_bf16_f32 v235, v22, v23
  v_dot2_f32_bf16 v16, v236, s70, v36
  v_dot2_f32_bf16 v17, v236, s71, v36
  v_dot2_f32_bf16 v18, v237, s70, v36
  v_dot2_f32_bf16 v19, v237, s71, v36
  v_dot2_f32_bf16 v20, v238, s70, v36
  v_dot2_f32_bf16 v21, v238, s71, v36
  v_dot2_f32_bf16 v22, v239, s70, v36
  v_dot2_f32_bf16 v23, v239, s71, v36
  v_cvt_pk_bf16_f32 v236, v16, v17
  v_cvt_pk_bf16_f32 v237, v18, v19
  v_cvt_pk_bf16_f32 v238, v20, v21
  v_cvt_pk_bf16_f32 v239, v22, v23
  v_dot2_f32_bf16 v16, v240, s70, v36
  v_dot2_f32_bf16 v17, v240, s71, v36
  v_dot2_f32_bf16 v18, v241, s70, v36
  v_dot2_f32_bf16 v19, v241, s71, v36
  v_dot2_f32_bf16 v20, v242, s70, v36
  v_dot2_f32_bf16 v21, v242, s71, v36
  v_dot2_f32_bf16 v22, v243, s70, v36
  v_dot2_f32_bf16 v23, v243, s71, v36
  v_cvt_pk_bf16_f32 v240, v16, v17
  v_cvt_pk_bf16_f32 v241, v18, v19
  v_cvt_pk_bf16_f32 v242, v20, v21
  v_cvt_pk_bf16_f32 v243, v22, v23
  v_dot2_f32_bf16 v16, v244, s70, v36
  v_dot2_f32_bf16 v17, v244, s71, v36
  v_dot2_f32_bf16 v18, v245, s70, v36
  v_dot2_f32_bf16 v19, v245, s71, v36
  buffer_load_dwordx4 v2, s[8:11], s55 offen offset:3072 lds
  v_dot2_f32_bf16 v20, v246, s70, v36
  v_dot2_f32_bf16 v21, v246, s71, v36
  v_dot2_f32_bf16 v22, v247, s70, v36
  v_dot2_f32_bf16 v23, v247, s71, v36
  v_cvt_pk_bf16_f32 v244, v16, v17
  v_cvt_pk_bf16_f32 v245, v18, v19
  v_cvt_pk_bf16_f32 v246, v20, v21
  v_cvt_pk_bf16_f32 v247, v22, v23
  v_dot2_f32_bf16 v16, v248, s70, v36
  v_dot2_f32_bf16 v17, v248, s71, v36
  v_dot2_f32_bf16 v18, v249, s70, v36
  v_dot2_f32_bf16 v19, v249, s71, v36
  v_dot2_f32_bf16 v20, v250, s70, v36
  v_dot2_f32_bf16 v21, v250, s71, v36
  v_dot2_f32_bf16 v22, v251, s70, v36
  v_dot2_f32_bf16 v23, v251, s71, v36
  v_cvt_pk_bf16_f32 v248, v16, v17
  v_cvt_pk_bf16_f32 v249, v18, v19
  v_cvt_pk_bf16_f32 v250, v20, v21
  v_cvt_pk_bf16_f32 v251, v22, v23
  v_dot2_f32_bf16 v16, v252, s70, v36
  v_dot2_f32_bf16 v17, v252, s71, v36
  v_dot2_f32_bf16 v18, v253, s70, v36
  v_dot2_f32_bf16 v19, v253, s71, v36
  v_dot2_f32_bf16 v20, v254, s70, v36
  v_dot2_f32_bf16 v21, v254, s71, v36
  v_dot2_f32_bf16 v22, v255, s70, v36
  v_dot2_f32_bf16 v23, v255, s71, v36
  v_cvt_pk_bf16_f32 v252, v16, v17
  v_cvt_pk_bf16_f32 v253, v18, v19
  v_cvt_pk_bf16_f32 v254, v20, v21
  v_cvt_pk_bf16_f32 v255, v22, v23
  s_waitcnt vmcnt(12)
  s_barrier
  ds_read_b64_tr_b16 a[224:225], v1 offset:32768
  ds_read_b64_tr_b16 a[226:227], v1 offset:33024
  ds_read_b64_tr_b16 a[228:229], v1 offset:33280
  ds_read_b64_tr_b16 a[230:231], v1 offset:33536
  ds_read_b64_tr_b16 a[232:233], v1 offset:34816
  ds_read_b64_tr_b16 a[234:235], v1 offset:35072
  ds_read_b64_tr_b16 a[236:237], v1 offset:35328
  ds_read_b64_tr_b16 a[238:239], v1 offset:35584
  ds_read_b64_tr_b16 a[240:241], v1 offset:36864
  ds_read_b64_tr_b16 a[242:243], v1 offset:37120
  ds_read_b64_tr_b16 a[244:245], v1 offset:37376
  ds_read_b64_tr_b16 a[246:247], v1 offset:37632
  ds_read_b64_tr_b16 a[248:249], v1 offset:38912
  ds_read_b64_tr_b16 a[250:251], v1 offset:39168
  ds_read_b64_tr_b16 a[252:253], v1 offset:39424
  ds_read_b64_tr_b16 a[254:255], v1 offset:39680
  s_waitcnt lgkmcnt(8)
  v_mfma_f32_32x32x16_bf16 v[80:95], a[224:227], v[128:131], 0
  ds_read_b64_tr_b16 a[224:225], v1 offset:40960
  ds_read_b64_tr_b16 a[226:227], v1 offset:41216
  v_mfma_f32_32x32x16_bf16 v[96:111], v[128:131], a[228:231], 0
  ds_read_b64_tr_b16 a[228:229], v1 offset:41472
  ds_read_b64_tr_b16 a[230:231], v1 offset:41728
  v_mfma_f32_32x32x16_bf16 v[80:95], a[232:235], v[132:135], v[80:95]
  ds_read_b64_tr_b16 a[232:233], v1 offset:43008
  ds_read_b64_tr_b16 a[234:235], v1 offset:43264
  v_mfma_f32_32x32x16_bf16 v[96:111], v[132:135], a[236:239], v[96:111]
  ds_read_b64_tr_b16 a[236:237], v1 offset:43520
  ds_read_b64_tr_b16 a[238:239], v1 offset:43776
  s_waitcnt lgkmcnt(8)
  v_mfma_f32_32x32x16_bf16 v[80:95], a[240:243], v[136:139], v[80:95]
  ds_read_b64_tr_b16 a[240:241], v1 offset:45056
  ds_read_b64_tr_b16 a[242:243], v1 offset:45312
  v_and_b32 v16, 0x1f0, v0
  v_lshrrev_b32 v16, 2, v16
  v_mfma_f32_32x32x16_bf16 v[96:111], v[136:139], a[244:247], v[96:111]
  ds_read_b64_tr_b16 a[244:245], v1 offset:45568
  ds_read_b64_tr_b16 a[246:247], v1 offset:45824
  s_lshl_b32 s77, s43, 7
  v_add_u32 v16, s77, v16
  v_mfma_f32_32x32x16_bf16 v[80:95], a[248:251], v[140:143], v[80:95]
  ds_write_b32 v16, v10
  ds_read_b64_tr_b16 a[248:249], v1 offset:47104
  ds_read_b64_tr_b16 a[250:251], v1 offset:47360
  v_mov_b32 v20, 0
  v_mov_b32 v22, 0
  v_mfma_f32_32x32x16_bf16 v[96:111], v[140:143], a[252:255], v[96:111]
  ds_read_b64_tr_b16 a[252:253], v1 offset:47616
  ds_read_b64_tr_b16 a[254:255], v1 offset:47872
  v_mov_b32 v21, s44
  s_waitcnt lgkmcnt(9)
  v_mfma_f32_32x32x16_bf16 v[80:95], a[224:227], v[144:147], v[80:95]
  v_mov_b32 v23, s44
  v_lshlrev_b32 v24, 22, v0
  v_and_b32 v24, 0x80000000, v24
  v_or_b32 v24, v24, v0
  v_mfma_f32_32x32x16_bf16 v[96:111], v[144:147], a[228:231], v[96:111]
  s_waitcnt vmcnt(8) lgkmcnt(0)
  s_barrier
  ds_read_b64_tr_b16 a[224:225], v1 offset:49152
  ds_read_b64_tr_b16 a[226:227], v1 offset:49408
  ds_read_b64_tr_b16 a[228:229], v1 offset:49664
  ds_read_b64_tr_b16 a[230:231], v1 offset:49920
  v_mfma_f32_32x32x16_bf16 v[80:95], a[232:235], v[148:151], v[80:95]
  ds_read_b64_tr_b16 a[232:233], v1 offset:51200
  ds_read_b64_tr_b16 a[234:235], v1 offset:51456
  s_add_u32 m0, s63, 32768
  v_mfma_f32_32x32x16_bf16 v[96:111], v[148:151], a[236:239], v[96:111]
  ds_read_b64_tr_b16 a[236:237], v1 offset:51712
  ds_read_b64_tr_b16 a[238:239], v1 offset:51968
  v_mfma_f32_32x32x16_bf16 v[80:95], a[240:243], v[152:155], v[80:95]
  buffer_load_dwordx4 v43, s[8:11], 0 offen lds
  ds_read_b64_tr_b16 a[240:241], v1 offset:53248
  ds_read_b64_tr_b16 a[242:243], v1 offset:53504
  v_mfma_f32_32x32x16_bf16 v[96:111], v[152:155], a[244:247], v[96:111]
  ds_read_b64_tr_b16 a[244:245], v1 offset:53760
  ds_read_b64_tr_b16 a[246:247], v1 offset:54016
  v_mfma_f32_32x32x16_bf16 v[80:95], a[248:251], v[156:159], v[80:95]
  ds_read_b64_tr_b16 a[248:249], v1 offset:55296
  ds_read_b64_tr_b16 a[250:251], v1 offset:55552
  v_mfma_f32_32x32x16_bf16 v[96:111], v[156:159], a[252:255], v[96:111]
  ds_read_b64_tr_b16 a[252:253], v1 offset:55808
  ds_read_b64_tr_b16 a[254:255], v1 offset:56064
  s_waitcnt lgkmcnt(8)
  v_mfma_f32_32x32x16_bf16 v[80:95], a[224:227], v[160:163], v[80:95]
  buffer_load_dwordx4 v43, s[8:11], s53 offen offset:1024 lds
  ds_read_b64_tr_b16 a[224:225], v1 offset:57344
  ds_read_b64_tr_b16 a[226:227], v1 offset:57600
  v_mfma_f32_32x32x16_bf16 v[96:111], v[160:163], a[228:231], v[96:111]
  ds_read_b64_tr_b16 a[228:229], v1 offset:57856
  ds_read_b64_tr_b16 a[230:231], v1 offset:58112
  v_mfma_f32_32x32x16_bf16 v[80:95], a[232:235], v[164:167], v[80:95]
  s_lshl_b32 s77, s46, 4
  s_add_u32 s77, s77, s41
  s_lshl_b32 s77, s77, 9
  s_add_u32 s77, s77, 1048576
  buffer_store_dwordx4 v[20:23], v24, s[36:39], s77 offen sc1
  ds_read_b64_tr_b16 a[232:233], v1 offset:59392
  ds_read_b64_tr_b16 a[234:235], v1 offset:59648
  v_mfma_f32_32x32x16_bf16 v[96:111], v[164:167], a[236:239], v[96:111]
  ds_read_b64_tr_b16 a[236:237], v1 offset:59904
  ds_read_b64_tr_b16 a[238:239], v1 offset:60160
  s_waitcnt lgkmcnt(8)
  v_mfma_f32_32x32x16_bf16 v[80:95], a[240:243], v[168:171], v[80:95]
  buffer_load_dwordx4 v43, s[8:11], s54 offen offset:2048 lds
  ds_read_b64_tr_b16 a[240:241], v1 offset:61440
  ds_read_b64_tr_b16 a[242:243], v1 offset:61696
  v_mfma_f32_32x32x16_bf16 v[96:111], v[168:171], a[244:247], v[96:111]
  ds_read_b64_tr_b16 a[244:245], v1 offset:61952
  ds_read_b64_tr_b16 a[246:247], v1 offset:62208
  v_mfma_f32_32x32x16_bf16 v[80:95], a[248:251], v[172:175], v[80:95]
  ds_read_b64_tr_b16 a[248:249], v1 offset:63488
  ds_read_b64_tr_b16 a[250:251], v1 offset:63744
  v_mfma_f32_32x32x16_bf16 v[96:111], v[172:175], a[252:255], v[96:111]
  ds_read_b64_tr_b16 a[252:253], v1 offset:64000
  ds_read_b64_tr_b16 a[254:255], v1 offset:64256
  s_waitcnt lgkmcnt(8)
  v_mfma_f32_32x32x16_bf16 v[80:95], a[224:227], v[176:179], v[80:95]
  buffer_load_dwordx4 v43, s[8:11], s55 offen offset:3072 lds
  v_mfma_f32_32x32x16_bf16 v[96:111], v[176:179], a[228:231], v[96:111]
  s_waitcnt vmcnt(9) lgkmcnt(0)
  s_barrier
  ds_read_b64_tr_b16 a[224:225], v1
  ds_read_b64_tr_b16 a[226:227], v1 offset:256
  ds_read_b64_tr_b16 a[228:229], v1 offset:512
  ds_read_b64_tr_b16 a[230:231], v1 offset:768
  v_mfma_f32_32x32x16_bf16 v[80:95], a[232:235], v[180:183], v[80:95]
  ds_read_b64_tr_b16 a[232:233], v1 offset:2048
  ds_read_b64_tr_b16 a[234:235], v1 offset:2304
  s_add_u32 m0, s63, 49152
  v_mfma_f32_32x32x16_bf16 v[96:111], v[180:183], a[236:239], v[96:111]
  ds_read_b64_tr_b16 a[236:237], v1 offset:2560
  ds_read_b64_tr_b16 a[238:239], v1 offset:2816
  v_mfma_f32_32x32x16_bf16 v[80:95], a[240:243], v[184:187], v[80:95]
  buffer_load_dwordx4 v44, s[8:11], 0 offen lds
  ds_read_b64_tr_b16 a[240:241], v1 offset:4096
  ds_read_b64_tr_b16 a[242:243], v1 offset:4352
  v_mfma_f32_32x32x16_bf16 v[96:111], v[184:187], a[244:247], v[96:111]
  ds_read_b64_tr_b16 a[244:245], v1 offset:4608
  ds_read_b64_tr_b16 a[246:247], v1 offset:4864
  v_mfma_f32_32x32x16_bf16 v[80:95], a[248:251], v[188:191], v[80:95]
  ds_read_b64_tr_b16 a[248:249], v1 offset:6144
  ds_read_b64_tr_b16 a[250:251], v1 offset:6400
  v_mfma_f32_32x32x16_bf16 v[96:111], v[188:191], a[252:255], v[96:111]
  ds_read_b64_tr_b16 a[252:253], v1 offset:6656
  ds_read_b64_tr_b16 a[254:255], v1 offset:6912
  s_waitcnt lgkmcnt(8)
  v_mfma_f32_32x32x16_bf16 v[80:95], a[224:227], v[192:195], v[80:95]
  buffer_load_dwordx4 v44, s[8:11], s53 offen offset:1024 lds
  ds_read_b64_tr_b16 a[224:225], v1 offset:8192
  ds_read_b64_tr_b16 a[226:227], v1 offset:8448
  v_mfma_f32_32x32x16_bf16 v[96:111], v[192:195], a[228:231], v[96:111]
  ds_read_b64_tr_b16 a[228:229], v1 offset:8704
  ds_read_b64_tr_b16 a[230:231], v1 offset:8960
  v_mfma_f32_32x32x16_bf16 v[80:95], a[232:235], v[196:199], v[80:95]
  ds_read_b64_tr_b16 a[232:233], v1 offset:10240
  ds_read_b64_tr_b16 a[234:235], v1 offset:10496
  v_mfma_f32_32x32x16_bf16 v[96:111], v[196:199], a[236:239], v[96:111]
  ds_read_b64_tr_b16 a[236:237], v1 offset:10752
  ds_read_b64_tr_b16 a[238:239], v1 offset:11008
  s_waitcnt lgkmcnt(8)
  v_mfma_f32_32x32x16_bf16 v[80:95], a[240:243], v[200:203], v[80:95]
  buffer_load_dwordx4 v44, s[8:11], s54 offen offset:2048 lds
  ds_read_b64_tr_b16 a[240:241], v1 offset:12288
  ds_read_b64_tr_b16 a[242:243], v1 offset:12544
  v_mfma_f32_32x32x16_bf16 v[96:111], v[200:203], a[244:247], v[96:111]
  ds_read_b64_tr_b16 a[244:245], v1 offset:12800
  ds_read_b64_tr_b16 a[246:247], v1 offset:13056
  v_mfma_f32_32x32x16_bf16 v[80:95], a[248:251], v[204:207], v[80:95]
  ds_read_b64_tr_b16 a[248:249], v1 offset:14336
  ds_read_b64_tr_b16 a[250:251], v1 offset:14592
  v_mfma_f32_32x32x16_bf16 v[96:111], v[204:207], a[252:255], v[96:111]
  ds_read_b64_tr_b16 a[252:253], v1 offset:14848
  ds_read_b64_tr_b16 a[254:255], v1 offset:15104
  s_waitcnt lgkmcnt(8)
  v_mfma_f32_32x32x16_bf16 v[80:95], a[224:227], v[208:211], v[80:95]
  buffer_load_dwordx4 v44, s[8:11], s55 offen offset:3072 lds
  v_mfma_f32_32x32x16_bf16 v[96:111], v[208:211], a[228:231], v[96:111]
  s_waitcnt vmcnt(9) lgkmcnt(0)
  s_barrier
  ds_read_b64_tr_b16 a[224:225], v1 offset:16384
  ds_read_b64_tr_b16 a[226:227], v1 offset:16640
  ds_read_b64_tr_b16 a[228:229], v1 offset:16896
  ds_read_b64_tr_b16 a[230:231], v1 offset:17152
  v_mfma_f32_32x32x16_bf16 v[80:95], a[232:235], v[212:215], v[80:95]
  ds_read_b64_tr_b16 a[232:233], v1 offset:18432
  ds_read_b64_tr_b16 a[234:235], v1 offset:18688
  v_mfma_f32_32x32x16_bf16 v[96:111], v[212:215], a[236:239], v[96:111]
  ds_read_b64_tr_b16 a[236:237], v1 offset:18944
  ds_read_b64_tr_b16 a[238:239], v1 offset:19200
  v_mfma_f32_32x32x16_bf16 v[80:95], a[240:243], v[216:219], v[80:95]
  ds_read_b64_tr_b16 a[240:241], v1 offset:20480
  ds_read_b64_tr_b16 a[242:243], v1 offset:20736
  v_mfma_f32_32x32x16_bf16 v[96:111], v[216:219], a[244:247], v[96:111]
  ds_read_b64_tr_b16 a[244:245], v1 offset:20992
  ds_read_b64_tr_b16 a[246:247], v1 offset:21248
  v_mfma_f32_32x32x16_bf16 v[80:95], a[248:251], v[220:223], v[80:95]
  ds_read_b64_tr_b16 a[248:249], v1 offset:22528
  ds_read_b64_tr_b16 a[250:251], v1 offset:22784
  v_mfma_f32_32x32x16_bf16 v[96:111], v[220:223], a[252:255], v[96:111]
  ds_read_b64_tr_b16 a[252:253], v1 offset:23040
  ds_read_b64_tr_b16 a[254:255], v1 offset:23296
  s_waitcnt lgkmcnt(8)
  v_mfma_f32_32x32x16_bf16 v[80:95], a[224:227], v[224:227], v[80:95]
  ds_read_b64_tr_b16 a[224:225], v1 offset:24576
  ds_read_b64_tr_b16 a[226:227], v1 offset:24832
  v_mfma_f32_32x32x16_bf16 v[96:111], v[224:227], a[228:231], v[96:111]
  ds_read_b64_tr_b16 a[228:229], v1 offset:25088
  ds_read_b64_tr_b16 a[230:231], v1 offset:25344
  v_mfma_f32_32x32x16_bf16 v[80:95], a[232:235], v[228:231], v[80:95]
  ds_read_b64_tr_b16 a[232:233], v1 offset:26624
  ds_read_b64_tr_b16 a[234:235], v1 offset:26880
  v_mfma_f32_32x32x16_bf16 v[96:111], v[228:231], a[236:239], v[96:111]
  ds_read_b64_tr_b16 a[236:237], v1 offset:27136
  ds_read_b64_tr_b16 a[238:239], v1 offset:27392
  s_waitcnt lgkmcnt(8)
  v_mfma_f32_32x32x16_bf16 v[80:95], a[240:243], v[232:235], v[80:95]
  ds_read_b64_tr_b16 a[240:241], v1 offset:28672
  ds_read_b64_tr_b16 a[242:243], v1 offset:28928
  v_mfma_f32_32x32x16_bf16 v[96:111], v[232:235], a[244:247], v[96:111]
  ds_read_b64_tr_b16 a[244:245], v1 offset:29184
  ds_read_b64_tr_b16 a[246:247], v1 offset:29440
  v_mfma_f32_32x32x16_bf16 v[80:95], a[248:251], v[236:239], v[80:95]
  ds_read_b64_tr_b16 a[248:249], v1 offset:30720
  ds_read_b64_tr_b16 a[250:251], v1 offset:30976
  v_mfma_f32_32x32x16_bf16 v[96:111], v[236:239], a[252:255], v[96:111]
  ds_read_b64_tr_b16 a[252:253], v1 offset:31232
  ds_read_b64_tr_b16 a[254:255], v1 offset:31488
  s_waitcnt lgkmcnt(8)
  v_mfma_f32_32x32x16_bf16 v[80:95], a[224:227], v[240:243], v[80:95]
  v_mfma_f32_32x32x16_bf16 v[96:111], v[240:243], a[228:231], v[96:111]
  s_waitcnt vmcnt(4) lgkmcnt(0)
  s_barrier
  ds_read_b64_tr_b16 a[224:225], v1 offset:32768
  ds_read_b64_tr_b16 a[226:227], v1 offset:33024
  ds_read_b64_tr_b16 a[228:229], v1 offset:33280
  ds_read_b64_tr_b16 a[230:231], v1 offset:33536
  v_mfma_f32_32x32x16_bf16 v[80:95], a[232:235], v[244:247], v[80:95]
  ds_read_b64_tr_b16 a[232:233], v1 offset:34816
  ds_read_b64_tr_b16 a[234:235], v1 offset:35072
  v_mfma_f32_32x32x16_bf16 v[96:111], v[244:247], a[236:239], v[96:111]
  ds_read_b64_tr_b16 a[236:237], v1 offset:35328
  ds_read_b64_tr_b16 a[238:239], v1 offset:35584
  v_mfma_f32_32x32x16_bf16 v[80:95], a[240:243], v[248:251], v[80:95]
  ds_read_b64_tr_b16 a[240:241], v1 offset:36864
  ds_read_b64_tr_b16 a[242:243], v1 offset:37120
  v_mfma_f32_32x32x16_bf16 v[96:111], v[248:251], a[244:247], v[96:111]
  ds_read_b64_tr_b16 a[244:245], v1 offset:37376
  ds_read_b64_tr_b16 a[246:247], v1 offset:37632
  v_mfma_f32_32x32x16_bf16 v[80:95], a[248:251], v[252:255], v[80:95]
  ds_read_b64_tr_b16 a[248:249], v1 offset:38912
  ds_read_b64_tr_b16 a[250:251], v1 offset:39168
  v_mfma_f32_32x32x16_bf16 v[96:111], v[252:255], a[252:255], v[96:111]
  ds_read_b64_tr_b16 a[252:253], v1 offset:39424
  ds_read_b64_tr_b16 a[254:255], v1 offset:39680
  s_waitcnt lgkmcnt(8)
  v_mfma_f32_32x32x16_bf16 v[112:127], a[224:227], v[128:131], 0
  ds_read_b64_tr_b16 a[224:225], v1 offset:40960
  ds_read_b64_tr_b16 a[226:227], v1 offset:41216
  v_mfma_f32_32x32x16_bf16 v[112:127], a[228:231], v[192:195], v[112:127]
  ds_read_b64_tr_b16 a[228:229], v1 offset:41472
  ds_read_b64_tr_b16 a[230:231], v1 offset:41728
  v_mfma_f32_32x32x16_bf16 v[112:127], a[232:235], v[132:135], v[112:127]
  ds_read_b64_tr_b16 a[232:233], v1 offset:43008
  ds_read_b64_tr_b16 a[234:235], v1 offset:43264
  v_mfma_f32_32x32x16_bf16 v[112:127], a[236:239], v[196:199], v[112:127]
  ds_read_b64_tr_b16 a[236:237], v1 offset:43520
  ds_read_b64_tr_b16 a[238:239], v1 offset:43776
  s_waitcnt lgkmcnt(8)
  v_mfma_f32_32x32x16_bf16 v[112:127], a[240:243], v[136:139], v[112:127]
  ds_read_b64_tr_b16 a[240:241], v1 offset:45056
  ds_read_b64_tr_b16 a[242:243], v1 offset:45312
  v_lshrrev_b32 v20, 9, v0
  v_lshlrev_b32 v20, 4, v20
  s_lshl_b32 s77, s43, 7
  v_add_u32 v20, s77, v20
  v_mfma_f32_32x32x16_bf16 v[112:127], a[244:247], v[200:203], v[112:127]
  ds_read_b128 v[24:27], v20
  ds_read_b128 v[28:31], v20 offset:32
  ds_read_b128 v[32:35], v20 offset:64
  ds_read_b64_tr_b16 a[244:245], v1 offset:45568
  ds_read_b64_tr_b16 a[246:247], v1 offset:45824
  v_mfma_f32_32x32x16_bf16 v[112:127], a[248:251], v[140:143], v[112:127]
  ds_read_b128 v[36:39], v20 offset:96
  ds_read_b64_tr_b16 a[248:249], v1 offset:47104
  ds_read_b64_tr_b16 a[250:251], v1 offset:47360
  s_lshl_b32 s77, s43, 12
  s_add_u32 s77, s77, 32768
  v_add_u32 v21, s77, v0
  v_mfma_f32_32x32x16_bf16 v[112:127], a[252:255], v[204:207], v[112:127]
  ds_read_b64_tr_b16 a[252:253], v1 offset:47616
  ds_read_b64_tr_b16 a[254:255], v1 offset:47872
  v_mul_f32 v80, v80, v10
  v_mul_f32 v81, v81, v10
  s_waitcnt lgkmcnt(12)
  v_mfma_f32_32x32x16_bf16 v[112:127], a[224:227], v[144:147], v[112:127]
  v_mul_f32 v82, v82, v10
  v_mul_f32 v83, v83, v10
  v_mul_f32 v84, v84, v10
  v_mul_f32 v85, v85, v10
  v_mul_f32 v86, v86, v10
  v_mul_f32 v87, v87, v10
  v_mfma_f32_32x32x16_bf16 v[112:127], a[228:231], v[208:211], v[112:127]
  s_waitcnt vmcnt(0) lgkmcnt(0)
  s_barrier
  ds_read_b64_tr_b16 a[224:225], v1 offset:49152
  ds_read_b64_tr_b16 a[226:227], v1 offset:49408
  ds_read_b64_tr_b16 a[228:229], v1 offset:49664
  ds_read_b64_tr_b16 a[230:231], v1 offset:49920
  v_mfma_f32_32x32x16_bf16 v[112:127], a[232:235], v[148:151], v[112:127]
  ds_read_b64_tr_b16 a[232:233], v1 offset:51200
  ds_read_b64_tr_b16 a[234:235], v1 offset:51456
  v_mul_f32 v88, v88, v10
  v_mul_f32 v89, v89, v10
  v_mul_f32 v90, v90, v10
  v_mfma_f32_32x32x16_bf16 v[112:127], a[236:239], v[212:215], v[112:127]
  ds_read_b64_tr_b16 a[236:237], v1 offset:51712
  ds_read_b64_tr_b16 a[238:239], v1 offset:51968
  v_mul_f32 v91, v91, v10
  v_mul_f32 v92, v92, v10
  v_mul_f32 v93, v93, v10
  v_mfma_f32_32x32x16_bf16 v[112:127], a[240:243], v[152:155], v[112:127]
  ds_read_b64_tr_b16 a[240:241], v1 offset:53248
  ds_read_b64_tr_b16 a[242:243], v1 offset:53504
  v_mul_f32 v94, v94, v10
  v_mul_f32 v95, v95, v10
  v_cvt_pk_bf16_f32 v80, v80, v81
  v_mfma_f32_32x32x16_bf16 v[112:127], a[244:247], v[216:219], v[112:127]
  ds_read_b64_tr_b16 a[244:245], v1 offset:53760
  ds_read_b64_tr_b16 a[246:247], v1 offset:54016
  v_cvt_pk_bf16_f32 v81, v82, v83
  v_cvt_pk_bf16_f32 v82, v84, v85
  v_cvt_pk_bf16_f32 v83, v86, v87
  v_mfma_f32_32x32x16_bf16 v[112:127], a[248:251], v[156:159], v[112:127]
  ds_read_b64_tr_b16 a[248:249], v1 offset:55296
  ds_read_b64_tr_b16 a[250:251], v1 offset:55552
  v_cvt_pk_bf16_f32 v84, v88, v89
  v_cvt_pk_bf16_f32 v85, v90, v91
  v_cvt_pk_bf16_f32 v86, v92, v93
  v_cvt_pk_bf16_f32 v87, v94, v95
  v_mfma_f32_32x32x16_bf16 v[112:127], a[252:255], v[220:223], v[112:127]
  ds_read_b64_tr_b16 a[252:253], v1 offset:55808
  ds_read_b64_tr_b16 a[254:255], v1 offset:56064
  s_lshl_b32 s78, s41, 6
  s_add_u32 s78, s78, s46
  s_lshl_b32 s78, s78, 12
  s_add_u32 s60, s78, 2097152
  s_waitcnt lgkmcnt(8)
  v_mfma_f32_32x32x16_bf16 v[112:127], a[224:227], v[160:163], v[112:127]
  ds_read_b64_tr_b16 a[224:225], v1 offset:57344
  ds_read_b64_tr_b16 a[226:227], v1 offset:57600
  v_mfma_f32_32x32x16_bf16 v[112:127], a[228:231], v[224:227], v[112:127]
  buffer_store_dwordx4 v[80:83], v0, s[36:39], s60 offen sc1
  ds_read_b64_tr_b16 a[228:229], v1 offset:57856
  ds_read_b64_tr_b16 a[230:231], v1 offset:58112
  v_mfma_f32_32x32x16_bf16 v[112:127], a[232:235], v[164:167], v[112:127]
  ds_read_b64_tr_b16 a[232:233], v1 offset:59392
  ds_read_b64_tr_b16 a[234:235], v1 offset:59648
  v_mul_f32 v96, v96, v24
  v_mul_f32 v97, v97, v25
  v_mfma_f32_32x32x16_bf16 v[112:127], a[236:239], v[228:231], v[112:127]
  ds_read_b64_tr_b16 a[236:237], v1 offset:59904
  ds_read_b64_tr_b16 a[238:239], v1 offset:60160
  v_mul_f32 v98, v98, v26
  v_mul_f32 v99, v99, v27
  v_mul_f32 v100, v100, v28
  s_waitcnt lgkmcnt(8)
  v_mfma_f32_32x32x16_bf16 v[112:127], a[240:243], v[168:171], v[112:127]
  ds_write_b128 v21, v[80:83]
  ds_read_b64_tr_b16 a[240:241], v1 offset:61440
  ds_read_b64_tr_b16 a[242:243], v1 offset:61696
  v_mul_f32 v101, v101, v29
  v_mfma_f32_32x32x16_bf16 v[112:127], a[244:247], v[232:235], v[112:127]
  ds_read_b64_tr_b16 a[244:245], v1 offset:61952
  ds_read_b64_tr_b16 a[246:247], v1 offset:62208
  v_mul_f32 v102, v102, v30
  v_mfma_f32_32x32x16_bf16 v[112:127], a[248:251], v[172:175], v[112:127]
  ds_read_b64_tr_b16 a[248:249], v1 offset:63488
  ds_read_b64_tr_b16 a[250:251], v1 offset:63744
  v_mul_f32 v103, v103, v31
  v_mul_f32 v104, v104, v32
  v_mul_f32 v105, v105, v33
  v_mul_f32 v106, v106, v34
  v_mfma_f32_32x32x16_bf16 v[112:127], a[252:255], v[236:239], v[112:127]
  ds_read_b64_tr_b16 a[252:253], v1 offset:64000
  ds_read_b64_tr_b16 a[254:255], v1 offset:64256
  v_mul_f32 v107, v107, v35
  s_waitcnt lgkmcnt(9)
  v_mfma_f32_32x32x16_bf16 v[112:127], a[224:227], v[176:179], v[112:127]
  buffer_store_dwordx4 v[84:87], v0, s[36:39], s60 offen offset:1024 sc1
  v_mul_f32 v108, v108, v36
  v_mfma_f32_32x32x16_bf16 v[112:127], a[228:231], v[240:243], v[112:127]
  v_mul_f32 v109, v109, v37
  v_mul_f32 v110, v110, v38
  v_mul_f32 v111, v111, v39
  v_cvt_pk_bf16_f32 v96, v96, v97
  v_cvt_pk_bf16_f32 v97, v98, v99
  v_mfma_f32_32x32x16_bf16 v[112:127], a[232:235], v[180:183], v[112:127]
  ds_write_b128 v21, v[84:87] offset:1024
  v_cvt_pk_bf16_f32 v98, v100, v101
  v_mfma_f32_32x32x16_bf16 v[112:127], a[236:239], v[244:247], v[112:127]
  v_cvt_pk_bf16_f32 v99, v102, v103
  v_cvt_pk_bf16_f32 v100, v104, v105
  v_cvt_pk_bf16_f32 v101, v106, v107
  v_cvt_pk_bf16_f32 v102, v108, v109
  v_cvt_pk_bf16_f32 v103, v110, v111
  s_waitcnt lgkmcnt(1)
  v_mfma_f32_32x32x16_bf16 v[112:127], a[240:243], v[184:187], v[112:127]
  buffer_store_dwordx4 v[96:99], v0, s[36:39], s60 offen offset:2048 sc1
  v_mfma_f32_32x32x16_bf16 v[112:127], a[244:247], v[248:251], v[112:127]
  ds_write_b128 v21, v[96:99] offset:2048
  v_mfma_f32_32x32x16_bf16 v[112:127], a[248:251], v[188:191], v[112:127]
  buffer_store_dwordx4 v[100:103], v0, s[36:39], s60 offen offset:3072 sc1
  v_mfma_f32_32x32x16_bf16 v[112:127], a[252:255], v[252:255], v[112:127]
  ds_write_b128 v21, v[100:103] offset:3072
  v_mul_f32 v40, 0x3eb8aa3b, v10
  s_nop 9
  v_mul_f32 v112, v112, v40
  v_mul_f32 v113, v113, v40
  v_mul_f32 v114, v114, v40
  v_mul_f32 v115, v115, v40
  v_mul_f32 v116, v116, v40
  v_mul_f32 v117, v117, v40
  v_mul_f32 v118, v118, v40
  v_mul_f32 v119, v119, v40
  v_mul_f32 v120, v120, v40
  v_mul_f32 v121, v121, v40
  v_mul_f32 v122, v122, v40
  v_mul_f32 v123, v123, v40
  v_mul_f32 v124, v124, v40
  v_mul_f32 v125, v125, v40
  v_mul_f32 v126, v126, v40
  v_mul_f32 v127, v127, v40
  v_cvt_pk_bf16_f32 v112, v112, v113
  v_cvt_pk_bf16_f32 v113, v114, v115
  v_cvt_pk_bf16_f32 v114, v116, v117
  v_cvt_pk_bf16_f32 v115, v118, v119
  v_cvt_pk_bf16_f32 v116, v120, v121
  v_cvt_pk_bf16_f32 v117, v122, v123
  v_cvt_pk_bf16_f32 v118, v124, v125
  v_cvt_pk_bf16_f32 v119, v126, v127
  s_waitcnt vmcnt(0)
  s_barrier
  s_add_u32 s77, s48, 0
  v_mov_b32 v127, s44
  buffer_store_dword v127, v9, s[36:39], s77 offen sc1
  s_max_u32 s77, s40, 1
  s_sub_u32 s77, s77, 1
  s_max_u32 s78, s40, 2
  s_sub_u32 s78, s78, 2
  s_sub_u32 s77, s77, s78
  s_lshl_b32 s77, s77, 8
  s_lshl_b32 s78, s78, 4
  s_add_u32 s78, s78, s41
  s_lshl_b32 s78, s78, 8
  s_add_u32 s78, s78, 4096
  v_and_b32 v2, 16, v0
  v_mul_u32_u24 v2, s77, v2
  v_add_u32 v2, s78, v2
  buffer_load_dword v10, v2, s[36:39], 0 offen sc1
  s_waitcnt vmcnt(0)
  v_cmp_ne_u32 s[74:75], s44, v10
  s_nop 1
  s_cmp_lg_u64 s[74:75], 0
  s_cbranch_scc1 L_slow_7
L_back_8:
  s_lshl_b32 s77, s43, 1
  s_add_u32 s77, s77, 0
  s_lshl_b32 m0, s77, 12
  s_lshl_b32 s78, s40, 2
  s_add_u32 s77, s77, s78
  s_max_u32 s77, s77, 8
  s_sub_u32 s77, s77, 8
  s_lshl_b32 s78, s41, 6
  s_add_u32 s77, s77, s78
  s_lshl_b32 s77, s77, 12
  s_add_u32 s69, s77, 2097152
  buffer_load_dwordx4 v0, s[36:39], s69 offen sc1 lds
  buffer_load_dwordx4 v0, s[36:39], s69 offen offset:1024 sc1 lds
  buffer_load_dwordx4 v0, s[36:39], s69 offen offset:2048 sc1 lds
  buffer_load_dwordx4 v0, s[36:39], s69 offen offset:3072 sc1 lds
  s_lshl_b32 s77, s43, 1
  s_add_u32 s77, s77, 1
  s_lshl_b32 m0, s77, 12
  s_lshl_b32 s78, s40, 2
  s_add_u32 s77, s77, s78
  s_max_u32 s77, s77, 8
  s_sub_u32 s77, s77, 8
  s_lshl_b32 s78, s41, 6
  s_add_u32 s77, s77, s78
  s_lshl_b32 s77, s77, 12
  s_add_u32 s69, s77, 2097152
  buffer_load_dwordx4 v0, s[36:39], s69 offen sc1 lds
  buffer_load_dwordx4 v0, s[36:39], s69 offen offset:1024 sc1 lds
  buffer_load_dwordx4 v0, s[36:39], s69 offen offset:2048 sc1 lds
  buffer_load_dwordx4 v0, s[36:39], s69 offen offset:3072 sc1 lds
  v_bfe_u32 v132, v0, 4, 5
  v_lshrrev_b32 v133, 9, v0
  v_lshlrev_b32 v133, 2, v133
  v_sub_u32 v132, v132, v133
  v_mov_b32 v134, 0xff800000
  v_cmp_gt_i32 vcc, 0, v132
  v_mov_b32 v224, s72
  s_nop 0
  v_cndmask_b32 v176, 0, v134, vcc
  v_cmp_gt_i32 vcc, 1, v132
  v_mov_b32 v225, s72
  v_xor_b32 v192, v176, v134
  v_cndmask_b32 v177, 0, v134, vcc
  v_cmp_gt_i32 vcc, 2, v132
  v_mov_b32 v226, s72
  v_xor_b32 v193, v177, v134
  v_cndmask_b32 v178, 0, v134, vcc
  v_cmp_gt_i32 vcc, 3, v132
  v_mov_b32 v227, s72
  v_xor_b32 v194, v178, v134
  v_cndmask_b32 v179, 0, v134, vcc
  v_cmp_gt_i32 vcc, 8, v132
  v_mov_b32 v228, s72
  v_xor_b32 v195, v179, v134
  v_cndmask_b32 v180, 0, v134, vcc
  v_cmp_gt_i32 vcc, 9, v132
  v_mov_b32 v229, s72
  v_xor_b32 v196, v180, v134
  v_cndmask_b32 v181, 0, v134, vcc
  v_cmp_gt_i32 vcc, 10, v132
  v_mov_b32 v230, s72
  v_xor_b32 v197, v181, v134
  v_cndmask_b32 v182, 0, v134, vcc
  v_cmp_gt_i32 vcc, 11, v132
  v_mov_b32 v231, s72
  v_xor_b32 v198, v182, v134
  v_cndmask_b32 v183, 0, v134, vcc
  v_cmp_gt_i32 vcc, 16, v132
  v_mov_b32 v232, s72
  v_xor_b32 v199, v183, v134
  v_cndmask_b32 v184, 0, v134, vcc
  v_cmp_gt_i32 vcc, 17, v132
  v_mov_b32 v233, s72
  v_xor_b32 v200, v184, v134
  v_cndmask_b32 v185, 0, v134, vcc
  v_cmp_gt_i32 vcc, 18, v132
  v_mov_b32 v234, s72
  v_xor_b32 v201, v185, v134
  v_cndmask_b32 v186, 0, v134, vcc
  v_cmp_gt_i32 vcc, 19, v132
  v_mov_b32 v235, s72
  v_xor_b32 v202, v186, v134
  v_cndmask_b32 v187, 0, v134, vcc
  v_cmp_gt_i32 vcc, 24, v132
  v_mov_b32 v236, s72
  v_xor_b32 v203, v187, v134
  v_cndmask_b32 v188, 0, v134, vcc
  v_cmp_gt_i32 vcc, 25, v132
  v_mov_b32 v237, s72
  v_xor_b32 v204, v188, v134
  v_cndmask_b32 v189, 0, v134, vcc
  v_cmp_gt_i32 vcc, 26, v132
  v_mov_b32 v238, s72
  v_xor_b32 v205, v189, v134
  v_cndmask_b32 v190, 0, v134, vcc
  v_cmp_gt_i32 vcc, 27, v132
  v_mov_b32 v239, s72
  v_xor_b32 v206, v190, v134
  v_cndmask_b32 v191, 0, v134, vcc
  v_xor_b32 v207, v191, v134
  s_mov_b32 s70, 0xffff
  s_mov_b32 s71, 0xffff
  s_min_u32 s52, s46, 8
  s_sub_u32 s52, 8, s52
  s_lshl_b32 s77, s43, 12
  v_add_u32 v120, s77, v0
  s_waitcnt vmcnt(0)
  s_waitcnt lgkmcnt(0)
  s_barrier
  s_cmp_lt_u32 s40, 2
  s_cbranch_scc1 L_ledge
  ds_read_b128 v[128:131], v120 offset:32768
  ds_read_b128 v[132:135], v120 offset:28672
  ds_read_b128 v[136:139], v120 offset:24576
  s_mov_b64 exec, s[70:71]
  ds_read_b128 v[224:227], v120 offset:34816
  ds_read_b128 v[228:231], v120 offset:35840
  s_mov_b64 exec, -1
  s_waitcnt lgkmcnt(4)
  v_mfma_f32_32x32x16_bf16 v[144:159], v[128:131], v[112:115], v[176:191]
  s_waitcnt lgkmcnt(3)
  v_mfma_f32_32x32x16_bf16 v[160:175], v[132:135], v[112:115], 0
  s_mov_b64 exec, s[70:71]
  ds_read_b128 v[232:235], v120 offset:30720
  ds_read_b128 v[236:239], v120 offset:31744
  s_mov_b64 exec, -1
  ds_read_b128 v[140:143], v120 offset:20480
  s_nop 4
  v_exp_f32 v144, v144
  v_exp_f32 v145, v145
  v_exp_f32 v146, v146
  v_exp_f32 v147, v147
  v_exp_f32 v148, v148
  v_exp_f32 v149, v149
  v_exp_f32 v150, v150
  v_exp_f32 v151, v151
  v_exp_f32 v152, v152
  v_exp_f32 v153, v153
  v_exp_f32 v154, v154
  v_exp_f32 v155, v155
  v_exp_f32 v156, v156
  v_exp_f32 v157, v157
  v_exp_f32 v158, v158
  v_exp_f32 v159, v159
  v_cvt_pk_bf16_f32 v208, v144, v145
  v_cvt_pk_bf16_f32 v209, v146, v147
  v_cvt_pk_bf16_f32 v210, v148, v149
  v_cvt_pk_bf16_f32 v211, v150, v151
  v_cvt_pk_bf16_f32 v212, v152, v153
  v_cvt_pk_bf16_f32 v213, v154, v155
  v_cvt_pk_bf16_f32 v214, v156, v157
  v_cvt_pk_bf16_f32 v215, v158, v159
  v_exp_f32 v160, v160
  v_exp_f32 v161, v161
  s_waitcnt lgkmcnt(5)
  v_mfma_f32_32x32x16_bf16 v[144:159], v[136:139], v[112:115], 0
  v_exp_f32 v162, v162
  v_exp_f32 v163, v163
  v_exp_f32 v164, v164
  v_exp_f32 v165, v165
  v_exp_f32 v166, v166
  s_waitcnt lgkmcnt(3)
  v_mfma_f32_32x32x16_bf16 v[240:255], v[224:227], v[208:211], 0
  v_exp_f32 v167, v167
  v_exp_f32 v168, v168
  v_exp_f32 v169, v169
  v_exp_f32 v170, v170
  v_exp_f32 v171, v171
  v_mfma_f32_32x32x16_bf16 v[240:255], v[228:231], v[212:215], v[240:255]
  s_mov_b64 exec, s[70:71]
  ds_read_b128 v[224:227], v120 offset:26624
  ds_read_b128 v[228:231], v120 offset:27648
  s_mov_b64 exec, -1
  ds_read_b128 v[128:131], v120 offset:16384
  v_exp_f32 v172, v172
  v_exp_f32 v173, v173
  v_exp_f32 v174, v174
  v_exp_f32 v175, v175
  v_cvt_pk_bf16_f32 v216, v160, v161
  v_cvt_pk_bf16_f32 v217, v162, v163
  v_cvt_pk_bf16_f32 v218, v164, v165
  v_cvt_pk_bf16_f32 v219, v166, v167
  v_cvt_pk_bf16_f32 v220, v168, v169
  v_cvt_pk_bf16_f32 v221, v170, v171
  v_cvt_pk_bf16_f32 v222, v172, v173
  v_cvt_pk_bf16_f32 v223, v174, v175
  v_exp_f32 v144, v144
  v_exp_f32 v145, v145
  s_waitcnt lgkmcnt(3)
  v_mfma_f32_32x32x16_bf16 v[160:175], v[140:143], v[112:115], 0
  v_exp_f32 v146, v146
  v_exp_f32 v147, v147
  v_exp_f32 v148, v148
  v_exp_f32 v149, v149
  v_exp_f32 v150, v150
  v_mfma_f32_32x32x16_bf16 v[240:255], v[232:235], v[216:219], v[240:255]
  v_exp_f32 v151, v151
  v_exp_f32 v152, v152
  v_exp_f32 v153, v153
  v_exp_f32 v154, v154
  v_exp_f32 v155, v155
  v_mfma_f32_32x32x16_bf16 v[240:255], v[236:239], v[220:223], v[240:255]
  s_mov_b64 exec, s[70:71]
  ds_read_b128 v[232:235], v120 offset:22528
  ds_read_b128 v[236:239], v120 offset:23552
  s_mov_b64 exec, -1
  ds_read_b128 v[132:135], v120 offset:12288
  v_exp_f32 v156, v156
  v_exp_f32 v157, v157
  v_exp_f32 v158, v158
  v_exp_f32 v159, v159
  v_cvt_pk_bf16_f32 v208, v144, v145
  v_cvt_pk_bf16_f32 v209, v146, v147
  v_cvt_pk_bf16_f32 v210, v148, v149
  v_cvt_pk_bf16_f32 v211, v150, v151
  v_cvt_pk_bf16_f32 v212, v152, v153
  v_cvt_pk_bf16_f32 v213, v154, v155
  v_cvt_pk_bf16_f32 v214, v156, v157
  v_cvt_pk_bf16_f32 v215, v158, v159
  v_exp_f32 v160, v160
  v_exp_f32 v161, v161
  s_waitcnt lgkmcnt(3)
  v_mfma_f32_32x32x16_bf16 v[144:159], v[128:131], v[112:115], 0
  v_exp_f32 v162, v162
  v_exp_f32 v163, v163
  v_exp_f32 v164, v164
  v_exp_f32 v165, v165
  v_exp_f32 v166, v166
  v_mfma_f32_32x32x16_bf16 v[240:255], v[224:227], v[208:211], v[240:255]
  v_exp_f32 v167, v167
  v_exp_f32 v168, v168
  v_exp_f32 v169, v169
  v_exp_f32 v170, v170
  v_exp_f32 v171, v171
  v_mfma_f32_32x32x16_bf16 v[240:255], v[228:231], v[212:215], v[240:255]
  s_mov_b64 exec, s[70:71]
  ds_read_b128 v[224:227], v120 offset:18432
  ds_read_b128 v[228:231], v120 offset:19456
  s_mov_b64 exec, -1
  ds_read_b128 v[136:139], v120 offset:8192
  v_exp_f32 v172, v172
  v_exp_f32 v173, v173
  v_exp_f32 v174, v174
  v_exp_f32 v175, v175
  v_cvt_pk_bf16_f32 v216, v160, v161
  v_cvt_pk_bf16_f32 v217, v162, v163
  v_cvt_pk_bf16_f32 v218, v164, v165
  v_cvt_pk_bf16_f32 v219, v166, v167
  v_cvt_pk_bf16_f32 v220, v168, v169
  v_cvt_pk_bf16_f32 v221, v170, v171
  v_cvt_pk_bf16_f32 v222, v172, v173
  v_cvt_pk_bf16_f32 v223, v174, v175
  v_exp_f32 v144, v144
  v_exp_f32 v145, v145
  s_waitcnt lgkmcnt(3)
  v_mfma_f32_32x32x16_bf16 v[160:175], v[132:135], v[112:115], 0
  v_exp_f32 v146, v146
  v_exp_f32 v147, v147
  v_exp_f32 v148, v148
  v_exp_f32 v149, v149
  v_exp_f32 v150, v150
  v_mfma_f32_32x32x16_bf16 v[240:255], v[232:235], v[216:219], v[240:255]
  v_exp_f32 v151, v151
  v_exp_f32 v152, v152
  v_exp_f32 v153, v153
  v_exp_f32 v154, v154
  v_exp_f32 v155, v155
  v_mfma_f32_32x32x16_bf16 v[240:255], v[236:239], v[220:223], v[240:255]
  s_mov_b64 exec, s[70:71]
  ds_read_b128 v[232:235], v120 offset:14336
  ds_read_b128 v[236:239], v120 offset:15360
  s_mov_b64 exec, -1
  ds_read_b128 v[140:143], v120 offset:4096
  v_exp_f32 v156, v156
  v_exp_f32 v157, v157
  v_exp_f32 v158, v158
  v_exp_f32 v159, v159
  v_cvt_pk_bf16_f32 v208, v144, v145
  v_cvt_pk_bf16_f32 v209, v146, v147
  v_cvt_pk_bf16_f32 v210, v148, v149
  v_cvt_pk_bf16_f32 v211, v150, v151
  v_cvt_pk_bf16_f32 v212, v152, v153
  v_cvt_pk_bf16_f32 v213, v154, v155
  v_cvt_pk_bf16_f32 v214, v156, v157
  v_cvt_pk_bf16_f32 v215, v158, v159
  v_exp_f32 v160, v160
  v_exp_f32 v161, v161
  s_waitcnt lgkmcnt(3)
  v_mfma_f32_32x32x16_bf16 v[144:159], v[136:139], v[112:115], 0
  v_exp_f32 v162, v162
  v_exp_f32 v163, v163
  v_exp_f32 v164, v164
  v_exp_f32 v165, v165
  v_exp_f32 v166, v166
  v_mfma_f32_32x32x16_bf16 v[240:255], v[224:227], v[208:211], v[240:255]
  v_exp_f32 v167, v167
  v_exp_f32 v168, v168
  v_exp_f32 v169, v169
  v_exp_f32 v170, v170
  v_exp_f32 v171, v171
  v_mfma_f32_32x32x16_bf16 v[240:255], v[228:231], v[212:215], v[240:255]
  s_mov_b64 exec, s[70:71]
  ds_read_b128 v[224:227], v120 offset:10240
  ds_read_b128 v[228:231], v120 offset:11264
  s_mov_b64 exec, -1
  ds_read_b128 v[128:131], v120
  v_exp_f32 v172, v172
  v_exp_f32 v173, v173
  v_exp_f32 v174, v174
  v_exp_f32 v175, v175
  v_cvt_pk_bf16_f32 v216, v160, v161
  v_cvt_pk_bf16_f32 v217, v162, v163
  v_cvt_pk_bf16_f32 v218, v164, v165
  v_cvt_pk_bf16_f32 v219, v166, v167
  v_cvt_pk_bf16_f32 v220, v168, v169
  v_cvt_pk_bf16_f32 v221, v170, v171
  v_cvt_pk_bf16_f32 v222, v172, v173
  v_cvt_pk_bf16_f32 v223, v174, v175
  v_exp_f32 v144, v144
  v_exp_f32 v145, v145
  s_waitcnt lgkmcnt(3)
  v_mfma_f32_32x32x16_bf16 v[160:175], v[140:143], v[112:115], 0
  v_exp_f32 v146, v146
  v_exp_f32 v147, v147
  v_exp_f32 v148, v148
  v_exp_f32 v149, v149
  v_exp_f32 v150, v150
  v_mfma_f32_32x32x16_bf16 v[240:255], v[232:235], v[216:219], v[240:255]
  v_exp_f32 v151, v151
  v_exp_f32 v152, v152
  v_exp_f32 v153, v153
  v_exp_f32 v154, v154
  v_exp_f32 v155, v155
  v_mfma_f32_32x32x16_bf16 v[240:255], v[236:239], v[220:223], v[240:255]
  s_mov_b64 exec, s[70:71]
  ds_read_b128 v[232:235], v120 offset:6144
  ds_read_b128 v[236:239], v120 offset:7168
  s_mov_b64 exec, -1
  ds_read_b128 v[132:135], v120 offset:33792
  v_exp_f32 v156, v156
  v_exp_f32 v157, v157
  v_exp_f32 v158, v158
  v_exp_f32 v159, v159
  v_cvt_pk_bf16_f32 v208, v144, v145
  v_cvt_pk_bf16_f32 v209, v146, v147
  v_cvt_pk_bf16_f32 v210, v148, v149
  v_cvt_pk_bf16_f32 v211, v150, v151
  v_cvt_pk_bf16_f32 v212, v152, v153
  v_cvt_pk_bf16_f32 v213, v154, v155
  v_cvt_pk_bf16_f32 v214, v156, v157
  v_cvt_pk_bf16_f32 v215, v158, v159
  v_exp_f32 v160, v160
  v_exp_f32 v161, v161
  s_waitcnt lgkmcnt(3)
  v_mfma_f32_32x32x16_bf16 v[144:159], v[128:131], v[112:115], v[192:207]
  v_exp_f32 v162, v162
  v_exp_f32 v163, v163
  v_exp_f32 v164, v164
  v_exp_f32 v165, v165
  v_exp_f32 v166, v166
  v_mfma_f32_32x32x16_bf16 v[240:255], v[224:227], v[208:211], v[240:255]
  v_exp_f32 v167, v167
  v_exp_f32 v168, v168
  v_exp_f32 v169, v169
  v_exp_f32 v170, v170
  v_exp_f32 v171, v171
  v_mfma_f32_32x32x16_bf16 v[240:255], v[228:231], v[212:215], v[240:255]
  s_mov_b64 exec, s[70:71]
  ds_read_b128 v[224:227], v120 offset:2048
  ds_read_b128 v[228:231], v120 offset:3072
  s_mov_b64 exec, -1
  ds_read_b128 v[136:139], v120 offset:29696
  v_exp_f32 v172, v172
  v_exp_f32 v173, v173
  v_exp_f32 v174, v174
  v_exp_f32 v175, v175
  v_cvt_pk_bf16_f32 v216, v160, v161
  v_cvt_pk_bf16_f32 v217, v162, v163
  v_cvt_pk_bf16_f32 v218, v164, v165
  v_cvt_pk_bf16_f32 v219, v166, v167
  v_cvt_pk_bf16_f32 v220, v168, v169
  v_cvt_pk_bf16_f32 v221, v170, v171
  v_cvt_pk_bf16_f32 v222, v172, v173
  v_cvt_pk_bf16_f32 v223, v174, v175
  v_exp_f32 v144, v144
  v_exp_f32 v145, v145
  s_waitcnt lgkmcnt(3)
  v_mfma_f32_32x32x16_bf16 v[160:175], v[132:135], v[116:119], v[176:191]
  v_exp_f32 v146, v146
  v_exp_f32 v147, v147
  v_exp_f32 v148, v148
  v_exp_f32 v149, v149
  v_exp_f32 v150, v150
  v_mfma_f32_32x32x16_bf16 v[240:255], v[232:235], v[216:219], v[240:255]
  v_exp_f32 v151, v151
  v_exp_f32 v152, v152
  v_exp_f32 v153, v153
  v_exp_f32 v154, v154
  v_exp_f32 v155, v155
  v_mfma_f32_32x32x16_bf16 v[240:255], v[236:239], v[220:223], v[240:255]
  s_mov_b64 exec, s[70:71]
  ds_read_b128 v[232:235], v120 offset:35072
  ds_read_b128 v[236:239], v120 offset:36096
  s_mov_b64 exec, -1
  ds_read_b128 v[140:143], v120 offset:25600
  v_exp_f32 v156, v156
  v_exp_f32 v157, v157
  v_exp_f32 v158, v158
  v_exp_f32 v159, v159
  v_cvt_pk_bf16_f32 v208, v144, v145
  v_cvt_pk_bf16_f32 v209, v146, v147
  v_cvt_pk_bf16_f32 v210, v148, v149
  v_cvt_pk_bf16_f32 v211, v150, v151
  v_cvt_pk_bf16_f32 v212, v152, v153
  v_cvt_pk_bf16_f32 v213, v154, v155
  v_cvt_pk_bf16_f32 v214, v156, v157
  v_cvt_pk_bf16_f32 v215, v158, v159
  v_exp_f32 v160, v160
  v_exp_f32 v161, v161
  s_waitcnt lgkmcnt(3)
  v_mfma_f32_32x32x16_bf16 v[144:159], v[136:139], v[116:119], 0
  v_exp_f32 v162, v162
  v_exp_f32 v163, v163
  v_exp_f32 v164, v164
  v_exp_f32 v165, v165
  v_exp_f32 v166, v166
  v_mfma_f32_32x32x16_bf16 v[240:255], v[224:227], v[208:211], v[240:255]
  v_exp_f32 v167, v167
  v_exp_f32 v168, v168
  v_exp_f32 v169, v169
  v_exp_f32 v170, v170
  v_exp_f32 v171, v171
  v_mfma_f32_32x32x16_bf16 v[240:255], v[228:231], v[212:215], v[240:255]
  s_mov_b64 exec, s[70:71]
  ds_read_b128 v[224:227], v120 offset:30976
  ds_read_b128 v[228:231], v120 offset:32000
  s_mov_b64 exec, -1
  ds_read_b128 v[128:131], v120 offset:21504
  v_exp_f32 v172, v172
  v_exp_f32 v173, v173
  v_exp_f32 v174, v174
  v_exp_f32 v175, v175
  v_cvt_pk_bf16_f32 v216, v160, v161
  v_cvt_pk_bf16_f32 v217, v162, v163
  v_cvt_pk_bf16_f32 v218, v164, v165
  v_cvt_pk_bf16_f32 v219, v166, v167
  v_cvt_pk_bf16_f32 v220, v168, v169
  v_cvt_pk_bf16_f32 v221, v170, v171
  v_cvt_pk_bf16_f32 v222, v172, v173
  v_cvt_pk_bf16_f32 v223, v174, v175
  v_exp_f32 v144, v144
  v_exp_f32 v145, v145
  s_waitcnt lgkmcnt(3)
  v_mfma_f32_32x32x16_bf16 v[160:175], v[140:143], v[116:119], 0
  v_exp_f32 v146, v146
  v_exp_f32 v147, v147
  v_exp_f32 v148, v148
  v_exp_f32 v149, v149
  v_exp_f32 v150, v150
  v_mfma_f32_32x32x16_bf16 v[16:31], v[232:235], v[216:219], 0
  v_exp_f32 v151, v151
  v_exp_f32 v152, v152
  v_exp_f32 v153, v153
  v_exp_f32 v154, v154
  v_exp_f32 v155, v155
  v_mfma_f32_32x32x16_bf16 v[16:31], v[236:239], v[220:223], v[16:31]
  s_mov_b64 exec, s[70:71]
  ds_read_b128 v[232:235], v120 offset:26880
  ds_read_b128 v[236:239], v120 offset:27904
  s_mov_b64 exec, -1
  ds_read_b128 v[132:135], v120 offset:17408
  v_exp_f32 v156, v156
  v_exp_f32 v157, v157
  v_exp_f32 v158, v158
  v_exp_f32 v159, v159
  v_cvt_pk_bf16_f32 v208, v144, v145
  v_cvt_pk_bf16_f32 v209, v146, v147
  v_cvt_pk_bf16_f32 v210, v148, v149
  v_cvt_pk_bf16_f32 v211, v150, v151
  v_cvt_pk_bf16_f32 v212, v152, v153
  v_cvt_pk_bf16_f32 v213, v154, v155
  v_cvt_pk_bf16_f32 v214, v156, v157
  v_cvt_pk_bf16_f32 v215, v158, v159
  v_max3_f32 v122, |v240|, |v241|, |v242|
  v_max3_f32 v122, v122, |v243|, |v244|
  v_max3_f32 v122, v122, |v245|, |v246|
  v_max3_f32 v122, v122, |v247|, |v247|
  v_cmp_nge_f32 vcc, 0x5d800000, v248
  s_nop 1
  s_mov_b64 s[86:87], vcc
  v_cmp_nle_f32 vcc, 0x21800000, v248
  s_nop 1
  s_or_b64 s[86:87], s[86:87], vcc
  v_cmp_nge_f32 vcc, 0x7e800000, v122
  s_nop 1
  s_or_b64 s[86:87], s[86:87], vcc
  v_rcp_f32 v121, v248
  s_nop 0
  v_mul_f32 v240, v240, v121
  v_mul_f32 v241, v241, v121
  v_mul_f32 v242, v242, v121
  v_mul_f32 v243, v243, v121
  v_mul_f32 v244, v244, v121
  v_mul_f32 v245, v245, v121
  v_mul_f32 v246, v246, v121
  v_mul_f32 v247, v247, v121
  v_cvt_pk_bf16_f32 v48, v240, v241
  v_cvt_pk_bf16_f32 v49, v242, v243
  v_cvt_pk_bf16_f32 v50, v244, v245
  v_cvt_pk_bf16_f32 v51, v246, v247
  v_exp_f32 v160, v160
  v_exp_f32 v161, v161
  s_waitcnt lgkmcnt(3)
  v_mfma_f32_32x32x16_bf16 v[144:159], v[128:131], v[116:119], 0
  v_exp_f32 v162, v162
  v_exp_f32 v163, v163
  v_exp_f32 v164, v164
  v_exp_f32 v165, v165
  v_exp_f32 v166, v166
  v_mfma_f32_32x32x16_bf16 v[16:31], v[224:227], v[208:211], v[16:31]
  v_exp_f32 v167, v167
  v_exp_f32 v168, v168
  v_exp_f32 v169, v169
  v_exp_f32 v170, v170
  v_exp_f32 v171, v171
  v_mfma_f32_32x32x16_bf16 v[16:31], v[228:231], v[212:215], v[16:31]
  s_mov_b64 exec, s[70:71]
  ds_read_b128 v[224:227], v120 offset:22784
  ds_read_b128 v[228:231], v120 offset:23808
  s_mov_b64 exec, -1
  ds_read_b128 v[136:139], v120 offset:13312
  v_exp_f32 v172, v172
  v_exp_f32 v173, v173
  v_exp_f32 v174, v174
  v_exp_f32 v175, v175
  v_cvt_pk_bf16_f32 v216, v160, v161
  v_cvt_pk_bf16_f32 v217, v162, v163
  v_cvt_pk_bf16_f32 v218, v164, v165
  v_cvt_pk_bf16_f32 v219, v166, v167
  v_cvt_pk_bf16_f32 v220, v168, v169
  v_cvt_pk_bf16_f32 v221, v170, v171
  v_cvt_pk_bf16_f32 v222, v172, v173
  v_cvt_pk_bf16_f32 v223, v174, v175
  v_exp_f32 v144, v144
  v_exp_f32 v145, v145
  s_waitcnt lgkmcnt(3)
  v_mfma_f32_32x32x16_bf16 v[160:175], v[132:135], v[116:119], 0
  v_exp_f32 v146, v146
  v_exp_f32 v147, v147
  v_exp_f32 v148, v148
  v_exp_f32 v149, v149
  v_exp_f32 v150, v150
  v_mfma_f32_32x32x16_bf16 v[16:31], v[232:235], v[216:219], v[16:31]
  v_exp_f32 v151, v151
  v_exp_f32 v152, v152
  v_exp_f32 v153, v153
  v_exp_f32 v154, v154
  v_exp_f32 v155, v155
  v_mfma_f32_32x32x16_bf16 v[16:31], v[236:239], v[220:223], v[16:31]
  s_mov_b64 exec, s[70:71]
  ds_read_b128 v[232:235], v120 offset:18688
  ds_read_b128 v[236:239], v120 offset:19712
  s_mov_b64 exec, -1
  ds_read_b128 v[140:143], v120 offset:9216
  v_exp_f32 v156, v156
  v_exp_f32 v157, v157
  v_exp_f32 v158, v158
  v_exp_f32 v159, v159
  v_cvt_pk_bf16_f32 v208, v144, v145
  v_cvt_pk_bf16_f32 v209, v146, v147
  v_cvt_pk_bf16_f32 v210, v148, v149
  v_cvt_pk_bf16_f32 v211, v150, v151
  v_cvt_pk_bf16_f32 v212, v152, v153
  v_cvt_pk_bf16_f32 v213, v154, v155
  v_cvt_pk_bf16_f32 v214, v156, v157
  v_cvt_pk_bf16_f32 v215, v158, v159
  v_exp_f32 v160, v160
  v_exp_f32 v161, v161
  s_waitcnt lgkmcnt(3)
  v_mfma_f32_32x32x16_bf16 v[144:159], v[136:139], v[116:119], 0
  v_exp_f32 v162, v162
  v_exp_f32 v163, v163
  v_exp_f32 v164, v164
  v_exp_f32 v165, v165
  v_exp_f32 v166, v166
  v_mfma_f32_32x32x16_bf16 v[16:31], v[224:227], v[208:211], v[16:31]
  v_exp_f32 v167, v167
  v_exp_f32 v168, v168
  v_exp_f32 v169, v169
  v_exp_f32 v170, v170
  v_exp_f32 v171, v171
  v_mfma_f32_32x32x16_bf16 v[16:31], v[228:231], v[212:215], v[16:31]
  s_mov_b64 exec, s[70:71]
  ds_read_b128 v[224:227], v120 offset:14592
  ds_read_b128 v[228:231], v120 offset:15616
  s_mov_b64 exec, -1
  ds_read_b128 v[128:131], v120 offset:5120
  v_exp_f32 v172, v172
  v_exp_f32 v173, v173
  v_exp_f32 v174, v174
  v_exp_f32 v175, v175
  v_cvt_pk_bf16_f32 v216, v160, v161
  v_cvt_pk_bf16_f32 v217, v162, v163
  v_cvt_pk_bf16_f32 v218, v164, v165
  v_cvt_pk_bf16_f32 v219, v166, v167
  v_cvt_pk_bf16_f32 v220, v168, v169
  v_cvt_pk_bf16_f32 v221, v170, v171
  v_cvt_pk_bf16_f32 v222, v172, v173
  v_cvt_pk_bf16_f32 v223, v174, v175
  v_exp_f32 v144, v144
  v_exp_f32 v145, v145
  s_waitcnt lgkmcnt(3)
  v_mfma_f32_32x32x16_bf16 v[160:175], v[140:143], v[116:119], 0
  v_exp_f32 v146, v146
  v_exp_f32 v147, v147
  v_exp_f32 v148, v148
  v_exp_f32 v149, v149
  v_exp_f32 v150, v150
  v_mfma_f32_32x32x16_bf16 v[16:31], v[232:235], v[216:219], v[16:31]
  v_exp_f32 v151, v151
  v_exp_f32 v152, v152
  v_exp_f32 v153, v153
  v_exp_f32 v154, v154
  v_exp_f32 v155, v155
  v_mfma_f32_32x32x16_bf16 v[16:31], v[236:239], v[220:223], v[16:31]
  s_mov_b64 exec, s[70:71]
  ds_read_b128 v[232:235], v120 offset:10496
  ds_read_b128 v[236:239], v120 offset:11520
  s_mov_b64 exec, -1
  ds_read_b128 v[132:135], v120 offset:1024
  v_exp_f32 v156, v156
  v_exp_f32 v157, v157
  v_exp_f32 v158, v158
  v_exp_f32 v159, v159
  v_cvt_pk_bf16_f32 v208, v144, v145
  v_cvt_pk_bf16_f32 v209, v146, v147
  v_cvt_pk_bf16_f32 v210, v148, v149
  v_cvt_pk_bf16_f32 v211, v150, v151
  v_cvt_pk_bf16_f32 v212, v152, v153
  v_cvt_pk_bf16_f32 v213, v154, v155
  v_cvt_pk_bf16_f32 v214, v156, v157
  v_cvt_pk_bf16_f32 v215, v158, v159
  v_exp_f32 v160, v160
  v_exp_f32 v161, v161
  s_waitcnt lgkmcnt(3)
  v_mfma_f32_32x32x16_bf16 v[144:159], v[128:131], v[116:119], 0
  v_exp_f32 v162, v162
  v_exp_f32 v163, v163
  v_exp_f32 v164, v164
  v_exp_f32 v165, v165
  v_exp_f32 v166, v166
  v_mfma_f32_32x32x16_bf16 v[16:31], v[224:227], v[208:211], v[16:31]
  v_exp_f32 v167, v167
  v_exp_f32 v168, v168
  v_exp_f32 v169, v169
  v_exp_f32 v170, v170
  v_exp_f32 v171, v171
  v_mfma_f32_32x32x16_bf16 v[16:31], v[228:231], v[212:215], v[16:31]
  s_mov_b64 exec, s[70:71]
  ds_read_b128 v[224:227], v120 offset:6400
  ds_read_b128 v[228:231], v120 offset:7424
  s_mov_b64 exec, -1
  v_exp_f32 v172, v172
  v_exp_f32 v173, v173
  v_exp_f32 v174, v174
  v_exp_f32 v175, v175
  v_cvt_pk_bf16_f32 v216, v160, v161
  v_cvt_pk_bf16_f32 v217, v162, v163
  v_cvt_pk_bf16_f32 v218, v164, v165
  v_cvt_pk_bf16_f32 v219, v166, v167
  v_cvt_pk_bf16_f32 v220, v168, v169
  v_cvt_pk_bf16_f32 v221, v170, v171
  v_cvt_pk_bf16_f32 v222, v172, v173
  v_cvt_pk_bf16_f32 v223, v174, v175
  v_exp_f32 v144, v144
  v_exp_f32 v145, v145
  s_waitcnt lgkmcnt(2)
  v_mfma_f32_32x32x16_bf16 v[160:175], v[132:135], v[116:119], v[192:207]
  v_exp_f32 v146, v146
  v_exp_f32 v147, v147
  v_exp_f32 v148, v148
  v_exp_f32 v149, v149
  v_exp_f32 v150, v150
  v_mfma_f32_32x32x16_bf16 v[16:31], v[232:235], v[216:219], v[16:31]
  v_exp_f32 v151, v151
  v_exp_f32 v152, v152
  v_exp_f32 v153, v153
  v_exp_f32 v154, v154
  v_exp_f32 v155, v155
  v_mfma_f32_32x32x16_bf16 v[16:31], v[236:239], v[220:223], v[16:31]
  s_mov_b64 exec, s[70:71]
  ds_read_b128 v[232:235], v120 offset:2304
  ds_read_b128 v[236:239], v120 offset:3328
  s_mov_b64 exec, -1
  v_exp_f32 v156, v156
  v_exp_f32 v157, v157
  v_exp_f32 v158, v158
  v_exp_f32 v159, v159
  v_cvt_pk_bf16_f32 v208, v144, v145
  v_cvt_pk_bf16_f32 v209, v146, v147
  v_cvt_pk_bf16_f32 v210, v148, v149
  v_cvt_pk_bf16_f32 v211, v150, v151
  v_cvt_pk_bf16_f32 v212, v152, v153
  v_cvt_pk_bf16_f32 v213, v154, v155
  v_cvt_pk_bf16_f32 v214, v156, v157
  v_cvt_pk_bf16_f32 v215, v158, v159
  v_exp_f32 v160, v160
  v_exp_f32 v161, v161
  v_exp_f32 v162, v162
  v_exp_f32 v163, v163
  v_exp_f32 v164, v164
  v_exp_f32 v165, v165
  v_exp_f32 v166, v166
  s_waitcnt lgkmcnt(2)
  v_mfma_f32_32x32x16_bf16 v[16:31], v[224:227], v[208:211], v[16:31]
  v_exp_f32 v167, v167
  v_exp_f32 v168, v168
  v_exp_f32 v169, v169
  v_exp_f32 v170, v170
  v_exp_f32 v171, v171
  v_mfma_f32_32x32x16_bf16 v[16:31], v[228:231], v[212:215], v[16:31]
  v_exp_f32 v172, v172
  v_exp_f32 v173, v173
  v_exp_f32 v174, v174
  v_exp_f32 v175, v175
  v_cvt_pk_bf16_f32 v216, v160, v161
  v_cvt_pk_bf16_f32 v217, v162, v163
  v_cvt_pk_bf16_f32 v218, v164, v165
  v_cvt_pk_bf16_f32 v219, v166, v167
  v_cvt_pk_bf16_f32 v220, v168, v169
  v_cvt_pk_bf16_f32 v221, v170, v171
  v_cvt_pk_bf16_f32 v222, v172, v173
  v_cvt_pk_bf16_f32 v223, v174, v175
  s_waitcnt lgkmcnt(0)
  v_mfma_f32_32x32x16_bf16 v[16:31], v[232:235], v[216:219], v[16:31]
  v_mfma_f32_32x32x16_bf16 v[16:31], v[236:239], v[220:223], v[16:31]
  s_lshl_b32 s79, s46, 4
  s_add_u32 s79, s79, s45
  s_lshl_b32 s79, s79, 11
  s_add_u32 s79, s79, 18874368
  s_nop 7
  v_max3_f32 v122, |v16|, |v17|, |v18|
  v_max3_f32 v122, v122, |v19|, |v20|
  v_max3_f32 v122, v122, |v21|, |v22|
  v_max3_f32 v122, v122, |v23|, |v23|
  v_cmp_nge_f32 vcc, 0x5d800000, v24
  s_nop 1
  s_or_b64 s[86:87], s[86:87], vcc
  v_cmp_nle_f32 vcc, 0x21800000, v24
  s_nop 1
  s_or_b64 s[86:87], s[86:87], vcc
  v_cmp_nge_f32 vcc, 0x7e800000, v122
  s_nop 1
  s_or_b64 s[86:87], s[86:87], vcc
  v_rcp_f32 v121, v24
  s_nop 0
  v_mul_f32 v16, v16, v121
  v_mul_f32 v17, v17, v121
  v_mul_f32 v18, v18, v121
  v_mul_f32 v19, v19, v121
  v_mul_f32 v20, v20, v121
  v_mul_f32 v21, v21, v121
  v_mul_f32 v22, v22, v121
  v_mul_f32 v23, v23, v121
  v_cvt_pk_bf16_f32 v52, v16, v17
  v_cvt_pk_bf16_f32 v53, v18, v19
  v_cvt_pk_bf16_f32 v54, v20, v21
  v_cvt_pk_bf16_f32 v55, v22, v23
  s_cmp_eq_u64 s[86:87], 0
  s_cbranch_scc1 L_ok_61
  s_call_b64 s[84:85], L_attslow
L_ok_61:
  buffer_store_dwordx4 v[48:51], v0, s[36:39], s79 offen sc1
  buffer_store_dwordx4 v[52:55], v0, s[36:39], s79 offen offset:1024 sc1
L_l2:
  buffer_load_dword v31, v9, s[28:31], 0 offen
  buffer_load_dword v31, v9, s[28:31], 0 offen
  s_lshl_b32 s66, s43, 12
  s_xor_b32 s77, s41, 1
  s_lshl_b32 s77, s77, 18
  s_lshl_b32 s78, s42, 16
  s_add_u32 s77, s77, s78
  s_add_u32 s77, s77, s66
  s_add_u32 s60, s77, 6291456
  s_xor_b32 s73, s60, 262144
  v_add_u32 v2, 131072, v0
  s_and_b32 s77, s40, 3
  s_lshl_b32 s69, s77, 14
  s_add_u32 s56, s3, 4
  s_and_b32 s56, s56, 7
  s_lshl_b32 s56, s56, 7
  s_lshr_b32 s68, s43, 1
  s_and_b32 s77, s43, 1
  s_lshl_b32 s78, s42, 1
  s_add_u32 s77, s77, s78
  s_lshl_b32 s78, s40, 2
  s_add_u32 s67, s77, s78
  s_add_u32 s77, s40, s3
  s_and_b32 s77, s77, 3
  s_lshl_b32 s80, s77, 16
  s_lshl_b32 s81, s77, 12
  s_and_b32 s77, s40, 3
  s_lshl_b32 s77, s77, 1
  s_add_u32 s77, s77, s3
  s_sub_u32 s78, s77, 7
  s_cmp_ge_u32 s77, 7
  s_cselect_b32 s77, s78, s77
  s_lshl_b32 s82, s77, 16
  s_lshl_b32 s83, s77, 12
  v_bfe_u32 v16, v0, 6, 3
  v_lshlrev_b32 v16, 10, v16
  v_and_b32 v17, 48, v0
  v_or_b32 v16, v16, v17
  v_lshrrev_b32 v17, 9, v0
  v_lshl_add_u32 v16, v17, 6, v16
  s_and_b32 s77, s43, 1
  s_lshl_b32 s77, s77, 15
  s_add_u32 s77, s77, s56
  v_add_u32 v16, s77, v16
  s_mul_i32 s77, s68, 458752
  v_add_u32 v8, s77, v16
  s_lshl_b32 s77, s68, 18
  v_add_u32 v7, s77, v16
  v_bfe_u32 v16, v0, 6, 2
  v_lshl_add_u32 v16, v17, 2, v16
  v_lshlrev_b32 v16, 6, v16
  v_bfe_u32 v18, v0, 8, 1
  v_lshl_add_u32 v16, v18, 5, v16
  v_bfe_u32 v18, v0, 4, 2
  v_lshl_add_u32 v16, v18, 3, v16
  s_lshl_b32 s77, s68, 13
  v_add_u32 v5, s77, v16
  s_waitcnt vmcnt(2)
  s_barrier
  s_add_u32 s77, s48, 196608
  v_mov_b32 v30, s44
  buffer_store_dword v30, v9, s[36:39], s77 offen sc1
  s_add_u32 m0, s66, 32768
  v_add_u32 v6, s82, v8
  s_add_u32 s82, s82, 65536
  s_cmp_eq_u32 s82, 458752
  s_cselect_b32 s82, 0, s82
  buffer_load_dwordx4 v6, s[24:27], 0 offen lds
  buffer_load_dwordx4 v6, s[24:27], s57 offen offset:1024 lds
  buffer_load_dwordx4 v6, s[24:27], s58 offen offset:2048 lds
  buffer_load_dwordx4 v6, s[24:27], s59 offen offset:3072 lds
  s_add_u32 m0, s66, 81920
  v_add_u32 v6, s82, v8
  s_add_u32 s82, s82, 65536
  s_cmp_eq_u32 s82, 458752
  s_cselect_b32 s82, 0, s82
  buffer_load_dwordx4 v6, s[24:27], 0 offen lds
  buffer_load_dwordx4 v6, s[24:27], s57 offen offset:1024 lds
  buffer_load_dwordx4 v6, s[24:27], s58 offen offset:2048 lds
  buffer_load_dwordx4 v6, s[24:27], s59 offen offset:3072 lds
  s_add_u32 m0, s66, 131072
  v_add_u32 v6, s82, v8
  s_add_u32 s82, s82, 65536
  s_cmp_eq_u32 s82, 458752
  s_cselect_b32 s82, 0, s82
  buffer_load_dwordx4 v6, s[24:27], 0 offen lds
  buffer_load_dwordx4 v6, s[24:27], s57 offen offset:1024 lds
  buffer_load_dwordx4 v6, s[24:27], s58 offen offset:2048 lds
  buffer_load_dwordx4 v6, s[24:27], s59 offen offset:3072 lds
  s_add_u32 m0, s66, 16384
  v_add_u32 v6, s82, v8
  s_add_u32 s82, s82, 65536
  s_cmp_eq_u32 s82, 458752
  s_cselect_b32 s82, 0, s82
  buffer_load_dwordx4 v6, s[24:27], 0 offen lds
  buffer_load_dwordx4 v6, s[24:27], s57 offen offset:1024 lds
  buffer_load_dwordx4 v6, s[24:27], s58 offen offset:2048 lds
  buffer_load_dwordx4 v6, s[24:27], s59 offen offset:3072 lds
  s_add_u32 m0, s66, 147456
  v_add_u32 v6, s80, v7
  s_add_u32 s80, s80, 65536
  s_and_b32 s80, s80, 0x3ffff
  buffer_load_dwordx4 v6, s[20:23], 0 offen lds
  buffer_load_dwordx4 v6, s[20:23], s57 offen offset:1024 lds
  buffer_load_dwordx4 v6, s[20:23], s58 offen offset:2048 lds
  buffer_load_dwordx4 v6, s[20:23], s59 offen offset:3072 lds
  s_add_u32 m0, s66, 0
  v_add_u32 v6, s80, v7
  s_add_u32 s80, s80, 65536
  s_and_b32 s80, s80, 0x3ffff
  buffer_load_dwordx4 v6, s[20:23], 0 offen lds
  buffer_load_dwordx4 v6, s[20:23], s57 offen offset:1024 lds
  buffer_load_dwordx4 v6, s[20:23], s58 offen offset:2048 lds
  buffer_load_dwordx4 v6, s[20:23], s59 offen offset:3072 lds
  s_add_u32 m0, s66, 49152
  v_add_u32 v6, s80, v7
  s_add_u32 s80, s80, 65536
  s_and_b32 s80, s80, 0x3ffff
  buffer_load_dwordx4 v6, s[20:23], 0 offen lds
  buffer_load_dwordx4 v6, s[20:23], s57 offen offset:1024 lds
  buffer_load_dwordx4 v6, s[20:23], s58 offen offset:2048 lds
  buffer_load_dwordx4 v6, s[20:23], s59 offen offset:3072 lds
  s_add_u32 m0, s66, 65536
  v_add_u32 v6, s80, v7
  s_add_u32 s80, s80, 65536
  s_and_b32 s80, s80, 0x3ffff
  buffer_load_dwordx4 v6, s[20:23], 0 offen lds
  buffer_load_dwordx4 v6, s[20:23], s57 offen offset:1024 lds
  buffer_load_dwordx4 v6, s[20:23], s58 offen offset:2048 lds
  buffer_load_dwordx4 v6, s[20:23], s59 offen offset:3072 lds
  s_add_u32 m0, s66, 98304
  v_add_u32 v6, s82, v8
  s_add_u32 s82, s82, 65536
  s_cmp_eq_u32 s82, 458752
  s_cselect_b32 s82, 0, s82
  buffer_load_dwordx4 v6, s[24:27], 0 offen lds
  buffer_load_dwordx4 v6, s[24:27], s57 offen offset:1024 lds
  buffer_load_dwordx4 v6, s[24:27], s58 offen offset:2048 lds
  buffer_load_dwordx4 v6, s[24:27], s59 offen offset:3072 lds
  s_add_u32 m0, s66, 114688
  v_add_u32 v6, s82, v8
  s_add_u32 s82, s82, 65536
  s_cmp_eq_u32 s82, 458752
  s_cselect_b32 s82, 0, s82
  buffer_load_dwordx4 v6, s[24:27], 0 offen lds
  buffer_load_dwordx4 v6, s[24:27], s57 offen offset:1024 lds
  buffer_load_dwordx4 v6, s[24:27], s58 offen offset:2048 lds
  buffer_load_dwordx4 v6, s[24:27], s59 offen offset:3072 lds
  v_lshrrev_b32 v28, 7, v0
  v_lshlrev_b32 v28, 10, v28
  v_and_b32 v29, 0x70, v0
  v_or_b32 v28, v28, v29
  s_lshl_b32 s77, s40, 17
  s_lshl_b32 s78, s42, 16
  s_add_u32 s77, s77, s78
  s_lshl_b32 s78, s43, 13
  s_add_u32 s77, s77, s78
  s_add_u32 s77, s77, s56
  v_add_u32 v28, s77, v28
  v_add_u32 v29, 32768, v28
  buffer_load_dwordx4 v[20:23], v28, s[4:7], 0 offen
  buffer_load_dwordx4 v[24:27], v29, s[4:7], 0 offen
  v_bfe_u32 v251, v0, 4, 4
  v_min_u32 v251, 15, v251
  v_lshlrev_b32 v251, 8, v251
  s_lshl_b32 s77, s40, 12
  s_add_u32 s77, s77, 200704
  v_add_u32 v251, s77, v251
  buffer_load_dword v250, v251, s[36:39], 0 offen sc1
  s_waitcnt vmcnt(0)
  v_cmp_ne_u32 s[74:75], s44, v250
  s_nop 1
  s_cmp_lg_u64 s[74:75], 0
  s_cbranch_scc1 L_slow_62
L_back_63:
  s_lshl_b32 s78, s67, 15
  s_lshl_b32 s77, s68, 14
  s_add_u32 s78, s78, s77
  s_add_u32 s84, s78, 18874368
  s_add_u32 s79, s84, s81
  s_add_u32 s81, s81, 4096
  s_and_b32 s81, s81, 0x3fff
  buffer_load_dwordx4 a[0:3], v0, s[36:39], s79 offen sc1
  buffer_load_dwordx4 a[4:7], v0, s[36:39], s79 offen offset:1024 sc1
  buffer_load_dwordx4 a[8:11], v0, s[36:39], s79 offen offset:2048 sc1
  buffer_load_dwordx4 a[12:15], v0, s[36:39], s79 offen offset:3072 sc1
  s_add_u32 s79, s84, s81
  s_add_u32 s81, s81, 4096
  s_and_b32 s81, s81, 0x3fff
  buffer_load_dwordx4 a[16:19], v0, s[36:39], s79 offen sc1
  buffer_load_dwordx4 a[20:23], v0, s[36:39], s79 offen offset:1024 sc1
  buffer_load_dwordx4 a[24:27], v0, s[36:39], s79 offen offset:2048 sc1
  buffer_load_dwordx4 a[28:31], v0, s[36:39], s79 offen offset:3072 sc1
  s_add_u32 s79, s84, s81
  s_add_u32 s81, s81, 4096
  s_and_b32 s81, s81, 0x3fff
  buffer_load_dwordx4 a[32:35], v0, s[36:39], s79 offen sc1
  buffer_load_dwordx4 a[36:39], v0, s[36:39], s79 offen offset:1024 sc1
  buffer_load_dwordx4 a[40:43], v0, s[36:39], s79 offen offset:2048 sc1
  buffer_load_dwordx4 a[44:47], v0, s[36:39], s79 offen offset:3072 sc1
  s_add_u32 s79, s84, s81
  s_add_u32 s81, s81, 4096
  s_and_b32 s81, s81, 0x3fff
  buffer_load_dwordx4 a[48:51], v0, s[36:39], s79 offen sc1
  buffer_load_dwordx4 a[52:55], v0, s[36:39], s79 offen offset:1024 sc1
  buffer_load_dwordx4 a[56:59], v0, s[36:39], s79 offen offset:2048 sc1
  buffer_load_dwordx4 a[60:63], v0, s[36:39], s79 offen offset:3072 sc1
  v_lshrrev_b32 v19, 2, v0
  s_lshl_b32 s78, s46, 4
  s_add_u32 s78, s78, s41
  s_lshl_b32 s78, s78, 8
  s_add_u32 s85, s78, 27262976
  v_cmp_ne_u32 vcc, 0, v0
  v_bfrev_b32 v249, 1
  s_nop 0
  v_cndmask_b32 v249, 0, v249, vcc
  s_branch L_p3
L_ledge:
  ds_read_b128 v[128:131], v120 offset:32768
  ds_read_b128 v[132:135], v120 offset:28672
  ds_read_b128 v[136:139], v120 offset:24576
  s_mov_b64 exec, s[70:71]
  ds_read_b128 v[224:227], v120 offset:34816
  ds_read_b128 v[228:231], v120 offset:35840
  s_mov_b64 exec, -1
  s_waitcnt lgkmcnt(4)
  v_mfma_f32_32x32x16_bf16 v[144:159], v[128:131], v[112:115], v[176:191]
  v_mov_b32 v32, 0
  v_mov_b32 v33, 0
  v_mov_b32 v34, 0
  v_mov_b32 v35, 0
  v_mov_b32 v36, 0
  v_mov_b32 v37, 0
  v_mov_b32 v38, 0
  v_mov_b32 v39, 0
  v_mov_b32 v40, 0
  v_mov_b32 v41, 0
  v_mov_b32 v42, 0
  v_mov_b32 v43, 0
  v_mov_b32 v44, 0
  v_mov_b32 v45, 0
  v_mov_b32 v46, 0
  v_mov_b32 v47, 0
  s_cmp_eq_u32 s52, 8
  s_cbranch_scc1 L_cz_65
L_czb_66:
  s_waitcnt lgkmcnt(3)
  v_mfma_f32_32x32x16_bf16 v[160:175], v[132:135], v[112:115], v[32:47]
  s_mov_b64 exec, s[70:71]
  ds_read_b128 v[232:235], v120 offset:30720
  ds_read_b128 v[236:239], v120 offset:31744
  s_mov_b64 exec, -1
  ds_read_b128 v[140:143], v120 offset:20480
  v_exp_f32 v144, v144
  v_exp_f32 v145, v145
  v_exp_f32 v146, v146
  v_exp_f32 v147, v147
  v_exp_f32 v148, v148
  v_exp_f32 v149, v149
  v_exp_f32 v150, v150
  v_exp_f32 v151, v151
  v_exp_f32 v152, v152
  v_exp_f32 v153, v153
  v_exp_f32 v154, v154
  v_exp_f32 v155, v155
  v_exp_f32 v156, v156
  v_exp_f32 v157, v157
  v_exp_f32 v158, v158
  v_exp_f32 v159, v159
  v_cvt_pk_bf16_f32 v208, v144, v145
  v_cvt_pk_bf16_f32 v209, v146, v147
  v_cvt_pk_bf16_f32 v210, v148, v149
  v_cvt_pk_bf16_f32 v211, v150, v151
  v_cvt_pk_bf16_f32 v212, v152, v153
  v_cvt_pk_bf16_f32 v213, v154, v155
  v_cvt_pk_bf16_f32 v214, v156, v157
  v_cvt_pk_bf16_f32 v215, v158, v159
  v_exp_f32 v160, v160
  v_exp_f32 v161, v161
  s_cmp_eq_u32 s52, 7
  s_cbranch_scc1 L_cz_67
L_czb_68:
  s_waitcnt lgkmcnt(5)
  v_mfma_f32_32x32x16_bf16 v[144:159], v[136:139], v[112:115], v[32:47]
  v_exp_f32 v162, v162
  v_exp_f32 v163, v163
  v_exp_f32 v164, v164
  v_exp_f32 v165, v165
  v_exp_f32 v166, v166
  s_waitcnt lgkmcnt(3)
  v_mfma_f32_32x32x16_bf16 v[240:255], v[224:227], v[208:211], 0
  v_exp_f32 v167, v167
  v_exp_f32 v168, v168
  v_exp_f32 v169, v169
  v_exp_f32 v170, v170
  v_exp_f32 v171, v171
  v_mfma_f32_32x32x16_bf16 v[240:255], v[228:231], v[212:215], v[240:255]
  s_mov_b64 exec, s[70:71]
  ds_read_b128 v[224:227], v120 offset:26624
  ds_read_b128 v[228:231], v120 offset:27648
  s_mov_b64 exec, -1
  ds_read_b128 v[128:131], v120 offset:16384
  v_exp_f32 v172, v172
  v_exp_f32 v173, v173
  v_exp_f32 v174, v174
  v_exp_f32 v175, v175
  v_cvt_pk_bf16_f32 v216, v160, v161
  v_cvt_pk_bf16_f32 v217, v162, v163
  v_cvt_pk_bf16_f32 v218, v164, v165
  v_cvt_pk_bf16_f32 v219, v166, v167
  v_cvt_pk_bf16_f32 v220, v168, v169
  v_cvt_pk_bf16_f32 v221, v170, v171
  v_cvt_pk_bf16_f32 v222, v172, v173
  v_cvt_pk_bf16_f32 v223, v174, v175
  v_exp_f32 v144, v144
  v_exp_f32 v145, v145
  s_cmp_eq_u32 s52, 6
  s_cbranch_scc1 L_cz_69
L_czb_70:
  s_waitcnt lgkmcnt(3)
  v_mfma_f32_32x32x16_bf16 v[160:175], v[140:143], v[112:115], v[32:47]
  v_exp_f32 v146, v146
  v_exp_f32 v147, v147
  v_exp_f32 v148, v148
  v_exp_f32 v149, v149
  v_exp_f32 v150, v150
  v_mfma_f32_32x32x16_bf16 v[240:255], v[232:235], v[216:219], v[240:255]
  v_exp_f32 v151, v151
  v_exp_f32 v152, v152
  v_exp_f32 v153, v153
  v_exp_f32 v154, v154
  v_exp_f32 v155, v155
  v_mfma_f32_32x32x16_bf16 v[240:255], v[236:239], v[220:223], v[240:255]
  s_mov_b64 exec, s[70:71]
  ds_read_b128 v[232:235], v120 offset:22528
  ds_read_b128 v[236:239], v120 offset:23552
  s_mov_b64 exec, -1
  ds_read_b128 v[132:135], v120 offset:12288
  v_exp_f32 v156, v156
  v_exp_f32 v157, v157
  v_exp_f32 v158, v158
  v_exp_f32 v159, v159
  v_cvt_pk_bf16_f32 v208, v144, v145
  v_cvt_pk_bf16_f32 v209, v146, v147
  v_cvt_pk_bf16_f32 v210, v148, v149
  v_cvt_pk_bf16_f32 v211, v150, v151
  v_cvt_pk_bf16_f32 v212, v152, v153
  v_cvt_pk_bf16_f32 v213, v154, v155
  v_cvt_pk_bf16_f32 v214, v156, v157
  v_cvt_pk_bf16_f32 v215, v158, v159
  v_exp_f32 v160, v160
  v_exp_f32 v161, v161
  s_cmp_eq_u32 s52, 5
  s_cbranch_scc1 L_cz_71
L_czb_72:
  s_waitcnt lgkmcnt(3)
  v_mfma_f32_32x32x16_bf16 v[144:159], v[128:131], v[112:115], v[32:47]
  v_exp_f32 v162, v162
  v_exp_f32 v163, v163
  v_exp_f32 v164, v164
  v_exp_f32 v165, v165
  v_exp_f32 v166, v166
  v_mfma_f32_32x32x16_bf16 v[240:255], v[224:227], v[208:211], v[240:255]
  v_exp_f32 v167, v167
  v_exp_f32 v168, v168
  v_exp_f32 v169, v169
  v_exp_f32 v170, v170
  v_exp_f32 v171, v171
  v_mfma_f32_32x32x16_bf16 v[240:255], v[228:231], v[212:215], v[240:255]
  s_mov_b64 exec, s[70:71]
  ds_read_b128 v[224:227], v120 offset:18432
  ds_read_b128 v[228:231], v120 offset:19456
  s_mov_b64 exec, -1
  ds_read_b128 v[136:139], v120 offset:8192
  v_exp_f32 v172, v172
  v_exp_f32 v173, v173
  v_exp_f32 v174, v174
  v_exp_f32 v175, v175
  v_cvt_pk_bf16_f32 v216, v160, v161
  v_cvt_pk_bf16_f32 v217, v162, v163
  v_cvt_pk_bf16_f32 v218, v164, v165
  v_cvt_pk_bf16_f32 v219, v166, v167
  v_cvt_pk_bf16_f32 v220, v168, v169
  v_cvt_pk_bf16_f32 v221, v170, v171
  v_cvt_pk_bf16_f32 v222, v172, v173
  v_cvt_pk_bf16_f32 v223, v174, v175
  v_exp_f32 v144, v144
  v_exp_f32 v145, v145
  s_cmp_eq_u32 s52, 4
  s_cbranch_scc1 L_cz_73
L_czb_74:
  s_waitcnt lgkmcnt(3)
  v_mfma_f32_32x32x16_bf16 v[160:175], v[132:135], v[112:115], v[32:47]
  v_exp_f32 v146, v146
  v_exp_f32 v147, v147
  v_exp_f32 v148, v148
  v_exp_f32 v149, v149
  v_exp_f32 v150, v150
  v_mfma_f32_32x32x16_bf16 v[240:255], v[232:235], v[216:219], v[240:255]
  v_exp_f32 v151, v151
  v_exp_f32 v152, v152
  v_exp_f32 v153, v153
  v_exp_f32 v154, v154
  v_exp_f32 v155, v155
  v_mfma_f32_32x32x16_bf16 v[240:255], v[236:239], v[220:223], v[240:255]
  s_mov_b64 exec, s[70:71]
  ds_read_b128 v[232:235], v120 offset:14336
  ds_read_b128 v[236:239], v120 offset:15360
  s_mov_b64 exec, -1
  ds_read_b128 v[140:143], v120 offset:4096
  v_exp_f32 v156, v156
  v_exp_f32 v157, v157
  v_exp_f32 v158, v158
  v_exp_f32 v159, v159
  v_cvt_pk_bf16_f32 v208, v144, v145
  v_cvt_pk_bf16_f32 v209, v146, v147
  v_cvt_pk_bf16_f32 v210, v148, v149
  v_cvt_pk_bf16_f32 v211, v150, v151
  v_cvt_pk_bf16_f32 v212, v152, v153
  v_cvt_pk_bf16_f32 v213, v154, v155
  v_cvt_pk_bf16_f32 v214, v156, v157
  v_cvt_pk_bf16_f32 v215, v158, v159
  v_exp_f32 v160, v160
  v_exp_f32 v161, v161
  s_cmp_eq_u32 s52, 3
  s_cbranch_scc1 L_cz_75
L_czb_76:
  s_waitcnt lgkmcnt(3)
  v_mfma_f32_32x32x16_bf16 v[144:159], v[136:139], v[112:115], v[32:47]
  v_exp_f32 v162, v162
  v_exp_f32 v163, v163
  v_exp_f32 v164, v164
  v_exp_f32 v165, v165
  v_exp_f32 v166, v166
  v_mfma_f32_32x32x16_bf16 v[240:255], v[224:227], v[208:211], v[240:255]
  v_exp_f32 v167, v167
  v_exp_f32 v168, v168
  v_exp_f32 v169, v169
  v_exp_f32 v170, v170
  v_exp_f32 v171, v171
  v_mfma_f32_32x32x16_bf16 v[240:255], v[228:231], v[212:215], v[240:255]
  s_mov_b64 exec, s[70:71]
  ds_read_b128 v[224:227], v120 offset:10240
  ds_read_b128 v[228:231], v120 offset:11264
  s_mov_b64 exec, -1
  ds_read_b128 v[128:131], v120 offset:33792
  v_exp_f32 v172, v172
  v_exp_f32 v173, v173
  v_exp_f32 v174, v174
  v_exp_f32 v175, v175
  v_cvt_pk_bf16_f32 v216, v160, v161
  v_cvt_pk_bf16_f32 v217, v162, v163
  v_cvt_pk_bf16_f32 v218, v164, v165
  v_cvt_pk_bf16_f32 v219, v166, v167
  v_cvt_pk_bf16_f32 v220, v168, v169
  v_cvt_pk_bf16_f32 v221, v170, v171
  v_cvt_pk_bf16_f32 v222, v172, v173
  v_cvt_pk_bf16_f32 v223, v174, v175
  v_exp_f32 v144, v144
  v_exp_f32 v145, v145
  s_cmp_eq_u32 s52, 2
  s_cbranch_scc1 L_cz_77
L_czb_78:
  s_waitcnt lgkmcnt(3)
  v_mfma_f32_32x32x16_bf16 v[160:175], v[140:143], v[112:115], v[32:47]
  v_exp_f32 v146, v146
  v_exp_f32 v147, v147
  v_exp_f32 v148, v148
  v_exp_f32 v149, v149
  v_exp_f32 v150, v150
  v_mfma_f32_32x32x16_bf16 v[240:255], v[232:235], v[216:219], v[240:255]
  v_exp_f32 v151, v151
  v_exp_f32 v152, v152
  v_exp_f32 v153, v153
  v_exp_f32 v154, v154
  v_exp_f32 v155, v155
  v_mfma_f32_32x32x16_bf16 v[240:255], v[236:239], v[220:223], v[240:255]
  s_mov_b64 exec, s[70:71]
  ds_read_b128 v[232:235], v120 offset:6144
  ds_read_b128 v[236:239], v120 offset:7168
  s_mov_b64 exec, -1
  ds_read_b128 v[132:135], v120 offset:29696
  v_exp_f32 v156, v156
  v_exp_f32 v157, v157
  v_exp_f32 v158, v158
  v_exp_f32 v159, v159
  v_cvt_pk_bf16_f32 v208, v144, v145
  v_cvt_pk_bf16_f32 v209, v146, v147
  v_cvt_pk_bf16_f32 v210, v148, v149
  v_cvt_pk_bf16_f32 v211, v150, v151
  v_cvt_pk_bf16_f32 v212, v152, v153
  v_cvt_pk_bf16_f32 v213, v154, v155
  v_cvt_pk_bf16_f32 v214, v156, v157
  v_cvt_pk_bf16_f32 v215, v158, v159
  v_exp_f32 v160, v160
  v_exp_f32 v161, v161
  s_waitcnt lgkmcnt(3)
  v_mfma_f32_32x32x16_bf16 v[144:159], v[128:131], v[116:119], v[176:191]
  v_exp_f32 v162, v162
  v_exp_f32 v163, v163
  v_exp_f32 v164, v164
  v_exp_f32 v165, v165
  v_exp_f32 v166, v166
  v_mfma_f32_32x32x16_bf16 v[240:255], v[224:227], v[208:211], v[240:255]
  v_exp_f32 v167, v167
  v_exp_f32 v168, v168
  v_exp_f32 v169, v169
  v_exp_f32 v170, v170
  v_exp_f32 v171, v171
  v_mfma_f32_32x32x16_bf16 v[240:255], v[228:231], v[212:215], v[240:255]
  s_mov_b64 exec, s[70:71]
  ds_read_b128 v[224:227], v120 offset:35072
  ds_read_b128 v[228:231], v120 offset:36096
  s_mov_b64 exec, -1
  ds_read_b128 v[136:139], v120 offset:25600
  v_exp_f32 v172, v172
  v_exp_f32 v173, v173
  v_exp_f32 v174, v174
  v_exp_f32 v175, v175
  v_cvt_pk_bf16_f32 v216, v160, v161
  v_cvt_pk_bf16_f32 v217, v162, v163
  v_cvt_pk_bf16_f32 v218, v164, v165
  v_cvt_pk_bf16_f32 v219, v166, v167
  v_cvt_pk_bf16_f32 v220, v168, v169
  v_cvt_pk_bf16_f32 v221, v170, v171
  v_cvt_pk_bf16_f32 v222, v172, v173
  v_cvt_pk_bf16_f32 v223, v174, v175
  v_exp_f32 v144, v144
  v_exp_f32 v145, v145
  v_mov_b32 v32, 0
  v_mov_b32 v33, 0
  v_mov_b32 v34, 0
  v_mov_b32 v35, 0
  v_mov_b32 v36, 0
  v_mov_b32 v37, 0
  v_mov_b32 v38, 0
  v_mov_b32 v39, 0
  v_mov_b32 v40, 0
  v_mov_b32 v41, 0
  v_mov_b32 v42, 0
  v_mov_b32 v43, 0
  v_mov_b32 v44, 0
  v_mov_b32 v45, 0
  v_mov_b32 v46, 0
  v_mov_b32 v47, 0
  s_cmp_eq_u32 s52, 8
  s_cbranch_scc1 L_cz_79
L_czb_80:
  s_waitcnt lgkmcnt(3)
  v_mfma_f32_32x32x16_bf16 v[160:175], v[132:135], v[116:119], v[32:47]
  v_exp_f32 v146, v146
  v_exp_f32 v147, v147
  v_exp_f32 v148, v148
  v_exp_f32 v149, v149
  v_exp_f32 v150, v150
  v_mfma_f32_32x32x16_bf16 v[240:255], v[232:235], v[216:219], v[240:255]
  v_exp_f32 v151, v151
  v_exp_f32 v152, v152
  v_exp_f32 v153, v153
  v_exp_f32 v154, v154
  v_exp_f32 v155, v155
  v_mfma_f32_32x32x16_bf16 v[240:255], v[236:239], v[220:223], v[240:255]
  s_mov_b64 exec, s[70:71]
  ds_read_b128 v[232:235], v120 offset:30976
  ds_read_b128 v[236:239], v120 offset:32000
  s_mov_b64 exec, -1
  ds_read_b128 v[140:143], v120 offset:21504
  v_exp_f32 v156, v156
  v_exp_f32 v157, v157
  v_exp_f32 v158, v158
  v_exp_f32 v159, v159
  v_cvt_pk_bf16_f32 v208, v144, v145
  v_cvt_pk_bf16_f32 v209, v146, v147
  v_cvt_pk_bf16_f32 v210, v148, v149
  v_cvt_pk_bf16_f32 v211, v150, v151
  v_cvt_pk_bf16_f32 v212, v152, v153
  v_cvt_pk_bf16_f32 v213, v154, v155
  v_cvt_pk_bf16_f32 v214, v156, v157
  v_cvt_pk_bf16_f32 v215, v158, v159
  v_exp_f32 v160, v160
  v_exp_f32 v161, v161
  s_cmp_eq_u32 s52, 7
  s_cbranch_scc1 L_cz_81
L_czb_82:
  s_waitcnt lgkmcnt(3)
  v_mfma_f32_32x32x16_bf16 v[144:159], v[136:139], v[116:119], v[32:47]
  v_exp_f32 v162, v162
  v_exp_f32 v163, v163
  v_exp_f32 v164, v164
  v_exp_f32 v165, v165
  v_exp_f32 v166, v166
  v_mfma_f32_32x32x16_bf16 v[16:31], v[224:227], v[208:211], 0
  v_exp_f32 v167, v167
  v_exp_f32 v168, v168
  v_exp_f32 v169, v169
  v_exp_f32 v170, v170
  v_exp_f32 v171, v171
  v_mfma_f32_32x32x16_bf16 v[16:31], v[228:231], v[212:215], v[16:31]
  s_mov_b64 exec, s[70:71]
  ds_read_b128 v[224:227], v120 offset:26880
  ds_read_b128 v[228:231], v120 offset:27904
  s_mov_b64 exec, -1
  ds_read_b128 v[128:131], v120 offset:17408
  v_exp_f32 v172, v172
  v_exp_f32 v173, v173
  v_exp_f32 v174, v174
  v_exp_f32 v175, v175
  v_cvt_pk_bf16_f32 v216, v160, v161
  v_cvt_pk_bf16_f32 v217, v162, v163
  v_cvt_pk_bf16_f32 v218, v164, v165
  v_cvt_pk_bf16_f32 v219, v166, v167
  v_cvt_pk_bf16_f32 v220, v168, v169
  v_cvt_pk_bf16_f32 v221, v170, v171
  v_cvt_pk_bf16_f32 v222, v172, v173
  v_cvt_pk_bf16_f32 v223, v174, v175
  v_max3_f32 v122, |v240|, |v241|, |v242|
  v_max3_f32 v122, v122, |v243|, |v244|
  v_max3_f32 v122, v122, |v245|, |v246|
  v_max3_f32 v122, v122, |v247|, |v247|
  v_cmp_nge_f32 vcc, 0x5d800000, v248
  s_nop 1
  s_mov_b64 s[86:87], vcc
  v_cmp_nle_f32 vcc, 0x21800000, v248
  s_nop 1
  s_or_b64 s[86:87], s[86:87], vcc
  v_cmp_nge_f32 vcc, 0x7e800000, v122
  s_nop 1
  s_or_b64 s[86:87], s[86:87], vcc
  v_rcp_f32 v121, v248
  s_nop 0
  v_mul_f32 v240, v240, v121
  v_mul_f32 v241, v241, v121
  v_mul_f32 v242, v242, v121
  v_mul_f32 v243, v243, v121
  v_mul_f32 v244, v244, v121
  v_mul_f32 v245, v245, v121
  v_mul_f32 v246, v246, v121
  v_mul_f32 v247, v247, v121
  v_cvt_pk_bf16_f32 v48, v240, v241
  v_cvt_pk_bf16_f32 v49, v242, v243
  v_cvt_pk_bf16_f32 v50, v244, v245
  v_cvt_pk_bf16_f32 v51, v246, v247
  v_exp_f32 v144, v144
  v_exp_f32 v145, v145
  s_cmp_eq_u32 s52, 6
  s_cbranch_scc1 L_cz_83
L_czb_84:
  s_waitcnt lgkmcnt(3)
  v_mfma_f32_32x32x16_bf16 v[160:175], v[140:143], v[116:119], v[32:47]
  v_exp_f32 v146, v146
  v_exp_f32 v147, v147
  v_exp_f32 v148, v148
  v_exp_f32 v149, v149
  v_exp_f32 v150, v150
  v_mfma_f32_32x32x16_bf16 v[16:31], v[232:235], v[216:219], v[16:31]
  v_exp_f32 v151, v151
  v_exp_f32 v152, v152
  v_exp_f32 v153, v153
  v_exp_f32 v154, v154
  v_exp_f32 v155, v155
  v_mfma_f32_32x32x16_bf16 v[16:31], v[236:239], v[220:223], v[16:31]
  s_mov_b64 exec, s[70:71]
  ds_read_b128 v[232:235], v120 offset:22784
  ds_read_b128 v[236:239], v120 offset:23808
  s_mov_b64 exec, -1
  ds_read_b128 v[132:135], v120 offset:13312
  v_exp_f32 v156, v156
  v_exp_f32 v157, v157
  v_exp_f32 v158, v158
  v_exp_f32 v159, v159
  v_cvt_pk_bf16_f32 v208, v144, v145
  v_cvt_pk_bf16_f32 v209, v146, v147
  v_cvt_pk_bf16_f32 v210, v148, v149
  v_cvt_pk_bf16_f32 v211, v150, v151
  v_cvt_pk_bf16_f32 v212, v152, v153
  v_cvt_pk_bf16_f32 v213, v154, v155
  v_cvt_pk_bf16_f32 v214, v156, v157
  v_cvt_pk_bf16_f32 v215, v158, v159
  v_exp_f32 v160, v160
  v_exp_f32 v161, v161
  s_cmp_eq_u32 s52, 5
  s_cbranch_scc1 L_cz_85
L_czb_86:
  s_waitcnt lgkmcnt(3)
  v_mfma_f32_32x32x16_bf16 v[144:159], v[128:131], v[116:119], v[32:47]
  v_exp_f32 v162, v162
  v_exp_f32 v163, v163
  v_exp_f32 v164, v164
  v_exp_f32 v165, v165
  v_exp_f32 v166, v166
  v_mfma_f32_32x32x16_bf16 v[16:31], v[224:227], v[208:211], v[16:31]
  v_exp_f32 v167, v167
  v_exp_f32 v168, v168
  v_exp_f32 v169, v169
  v_exp_f32 v170, v170
  v_exp_f32 v171, v171
  v_mfma_f32_32x32x16_bf16 v[16:31], v[228:231], v[212:215], v[16:31]
  s_mov_b64 exec, s[70:71]
  ds_read_b128 v[224:227], v120 offset:18688
  ds_read_b128 v[228:231], v120 offset:19712
  s_mov_b64 exec, -1
  ds_read_b128 v[136:139], v120 offset:9216
  v_exp_f32 v172, v172
  v_exp_f32 v173, v173
  v_exp_f32 v174, v174
  v_exp_f32 v175, v175
  v_cvt_pk_bf16_f32 v216, v160, v161
  v_cvt_pk_bf16_f32 v217, v162, v163
  v_cvt_pk_bf16_f32 v218, v164, v165
  v_cvt_pk_bf16_f32 v219, v166, v167
  v_cvt_pk_bf16_f32 v220, v168, v169
  v_cvt_pk_bf16_f32 v221, v170, v171
  v_cvt_pk_bf16_f32 v222, v172, v173
  v_cvt_pk_bf16_f32 v223, v174, v175
  v_exp_f32 v144, v144
  v_exp_f32 v145, v145
  s_cmp_eq_u32 s52, 4
  s_cbranch_scc1 L_cz_87
L_czb_88:
  s_waitcnt lgkmcnt(3)
  v_mfma_f32_32x32x16_bf16 v[160:175], v[132:135], v[116:119], v[32:47]
  v_exp_f32 v146, v146
  v_exp_f32 v147, v147
  v_exp_f32 v148, v148
  v_exp_f32 v149, v149
  v_exp_f32 v150, v150
  v_mfma_f32_32x32x16_bf16 v[16:31], v[232:235], v[216:219], v[16:31]
  v_exp_f32 v151, v151
  v_exp_f32 v152, v152
  v_exp_f32 v153, v153
  v_exp_f32 v154, v154
  v_exp_f32 v155, v155
  v_mfma_f32_32x32x16_bf16 v[16:31], v[236:239], v[220:223], v[16:31]
  s_mov_b64 exec, s[70:71]
  ds_read_b128 v[232:235], v120 offset:14592
  ds_read_b128 v[236:239], v120 offset:15616
  s_mov_b64 exec, -1
  ds_read_b128 v[140:143], v120 offset:5120
  v_exp_f32 v156, v156
  v_exp_f32 v157, v157
  v_exp_f32 v158, v158
  v_exp_f32 v159, v159
  v_cvt_pk_bf16_f32 v208, v144, v145
  v_cvt_pk_bf16_f32 v209, v146, v147
  v_cvt_pk_bf16_f32 v210, v148, v149
  v_cvt_pk_bf16_f32 v211, v150, v151
  v_cvt_pk_bf16_f32 v212, v152, v153
  v_cvt_pk_bf16_f32 v213, v154, v155
  v_cvt_pk_bf16_f32 v214, v156, v157
  v_cvt_pk_bf16_f32 v215, v158, v159
  v_exp_f32 v160, v160
  v_exp_f32 v161, v161
  s_cmp_eq_u32 s52, 3
  s_cbranch_scc1 L_cz_89
L_czb_90:
  s_waitcnt lgkmcnt(3)
  v_mfma_f32_32x32x16_bf16 v[144:159], v[136:139], v[116:119], v[32:47]
  v_exp_f32 v162, v162
  v_exp_f32 v163, v163
  v_exp_f32 v164, v164
  v_exp_f32 v165, v165
  v_exp_f32 v166, v166
  v_mfma_f32_32x32x16_bf16 v[16:31], v[224:227], v[208:211], v[16:31]
  v_exp_f32 v167, v167
  v_exp_f32 v168, v168
  v_exp_f32 v169, v169
  v_exp_f32 v170, v170
  v_exp_f32 v171, v171
  v_mfma_f32_32x32x16_bf16 v[16:31], v[228:231], v[212:215], v[16:31]
  s_mov_b64 exec, s[70:71]
  ds_read_b128 v[224:227], v120 offset:10496
  ds_read_b128 v[228:231], v120 offset:11520
  s_mov_b64 exec, -1
  v_exp_f32 v172, v172
  v_exp_f32 v173, v173
  v_exp_f32 v174, v174
  v_exp_f32 v175, v175
  v_cvt_pk_bf16_f32 v216, v160, v161
  v_cvt_pk_bf16_f32 v217, v162, v163
  v_cvt_pk_bf16_f32 v218, v164, v165
  v_cvt_pk_bf16_f32 v219, v166, v167
  v_cvt_pk_bf16_f32 v220, v168, v169
  v_cvt_pk_bf16_f32 v221, v170, v171
  v_cvt_pk_bf16_f32 v222, v172, v173
  v_cvt_pk_bf16_f32 v223, v174, v175
  v_exp_f32 v144, v144
  v_exp_f32 v145, v145
  s_cmp_eq_u32 s52, 2
  s_cbranch_scc1 L_cz_91
L_czb_92:
  s_waitcnt lgkmcnt(2)
  v_mfma_f32_32x32x16_bf16 v[160:175], v[140:143], v[116:119], v[32:47]
  v_exp_f32 v146, v146
  v_exp_f32 v147, v147
  v_exp_f32 v148, v148
  v_exp_f32 v149, v149
  v_exp_f32 v150, v150
  v_mfma_f32_32x32x16_bf16 v[16:31], v[232:235], v[216:219], v[16:31]
  v_exp_f32 v151, v151
  v_exp_f32 v152, v152
  v_exp_f32 v153, v153
  v_exp_f32 v154, v154
  v_exp_f32 v155, v155
  v_mfma_f32_32x32x16_bf16 v[16:31], v[236:239], v[220:223], v[16:31]
  s_mov_b64 exec, s[70:71]
  ds_read_b128 v[232:235], v120 offset:6400
  ds_read_b128 v[236:239], v120 offset:7424
  s_mov_b64 exec, -1
  v_exp_f32 v156, v156
  v_exp_f32 v157, v157
  v_exp_f32 v158, v158
  v_exp_f32 v159, v159
  v_cvt_pk_bf16_f32 v208, v144, v145
  v_cvt_pk_bf16_f32 v209, v146, v147
  v_cvt_pk_bf16_f32 v210, v148, v149
  v_cvt_pk_bf16_f32 v211, v150, v151
  v_cvt_pk_bf16_f32 v212, v152, v153
  v_cvt_pk_bf16_f32 v213, v154, v155
  v_cvt_pk_bf16_f32 v214, v156, v157
  v_cvt_pk_bf16_f32 v215, v158, v159
  v_exp_f32 v160, v160
  v_exp_f32 v161, v161
  v_exp_f32 v162, v162
  v_exp_f32 v163, v163
  v_exp_f32 v164, v164
  v_exp_f32 v165, v165
  v_exp_f32 v166, v166
  s_waitcnt lgkmcnt(2)
  v_mfma_f32_32x32x16_bf16 v[16:31], v[224:227], v[208:211], v[16:31]
  v_exp_f32 v167, v167
  v_exp_f32 v168, v168
  v_exp_f32 v169, v169
  v_exp_f32 v170, v170
  v_exp_f32 v171, v171
  v_mfma_f32_32x32x16_bf16 v[16:31], v[228:231], v[212:215], v[16:31]
  v_exp_f32 v172, v172
  v_exp_f32 v173, v173
  v_exp_f32 v174, v174
  v_exp_f32 v175, v175
  v_cvt_pk_bf16_f32 v216, v160, v161
  v_cvt_pk_bf16_f32 v217, v162, v163
  v_cvt_pk_bf16_f32 v218, v164, v165
  v_cvt_pk_bf16_f32 v219, v166, v167
  v_cvt_pk_bf16_f32 v220, v168, v169
  v_cvt_pk_bf16_f32 v221, v170, v171
  v_cvt_pk_bf16_f32 v222, v172, v173
  v_cvt_pk_bf16_f32 v223, v174, v175
  s_waitcnt lgkmcnt(0)
  v_mfma_f32_32x32x16_bf16 v[16:31], v[232:235], v[216:219], v[16:31]
  v_mfma_f32_32x32x16_bf16 v[16:31], v[236:239], v[220:223], v[16:31]
  s_lshl_b32 s79, s46, 4
  s_add_u32 s79, s79, s45
  s_lshl_b32 s79, s79, 11
  s_add_u32 s79, s79, 18874368
  s_nop 7
  v_max3_f32 v122, |v16|, |v17|, |v18|
  v_max3_f32 v122, v122, |v19|, |v20|
  v_max3_f32 v122, v122, |v21|, |v22|
  v_max3_f32 v122, v122, |v23|, |v23|
  v_cmp_nge_f32 vcc, 0x5d800000, v24
  s_nop 1
  s_or_b64 s[86:87], s[86:87], vcc
  v_cmp_nle_f32 vcc, 0x21800000, v24
  s_nop 1
  s_or_b64 s[86:87], s[86:87], vcc
  v_cmp_nge_f32 vcc, 0x7e800000, v122
  s_nop 1
  s_or_b64 s[86:87], s[86:87], vcc
  v_rcp_f32 v121, v24
  s_nop 0
  v_mul_f32 v16, v16, v121
  v_mul_f32 v17, v17, v121
  v_mul_f32 v18, v18, v121
  v_mul_f32 v19, v19, v121
  v_mul_f32 v20, v20, v121
  v_mul_f32 v21, v21, v121
  v_mul_f32 v22, v22, v121
  v_mul_f32 v23, v23, v121
  v_cvt_pk_bf16_f32 v52, v16, v17
  v_cvt_pk_bf16_f32 v53, v18, v19
  v_cvt_pk_bf16_f32 v54, v20, v21
  v_cvt_pk_bf16_f32 v55, v22, v23
  s_cmp_eq_u64 s[86:87], 0
  s_cbranch_scc1 L_ok_93
  s_call_b64 s[84:85], L_attslow
L_ok_93:
  buffer_store_dwordx4 v[48:51], v0, s[36:39], s79 offen sc1
  buffer_store_dwordx4 v[52:55], v0, s[36:39], s79 offen offset:1024 sc1
  s_branch L_l2
L_attslow:
  s_nop 7
  ds_read_b128 v[128:131], v120 offset:32768
  s_waitcnt lgkmcnt(0)
  v_mfma_f32_32x32x16_bf16 v[144:159], v[128:131], v[112:115], v[176:191]
  s_nop 11
  v_max3_f32 v122, v144, v145, v146
  v_max3_f32 v122, v122, v147, v148
  v_max3_f32 v122, v122, v149, v150
  v_max3_f32 v122, v122, v151, v152
  v_max3_f32 v122, v122, v153, v154
  v_max3_f32 v122, v122, v155, v156
  v_max3_f32 v122, v122, v157, v158
  v_max_f32 v122, v122, v159
  s_cmp_eq_u32 s52, 8
  s_cbranch_scc1 L_s1_94
  ds_read_b128 v[128:131], v120 offset:28672
  s_waitcnt lgkmcnt(0)
  v_mfma_f32_32x32x16_bf16 v[144:159], v[128:131], v[112:115], 0
  s_nop 11
  v_max3_f32 v122, v122, v144, v145
  v_max3_f32 v122, v122, v146, v147
  v_max3_f32 v122, v122, v148, v149
  v_max3_f32 v122, v122, v150, v151
  v_max3_f32 v122, v122, v152, v153
  v_max3_f32 v122, v122, v154, v155
  v_max3_f32 v122, v122, v156, v157
  v_max3_f32 v122, v122, v158, v159
  s_cmp_eq_u32 s52, 7
  s_cbranch_scc1 L_s1_94
  ds_read_b128 v[128:131], v120 offset:24576
  s_waitcnt lgkmcnt(0)
  v_mfma_f32_32x32x16_bf16 v[144:159], v[128:131], v[112:115], 0
  s_nop 11
  v_max3_f32 v122, v122, v144, v145
  v_max3_f32 v122, v122, v146, v147
  v_max3_f32 v122, v122, v148, v149
  v_max3_f32 v122, v122, v150, v151
  v_max3_f32 v122, v122, v152, v153
  v_max3_f32 v122, v122, v154, v155
  v_max3_f32 v122, v122, v156, v157
  v_max3_f32 v122, v122, v158, v159
  s_cmp_eq_u32 s52, 6
  s_cbranch_scc1 L_s1_94
  ds_read_b128 v[128:131], v120 offset:20480
  s_waitcnt lgkmcnt(0)
  v_mfma_f32_32x32x16_bf16 v[144:159], v[128:131], v[112:115], 0
  s_nop 11
  v_max3_f32 v122, v122, v144, v145
  v_max3_f32 v122, v122, v146, v147
  v_max3_f32 v122, v122, v148, v149
  v_max3_f32 v122, v122, v150, v151
  v_max3_f32 v122, v122, v152, v153
  v_max3_f32 v122, v122, v154, v155
  v_max3_f32 v122, v122, v156, v157
  v_max3_f32 v122, v122, v158, v159
  s_cmp_eq_u32 s52, 5
  s_cbranch_scc1 L_s1_94
  ds_read_b128 v[128:131], v120 offset:16384
  s_waitcnt lgkmcnt(0)
  v_mfma_f32_32x32x16_bf16 v[144:159], v[128:131], v[112:115], 0
  s_nop 11
  v_max3_f32 v122, v122, v144, v145
  v_max3_f32 v122, v122, v146, v147
  v_max3_f32 v122, v122, v148, v149
  v_max3_f32 v122, v122, v150, v151
  v_max3_f32 v122, v122, v152, v153
  v_max3_f32 v122, v122, v154, v155
  v_max3_f32 v122, v122, v156, v157
  v_max3_f32 v122, v122, v158, v159
  s_cmp_eq_u32 s52, 4
  s_cbranch_scc1 L_s1_94
  ds_read_b128 v[128:131], v120 offset:12288
  s_waitcnt lgkmcnt(0)
  v_mfma_f32_32x32x16_bf16 v[144:159], v[128:131], v[112:115], 0
  s_nop 11
  v_max3_f32 v122, v122, v144, v145
  v_max3_f32 v122, v122, v146, v147
  v_max3_f32 v122, v122, v148, v149
  v_max3_f32 v122, v122, v150, v151
  v_max3_f32 v122, v122, v152, v153
  v_max3_f32 v122, v122, v154, v155
  v_max3_f32 v122, v122, v156, v157
  v_max3_f32 v122, v122, v158, v159
  s_cmp_eq_u32 s52, 3
  s_cbranch_scc1 L_s1_94
  ds_read_b128 v[128:131], v120 offset:8192
  s_waitcnt lgkmcnt(0)
  v_mfma_f32_32x32x16_bf16 v[144:159], v[128:131], v[112:115], 0
  s_nop 11
  v_max3_f32 v122, v122, v144, v145
  v_max3_f32 v122, v122, v146, v147
  v_max3_f32 v122, v122, v148, v149
  v_max3_f32 v122, v122, v150, v151
  v_max3_f32 v122, v122, v152, v153
  v_max3_f32 v122, v122, v154, v155
  v_max3_f32 v122, v122, v156, v157
  v_max3_f32 v122, v122, v158, v159
  s_cmp_eq_u32 s52, 2
  s_cbranch_scc1 L_s1_94
  ds_read_b128 v[128:131], v120 offset:4096
  s_waitcnt lgkmcnt(0)
  v_mfma_f32_32x32x16_bf16 v[144:159], v[128:131], v[112:115], 0
  s_nop 11
  v_max3_f32 v122, v122, v144, v145
  v_max3_f32 v122, v122, v146, v147
  v_max3_f32 v122, v122, v148, v149
  v_max3_f32 v122, v122, v150, v151
  v_max3_f32 v122, v122, v152, v153
  v_max3_f32 v122, v122, v154, v155
  v_max3_f32 v122, v122, v156, v157
  v_max3_f32 v122, v122, v158, v159
  s_cmp_eq_u32 s52, 1
  s_cbranch_scc1 L_s1_94
  ds_read_b128 v[128:131], v120
  s_waitcnt lgkmcnt(0)
  v_mfma_f32_32x32x16_bf16 v[144:159], v[128:131], v[112:115], v[192:207]
  s_nop 11
  v_max3_f32 v122, v122, v144, v145
  v_max3_f32 v122, v122, v146, v147
  v_max3_f32 v122, v122, v148, v149
  v_max3_f32 v122, v122, v150, v151
  v_max3_f32 v122, v122, v152, v153
  v_max3_f32 v122, v122, v154, v155
  v_max3_f32 v122, v122, v156, v157
  v_max3_f32 v122, v122, v158, v159
L_s1_94:
  s_nop 7
  v_mov_b32 v121, v122
  s_nop 1
  v_permlane32_swap_b32 v122, v121
  v_max_f32 v122, v122, v121
  v_sub_f32 v160, 0, v122
  v_sub_f32 v161, 0, v122
  v_sub_f32 v162, 0, v122
  v_sub_f32 v163, 0, v122
  v_sub_f32 v164, 0, v122
  v_sub_f32 v165, 0, v122
  v_sub_f32 v166, 0, v122
  v_sub_f32 v167, 0, v122
  v_sub_f32 v168, 0, v122
  v_sub_f32 v169, 0, v122
  v_sub_f32 v170, 0, v122
  v_sub_f32 v171, 0, v122
  v_sub_f32 v172, 0, v122
  v_sub_f32 v173, 0, v122
  v_sub_f32 v174, 0, v122
  v_sub_f32 v175, 0, v122
  v_sub_f32 v32, v176, v122
  v_sub_f32 v33, v177, v122
  v_sub_f32 v34, v178, v122
  v_sub_f32 v35, v179, v122
  v_sub_f32 v36, v180, v122
  v_sub_f32 v37, v181, v122
  v_sub_f32 v38, v182, v122
  v_sub_f32 v39, v183, v122
  v_sub_f32 v40, v184, v122
  v_sub_f32 v41, v185, v122
  v_sub_f32 v42, v186, v122
  v_sub_f32 v43, v187, v122
  v_sub_f32 v44, v188, v122
  v_sub_f32 v45, v189, v122
  v_sub_f32 v46, v190, v122
  v_sub_f32 v47, v191, v122
  ds_read_b128 v[128:131], v120 offset:32768
  s_mov_b64 exec, s[70:71]
  ds_read_b128 v[224:227], v120 offset:34816
  ds_read_b128 v[228:231], v120 offset:35840
  s_mov_b64 exec, -1
  s_waitcnt lgkmcnt(0)
  v_mfma_f32_32x32x16_bf16 v[144:159], v[128:131], v[112:115], v[32:47]
  s_nop 11
  v_exp_f32 v144, v144
  v_exp_f32 v145, v145
  v_exp_f32 v146, v146
  v_exp_f32 v147, v147
  v_exp_f32 v148, v148
  v_exp_f32 v149, v149
  v_exp_f32 v150, v150
  v_exp_f32 v151, v151
  v_exp_f32 v152, v152
  v_exp_f32 v153, v153
  v_exp_f32 v154, v154
  v_exp_f32 v155, v155
  v_exp_f32 v156, v156
  v_exp_f32 v157, v157
  v_exp_f32 v158, v158
  v_exp_f32 v159, v159
  v_cvt_pk_bf16_f32 v208, v144, v145
  v_cvt_pk_bf16_f32 v209, v146, v147
  v_cvt_pk_bf16_f32 v210, v148, v149
  v_cvt_pk_bf16_f32 v211, v150, v151
  v_cvt_pk_bf16_f32 v212, v152, v153
  v_cvt_pk_bf16_f32 v213, v154, v155
  v_cvt_pk_bf16_f32 v214, v156, v157
  v_cvt_pk_bf16_f32 v215, v158, v159
  v_mfma_f32_32x32x16_bf16 v[240:255], v[224:227], v[208:211], 0
  s_nop 0
  v_mfma_f32_32x32x16_bf16 v[240:255], v[228:231], v[212:215], v[240:255]
  s_nop 7
  s_cmp_eq_u32 s52, 8
  s_cbranch_scc1 L_s2_95
  ds_read_b128 v[128:131], v120 offset:28672
  s_mov_b64 exec, s[70:71]
  ds_read_b128 v[224:227], v120 offset:30720
  ds_read_b128 v[228:231], v120 offset:31744
  s_mov_b64 exec, -1
  s_waitcnt lgkmcnt(0)
  v_mfma_f32_32x32x16_bf16 v[144:159], v[128:131], v[112:115], v[160:175]
  s_nop 11
  v_exp_f32 v144, v144
  v_exp_f32 v145, v145
  v_exp_f32 v146, v146
  v_exp_f32 v147, v147
  v_exp_f32 v148, v148
  v_exp_f32 v149, v149
  v_exp_f32 v150, v150
  v_exp_f32 v151, v151
  v_exp_f32 v152, v152
  v_exp_f32 v153, v153
  v_exp_f32 v154, v154
  v_exp_f32 v155, v155
  v_exp_f32 v156, v156
  v_exp_f32 v157, v157
  v_exp_f32 v158, v158
  v_exp_f32 v159, v159
  v_cvt_pk_bf16_f32 v208, v144, v145
  v_cvt_pk_bf16_f32 v209, v146, v147
  v_cvt_pk_bf16_f32 v210, v148, v149
  v_cvt_pk_bf16_f32 v211, v150, v151
  v_cvt_pk_bf16_f32 v212, v152, v153
  v_cvt_pk_bf16_f32 v213, v154, v155
  v_cvt_pk_bf16_f32 v214, v156, v157
  v_cvt_pk_bf16_f32 v215, v158, v159
  v_mfma_f32_32x32x16_bf16 v[240:255], v[224:227], v[208:211], v[240:255]
  s_nop 0
  v_mfma_f32_32x32x16_bf16 v[240:255], v[228:231], v[212:215], v[240:255]
  s_nop 7
  s_cmp_eq_u32 s52, 7
  s_cbranch_scc1 L_s2_95
  ds_read_b128 v[128:131], v120 offset:24576
  s_mov_b64 exec, s[70:71]
  ds_read_b128 v[224:227], v120 offset:26624
  ds_read_b128 v[228:231], v120 offset:27648
  s_mov_b64 exec, -1
  s_waitcnt lgkmcnt(0)
  v_mfma_f32_32x32x16_bf16 v[144:159], v[128:131], v[112:115], v[160:175]
  s_nop 11
  v_exp_f32 v144, v144
  v_exp_f32 v145, v145
  v_exp_f32 v146, v146
  v_exp_f32 v147, v147
  v_exp_f32 v148, v148
  v_exp_f32 v149, v149
  v_exp_f32 v150, v150
  v_exp_f32 v151, v151
  v_exp_f32 v152, v152
  v_exp_f32 v153, v153
  v_exp_f32 v154, v154
  v_exp_f32 v155, v155
  v_exp_f32 v156, v156
  v_exp_f32 v157, v157
  v_exp_f32 v158, v158
  v_exp_f32 v159, v159
  v_cvt_pk_bf16_f32 v208, v144, v145
  v_cvt_pk_bf16_f32 v209, v146, v147
  v_cvt_pk_bf16_f32 v210, v148, v149
  v_cvt_pk_bf16_f32 v211, v150, v151
  v_cvt_pk_bf16_f32 v212, v152, v153
  v_cvt_pk_bf16_f32 v213, v154, v155
  v_cvt_pk_bf16_f32 v214, v156, v157
  v_cvt_pk_bf16_f32 v215, v158, v159
  v_mfma_f32_32x32x16_bf16 v[240:255], v[224:227], v[208:211], v[240:255]
  s_nop 0
  v_mfma_f32_32x32x16_bf16 v[240:255], v[228:231], v[212:215], v[240:255]
  s_nop 7
  s_cmp_eq_u32 s52, 6
  s_cbranch_scc1 L_s2_95
  ds_read_b128 v[128:131], v120 offset:20480
  s_mov_b64 exec, s[70:71]
  ds_read_b128 v[224:227], v120 offset:22528
  ds_read_b128 v[228:231], v120 offset:23552
  s_mov_b64 exec, -1
  s_waitcnt lgkmcnt(0)
  v_mfma_f32_32x32x16_bf16 v[144:159], v[128:131], v[112:115], v[160:175]
  s_nop 11
  v_exp_f32 v144, v144
  v_exp_f32 v145, v145
  v_exp_f32 v146, v146
  v_exp_f32 v147, v147
  v_exp_f32 v148, v148
  v_exp_f32 v149, v149
  v_exp_f32 v150, v150
  v_exp_f32 v151, v151
  v_exp_f32 v152, v152
  v_exp_f32 v153, v153
  v_exp_f32 v154, v154
  v_exp_f32 v155, v155
  v_exp_f32 v156, v156
  v_exp_f32 v157, v157
  v_exp_f32 v158, v158
  v_exp_f32 v159, v159
  v_cvt_pk_bf16_f32 v208, v144, v145
  v_cvt_pk_bf16_f32 v209, v146, v147
  v_cvt_pk_bf16_f32 v210, v148, v149
  v_cvt_pk_bf16_f32 v211, v150, v151
  v_cvt_pk_bf16_f32 v212, v152, v153
  v_cvt_pk_bf16_f32 v213, v154, v155
  v_cvt_pk_bf16_f32 v214, v156, v157
  v_cvt_pk_bf16_f32 v215, v158, v159
  v_mfma_f32_32x32x16_bf16 v[240:255], v[224:227], v[208:211], v[240:255]
  s_nop 0
  v_mfma_f32_32x32x16_bf16 v[240:255], v[228:231], v[212:215], v[240:255]
  s_nop 7
  s_cmp_eq_u32 s52, 5
  s_cbranch_scc1 L_s2_95
  ds_read_b128 v[128:131], v120 offset:16384
  s_mov_b64 exec, s[70:71]
  ds_read_b128 v[224:227], v120 offset:18432
  ds_read_b128 v[228:231], v120 offset:19456
  s_mov_b64 exec, -1
  s_waitcnt lgkmcnt(0)
  v_mfma_f32_32x32x16_bf16 v[144:159], v[128:131], v[112:115], v[160:175]
  s_nop 11
  v_exp_f32 v144, v144
  v_exp_f32 v145, v145
  v_exp_f32 v146, v146
  v_exp_f32 v147, v147
  v_exp_f32 v148, v148
  v_exp_f32 v149, v149
  v_exp_f32 v150, v150
  v_exp_f32 v151, v151
  v_exp_f32 v152, v152
  v_exp_f32 v153, v153
  v_exp_f32 v154, v154
  v_exp_f32 v155, v155
  v_exp_f32 v156, v156
  v_exp_f32 v157, v157
  v_exp_f32 v158, v158
  v_exp_f32 v159, v159
  v_cvt_pk_bf16_f32 v208, v144, v145
  v_cvt_pk_bf16_f32 v209, v146, v147
  v_cvt_pk_bf16_f32 v210, v148, v149
  v_cvt_pk_bf16_f32 v211, v150, v151
  v_cvt_pk_bf16_f32 v212, v152, v153
  v_cvt_pk_bf16_f32 v213, v154, v155
  v_cvt_pk_bf16_f32 v214, v156, v157
  v_cvt_pk_bf16_f32 v215, v158, v159
  v_mfma_f32_32x32x16_bf16 v[240:255], v[224:227], v[208:211], v[240:255]
  s_nop 0
  v_mfma_f32_32x32x16_bf16 v[240:255], v[228:231], v[212:215], v[240:255]
  s_nop 7
  s_cmp_eq_u32 s52, 4
  s_cbranch_scc1 L_s2_95
  ds_read_b128 v[128:131], v120 offset:12288
  s_mov_b64 exec, s[70:71]
  ds_read_b128 v[224:227], v120 offset:14336
  ds_read_b128 v[228:231], v120 offset:15360
  s_mov_b64 exec, -1
  s_waitcnt lgkmcnt(0)
  v_mfma_f32_32x32x16_bf16 v[144:159], v[128:131], v[112:115], v[160:175]
  s_nop 11
  v_exp_f32 v144, v144
  v_exp_f32 v145, v145
  v_exp_f32 v146, v146
  v_exp_f32 v147, v147
  v_exp_f32 v148, v148
  v_exp_f32 v149, v149
  v_exp_f32 v150, v150
  v_exp_f32 v151, v151
  v_exp_f32 v152, v152
  v_exp_f32 v153, v153
  v_exp_f32 v154, v154
  v_exp_f32 v155, v155
  v_exp_f32 v156, v156
  v_exp_f32 v157, v157
  v_exp_f32 v158, v158
  v_exp_f32 v159, v159
  v_cvt_pk_bf16_f32 v208, v144, v145
  v_cvt_pk_bf16_f32 v209, v146, v147
  v_cvt_pk_bf16_f32 v210, v148, v149
  v_cvt_pk_bf16_f32 v211, v150, v151
  v_cvt_pk_bf16_f32 v212, v152, v153
  v_cvt_pk_bf16_f32 v213, v154, v155
  v_cvt_pk_bf16_f32 v214, v156, v157
  v_cvt_pk_bf16_f32 v215, v158, v159
  v_mfma_f32_32x32x16_bf16 v[240:255], v[224:227], v[208:211], v[240:255]
  s_nop 0
  v_mfma_f32_32x32x16_bf16 v[240:255], v[228:231], v[212:215], v[240:255]
  s_nop 7
  s_cmp_eq_u32 s52, 3
  s_cbranch_scc1 L_s2_95
  ds_read_b128 v[128:131], v120 offset:8192
  s_mov_b64 exec, s[70:71]
  ds_read_b128 v[224:227], v120 offset:10240
  ds_read_b128 v[228:231], v120 offset:11264
  s_mov_b64 exec, -1
  s_waitcnt lgkmcnt(0)
  v_mfma_f32_32x32x16_bf16 v[144:159], v[128:131], v[112:115], v[160:175]
  s_nop 11
  v_exp_f32 v144, v144
  v_exp_f32 v145, v145
  v_exp_f32 v146, v146
  v_exp_f32 v147, v147
  v_exp_f32 v148, v148
  v_exp_f32 v149, v149
  v_exp_f32 v150, v150
  v_exp_f32 v151, v151
  v_exp_f32 v152, v152
  v_exp_f32 v153, v153
  v_exp_f32 v154, v154
  v_exp_f32 v155, v155
  v_exp_f32 v156, v156
  v_exp_f32 v157, v157
  v_exp_f32 v158, v158
  v_exp_f32 v159, v159
  v_cvt_pk_bf16_f32 v208, v144, v145
  v_cvt_pk_bf16_f32 v209, v146, v147
  v_cvt_pk_bf16_f32 v210, v148, v149
  v_cvt_pk_bf16_f32 v211, v150, v151
  v_cvt_pk_bf16_f32 v212, v152, v153
  v_cvt_pk_bf16_f32 v213, v154, v155
  v_cvt_pk_bf16_f32 v214, v156, v157
  v_cvt_pk_bf16_f32 v215, v158, v159
  v_mfma_f32_32x32x16_bf16 v[240:255], v[224:227], v[208:211], v[240:255]
  s_nop 0
  v_mfma_f32_32x32x16_bf16 v[240:255], v[228:231], v[212:215], v[240:255]
  s_nop 7
  s_cmp_eq_u32 s52, 2
  s_cbranch_scc1 L_s2_95
  ds_read_b128 v[128:131], v120 offset:4096
  s_mov_b64 exec, s[70:71]
  ds_read_b128 v[224:227], v120 offset:6144
  ds_read_b128 v[228:231], v120 offset:7168
  s_mov_b64 exec, -1
  s_waitcnt lgkmcnt(0)
  v_mfma_f32_32x32x16_bf16 v[144:159], v[128:131], v[112:115], v[160:175]
  s_nop 11
  v_exp_f32 v144, v144
  v_exp_f32 v145, v145
  v_exp_f32 v146, v146
  v_exp_f32 v147, v147
  v_exp_f32 v148, v148
  v_exp_f32 v149, v149
  v_exp_f32 v150, v150
  v_exp_f32 v151, v151
  v_exp_f32 v152, v152
  v_exp_f32 v153, v153
  v_exp_f32 v154, v154
  v_exp_f32 v155, v155
  v_exp_f32 v156, v156
  v_exp_f32 v157, v157
  v_exp_f32 v158, v158
  v_exp_f32 v159, v159
  v_cvt_pk_bf16_f32 v208, v144, v145
  v_cvt_pk_bf16_f32 v209, v146, v147
  v_cvt_pk_bf16_f32 v210, v148, v149
  v_cvt_pk_bf16_f32 v211, v150, v151
  v_cvt_pk_bf16_f32 v212, v152, v153
  v_cvt_pk_bf16_f32 v213, v154, v155
  v_cvt_pk_bf16_f32 v214, v156, v157
  v_cvt_pk_bf16_f32 v215, v158, v159
  v_mfma_f32_32x32x16_bf16 v[240:255], v[224:227], v[208:211], v[240:255]
  s_nop 0
  v_mfma_f32_32x32x16_bf16 v[240:255], v[228:231], v[212:215], v[240:255]
  s_nop 7
  s_cmp_eq_u32 s52, 1
  s_cbranch_scc1 L_s2_95
  v_sub_f32 v32, v192, v122
  v_sub_f32 v33, v193, v122
  v_sub_f32 v34, v194, v122
  v_sub_f32 v35, v195, v122
  v_sub_f32 v36, v196, v122
  v_sub_f32 v37, v197, v122
  v_sub_f32 v38, v198, v122
  v_sub_f32 v39, v199, v122
  v_sub_f32 v40, v200, v122
  v_sub_f32 v41, v201, v122
  v_sub_f32 v42, v202, v122
  v_sub_f32 v43, v203, v122
  v_sub_f32 v44, v204, v122
  v_sub_f32 v45, v205, v122
  v_sub_f32 v46, v206, v122
  v_sub_f32 v47, v207, v122
  ds_read_b128 v[128:131], v120
  s_mov_b64 exec, s[70:71]
  ds_read_b128 v[224:227], v120 offset:2048
  ds_read_b128 v[228:231], v120 offset:3072
  s_mov_b64 exec, -1
  s_waitcnt lgkmcnt(0)
  v_mfma_f32_32x32x16_bf16 v[144:159], v[128:131], v[112:115], v[32:47]
  s_nop 11
  v_exp_f32 v144, v144
  v_exp_f32 v145, v145
  v_exp_f32 v146, v146
  v_exp_f32 v147, v147
  v_exp_f32 v148, v148
  v_exp_f32 v149, v149
  v_exp_f32 v150, v150
  v_exp_f32 v151, v151
  v_exp_f32 v152, v152
  v_exp_f32 v153, v153
  v_exp_f32 v154, v154
  v_exp_f32 v155, v155
  v_exp_f32 v156, v156
  v_exp_f32 v157, v157
  v_exp_f32 v158, v158
  v_exp_f32 v159, v159
  v_cvt_pk_bf16_f32 v208, v144, v145
  v_cvt_pk_bf16_f32 v209, v146, v147
  v_cvt_pk_bf16_f32 v210, v148, v149
  v_cvt_pk_bf16_f32 v211, v150, v151
  v_cvt_pk_bf16_f32 v212, v152, v153
  v_cvt_pk_bf16_f32 v213, v154, v155
  v_cvt_pk_bf16_f32 v214, v156, v157
  v_cvt_pk_bf16_f32 v215, v158, v159
  v_mfma_f32_32x32x16_bf16 v[240:255], v[224:227], v[208:211], v[240:255]
  s_nop 0
  v_mfma_f32_32x32x16_bf16 v[240:255], v[228:231], v[212:215], v[240:255]
  s_nop 7
L_s2_95:
  s_nop 11
  v_rcp_f32 v121, v248
  s_nop 0
  v_mul_f32 v240, v240, v121
  v_mul_f32 v241, v241, v121
  v_mul_f32 v242, v242, v121
  v_mul_f32 v243, v243, v121
  v_mul_f32 v244, v244, v121
  v_mul_f32 v245, v245, v121
  v_mul_f32 v246, v246, v121
  v_mul_f32 v247, v247, v121
  v_cvt_pk_bf16_f32 v48, v240, v241
  v_cvt_pk_bf16_f32 v49, v242, v243
  v_cvt_pk_bf16_f32 v50, v244, v245
  v_cvt_pk_bf16_f32 v51, v246, v247
  ds_read_b128 v[128:131], v120 offset:33792
  s_waitcnt lgkmcnt(0)
  v_mfma_f32_32x32x16_bf16 v[144:159], v[128:131], v[116:119], v[176:191]
  s_nop 11
  v_max3_f32 v122, v144, v145, v146
  v_max3_f32 v122, v122, v147, v148
  v_max3_f32 v122, v122, v149, v150
  v_max3_f32 v122, v122, v151, v152
  v_max3_f32 v122, v122, v153, v154
  v_max3_f32 v122, v122, v155, v156
  v_max3_f32 v122, v122, v157, v158
  v_max_f32 v122, v122, v159
  s_cmp_eq_u32 s52, 8
  s_cbranch_scc1 L_s1_96
  ds_read_b128 v[128:131], v120 offset:29696
  s_waitcnt lgkmcnt(0)
  v_mfma_f32_32x32x16_bf16 v[144:159], v[128:131], v[116:119], 0
  s_nop 11
  v_max3_f32 v122, v122, v144, v145
  v_max3_f32 v122, v122, v146, v147
  v_max3_f32 v122, v122, v148, v149
  v_max3_f32 v122, v122, v150, v151
  v_max3_f32 v122, v122, v152, v153
  v_max3_f32 v122, v122, v154, v155
  v_max3_f32 v122, v122, v156, v157
  v_max3_f32 v122, v122, v158, v159
  s_cmp_eq_u32 s52, 7
  s_cbranch_scc1 L_s1_96
  ds_read_b128 v[128:131], v120 offset:25600
  s_waitcnt lgkmcnt(0)
  v_mfma_f32_32x32x16_bf16 v[144:159], v[128:131], v[116:119], 0
  s_nop 11
  v_max3_f32 v122, v122, v144, v145
  v_max3_f32 v122, v122, v146, v147
  v_max3_f32 v122, v122, v148, v149
  v_max3_f32 v122, v122, v150, v151
  v_max3_f32 v122, v122, v152, v153
  v_max3_f32 v122, v122, v154, v155
  v_max3_f32 v122, v122, v156, v157
  v_max3_f32 v122, v122, v158, v159
  s_cmp_eq_u32 s52, 6
  s_cbranch_scc1 L_s1_96
  ds_read_b128 v[128:131], v120 offset:21504
  s_waitcnt lgkmcnt(0)
  v_mfma_f32_32x32x16_bf16 v[144:159], v[128:131], v[116:119], 0
  s_nop 11
  v_max3_f32 v122, v122, v144, v145
  v_max3_f32 v122, v122, v146, v147
  v_max3_f32 v122, v122, v148, v149
  v_max3_f32 v122, v122, v150, v151
  v_max3_f32 v122, v122, v152, v153
  v_max3_f32 v122, v122, v154, v155
  v_max3_f32 v122, v122, v156, v157
  v_max3_f32 v122, v122, v158, v159
  s_cmp_eq_u32 s52, 5
  s_cbranch_scc1 L_s1_96
  ds_read_b128 v[128:131], v120 offset:17408
  s_waitcnt lgkmcnt(0)
  v_mfma_f32_32x32x16_bf16 v[144:159], v[128:131], v[116:119], 0
  s_nop 11
  v_max3_f32 v122, v122, v144, v145
  v_max3_f32 v122, v122, v146, v147
  v_max3_f32 v122, v122, v148, v149
  v_max3_f32 v122, v122, v150, v151
  v_max3_f32 v122, v122, v152, v153
  v_max3_f32 v122, v122, v154, v155
  v_max3_f32 v122, v122, v156, v157
  v_max3_f32 v122, v122, v158, v159
  s_cmp_eq_u32 s52, 4
  s_cbranch_scc1 L_s1_96
  ds_read_b128 v[128:131], v120 offset:13312
  s_waitcnt lgkmcnt(0)
  v_mfma_f32_32x32x16_bf16 v[144:159], v[128:131], v[116:119], 0
  s_nop 11
  v_max3_f32 v122, v122, v144, v145
  v_max3_f32 v122, v122, v146, v147
  v_max3_f32 v122, v122, v148, v149
  v_max3_f32 v122, v122, v150, v151
  v_max3_f32 v122, v122, v152, v153
  v_max3_f32 v122, v122, v154, v155
  v_max3_f32 v122, v122, v156, v157
  v_max3_f32 v122, v122, v158, v159
  s_cmp_eq_u32 s52, 3
  s_cbranch_scc1 L_s1_96
  ds_read_b128 v[128:131], v120 offset:9216
  s_waitcnt lgkmcnt(0)
  v_mfma_f32_32x32x16_bf16 v[144:159], v[128:131], v[116:119], 0
  s_nop 11
  v_max3_f32 v122, v122, v144, v145
  v_max3_f32 v122, v122, v146, v147
  v_max3_f32 v122, v122, v148, v149
  v_max3_f32 v122, v122, v150, v151
  v_max3_f32 v122, v122, v152, v153
  v_max3_f32 v122, v122, v154, v155
  v_max3_f32 v122, v122, v156, v157
  v_max3_f32 v122, v122, v158, v159
  s_cmp_eq_u32 s52, 2
  s_cbranch_scc1 L_s1_96
  ds_read_b128 v[128:131], v120 offset:5120
  s_waitcnt lgkmcnt(0)
  v_mfma_f32_32x32x16_bf16 v[144:159], v[128:131], v[116:119], 0
  s_nop 11
  v_max3_f32 v122, v122, v144, v145
  v_max3_f32 v122, v122, v146, v147
  v_max3_f32 v122, v122, v148, v149
  v_max3_f32 v122, v122, v150, v151
  v_max3_f32 v122, v122, v152, v153
  v_max3_f32 v122, v122, v154, v155
  v_max3_f32 v122, v122, v156, v157
  v_max3_f32 v122, v122, v158, v159
  s_cmp_eq_u32 s52, 1
  s_cbranch_scc1 L_s1_96
  ds_read_b128 v[128:131], v120 offset:1024
  s_waitcnt lgkmcnt(0)
  v_mfma_f32_32x32x16_bf16 v[144:159], v[128:131], v[116:119], v[192:207]
  s_nop 11
  v_max3_f32 v122, v122, v144, v145
  v_max3_f32 v122, v122, v146, v147
  v_max3_f32 v122, v122, v148, v149
  v_max3_f32 v122, v122, v150, v151
  v_max3_f32 v122, v122, v152, v153
  v_max3_f32 v122, v122, v154, v155
  v_max3_f32 v122, v122, v156, v157
  v_max3_f32 v122, v122, v158, v159
L_s1_96:
  s_nop 7
  v_mov_b32 v121, v122
  s_nop 1
  v_permlane32_swap_b32 v122, v121
  v_max_f32 v122, v122, v121
  v_sub_f32 v160, 0, v122
  v_sub_f32 v161, 0, v122
  v_sub_f32 v162, 0, v122
  v_sub_f32 v163, 0, v122
  v_sub_f32 v164, 0, v122
  v_sub_f32 v165, 0, v122
  v_sub_f32 v166, 0, v122
  v_sub_f32 v167, 0, v122
  v_sub_f32 v168, 0, v122
  v_sub_f32 v169, 0, v122
  v_sub_f32 v170, 0, v122
  v_sub_f32 v171, 0, v122
  v_sub_f32 v172, 0, v122
  v_sub_f32 v173, 0, v122
  v_sub_f32 v174, 0, v122
  v_sub_f32 v175, 0, v122
  v_sub_f32 v32, v176, v122
  v_sub_f32 v33, v177, v122
  v_sub_f32 v34, v178, v122
  v_sub_f32 v35, v179, v122
  v_sub_f32 v36, v180, v122
  v_sub_f32 v37, v181, v122
  v_sub_f32 v38, v182, v122
  v_sub_f32 v39, v183, v122
  v_sub_f32 v40, v184, v122
  v_sub_f32 v41, v185, v122
  v_sub_f32 v42, v186, v122
  v_sub_f32 v43, v187, v122
  v_sub_f32 v44, v188, v122
  v_sub_f32 v45, v189, v122
  v_sub_f32 v46, v190, v122
  v_sub_f32 v47, v191, v122
  ds_read_b128 v[128:131], v120 offset:33792
  s_mov_b64 exec, s[70:71]
  ds_read_b128 v[224:227], v120 offset:35072
  ds_read_b128 v[228:231], v120 offset:36096
  s_mov_b64 exec, -1
  s_waitcnt lgkmcnt(0)
  v_mfma_f32_32x32x16_bf16 v[144:159], v[128:131], v[116:119], v[32:47]
  s_nop 11
  v_exp_f32 v144, v144
  v_exp_f32 v145, v145
  v_exp_f32 v146, v146
  v_exp_f32 v147, v147
  v_exp_f32 v148, v148
  v_exp_f32 v149, v149
  v_exp_f32 v150, v150
  v_exp_f32 v151, v151
  v_exp_f32 v152, v152
  v_exp_f32 v153, v153
  v_exp_f32 v154, v154
  v_exp_f32 v155, v155
  v_exp_f32 v156, v156
  v_exp_f32 v157, v157
  v_exp_f32 v158, v158
  v_exp_f32 v159, v159
  v_cvt_pk_bf16_f32 v208, v144, v145
  v_cvt_pk_bf16_f32 v209, v146, v147
  v_cvt_pk_bf16_f32 v210, v148, v149
  v_cvt_pk_bf16_f32 v211, v150, v151
  v_cvt_pk_bf16_f32 v212, v152, v153
  v_cvt_pk_bf16_f32 v213, v154, v155
  v_cvt_pk_bf16_f32 v214, v156, v157
  v_cvt_pk_bf16_f32 v215, v158, v159
  v_mfma_f32_32x32x16_bf16 v[16:31], v[224:227], v[208:211], 0
  s_nop 0
  v_mfma_f32_32x32x16_bf16 v[16:31], v[228:231], v[212:215], v[16:31]
  s_nop 7
  s_cmp_eq_u32 s52, 8
  s_cbranch_scc1 L_s2_97
  ds_read_b128 v[128:131], v120 offset:29696
  s_mov_b64 exec, s[70:71]
  ds_read_b128 v[224:227], v120 offset:30976
  ds_read_b128 v[228:231], v120 offset:32000
  s_mov_b64 exec, -1
  s_waitcnt lgkmcnt(0)
  v_mfma_f32_32x32x16_bf16 v[144:159], v[128:131], v[116:119], v[160:175]
  s_nop 11
  v_exp_f32 v144, v144
  v_exp_f32 v145, v145
  v_exp_f32 v146, v146
  v_exp_f32 v147, v147
  v_exp_f32 v148, v148
  v_exp_f32 v149, v149
  v_exp_f32 v150, v150
  v_exp_f32 v151, v151
  v_exp_f32 v152, v152
  v_exp_f32 v153, v153
  v_exp_f32 v154, v154
  v_exp_f32 v155, v155
  v_exp_f32 v156, v156
  v_exp_f32 v157, v157
  v_exp_f32 v158, v158
  v_exp_f32 v159, v159
  v_cvt_pk_bf16_f32 v208, v144, v145
  v_cvt_pk_bf16_f32 v209, v146, v147
  v_cvt_pk_bf16_f32 v210, v148, v149
  v_cvt_pk_bf16_f32 v211, v150, v151
  v_cvt_pk_bf16_f32 v212, v152, v153
  v_cvt_pk_bf16_f32 v213, v154, v155
  v_cvt_pk_bf16_f32 v214, v156, v157
  v_cvt_pk_bf16_f32 v215, v158, v159
  v_mfma_f32_32x32x16_bf16 v[16:31], v[224:227], v[208:211], v[16:31]
  s_nop 0
  v_mfma_f32_32x32x16_bf16 v[16:31], v[228:231], v[212:215], v[16:31]
  s_nop 7
  s_cmp_eq_u32 s52, 7
  s_cbranch_scc1 L_s2_97
  ds_read_b128 v[128:131], v120 offset:25600
  s_mov_b64 exec, s[70:71]
  ds_read_b128 v[224:227], v120 offset:26880
  ds_read_b128 v[228:231], v120 offset:27904
  s_mov_b64 exec, -1
  s_waitcnt lgkmcnt(0)
  v_mfma_f32_32x32x16_bf16 v[144:159], v[128:131], v[116:119], v[160:175]
  s_nop 11
  v_exp_f32 v144, v144
  v_exp_f32 v145, v145
  v_exp_f32 v146, v146
  v_exp_f32 v147, v147
  v_exp_f32 v148, v148
  v_exp_f32 v149, v149
  v_exp_f32 v150, v150
  v_exp_f32 v151, v151
  v_exp_f32 v152, v152
  v_exp_f32 v153, v153
  v_exp_f32 v154, v154
  v_exp_f32 v155, v155
  v_exp_f32 v156, v156
  v_exp_f32 v157, v157
  v_exp_f32 v158, v158
  v_exp_f32 v159, v159
  v_cvt_pk_bf16_f32 v208, v144, v145
  v_cvt_pk_bf16_f32 v209, v146, v147
  v_cvt_pk_bf16_f32 v210, v148, v149
  v_cvt_pk_bf16_f32 v211, v150, v151
  v_cvt_pk_bf16_f32 v212, v152, v153
  v_cvt_pk_bf16_f32 v213, v154, v155
  v_cvt_pk_bf16_f32 v214, v156, v157
  v_cvt_pk_bf16_f32 v215, v158, v159
  v_mfma_f32_32x32x16_bf16 v[16:31], v[224:227], v[208:211], v[16:31]
  s_nop 0
  v_mfma_f32_32x32x16_bf16 v[16:31], v[228:231], v[212:215], v[16:31]
  s_nop 7
  s_cmp_eq_u32 s52, 6
  s_cbranch_scc1 L_s2_97
  ds_read_b128 v[128:131], v120 offset:21504
  s_mov_b64 exec, s[70:71]
  ds_read_b128 v[224:227], v120 offset:22784
  ds_read_b128 v[228:231], v120 offset:23808
  s_mov_b64 exec, -1
  s_waitcnt lgkmcnt(0)
  v_mfma_f32_32x32x16_bf16 v[144:159], v[128:131], v[116:119], v[160:175]
  s_nop 11
  v_exp_f32 v144, v144
  v_exp_f32 v145, v145
  v_exp_f32 v146, v146
  v_exp_f32 v147, v147
  v_exp_f32 v148, v148
  v_exp_f32 v149, v149
  v_exp_f32 v150, v150
  v_exp_f32 v151, v151
  v_exp_f32 v152, v152
  v_exp_f32 v153, v153
  v_exp_f32 v154, v154
  v_exp_f32 v155, v155
  v_exp_f32 v156, v156
  v_exp_f32 v157, v157
  v_exp_f32 v158, v158
  v_exp_f32 v159, v159
  v_cvt_pk_bf16_f32 v208, v144, v145
  v_cvt_pk_bf16_f32 v209, v146, v147
  v_cvt_pk_bf16_f32 v210, v148, v149
  v_cvt_pk_bf16_f32 v211, v150, v151
  v_cvt_pk_bf16_f32 v212, v152, v153
  v_cvt_pk_bf16_f32 v213, v154, v155
  v_cvt_pk_bf16_f32 v214, v156, v157
  v_cvt_pk_bf16_f32 v215, v158, v159
  v_mfma_f32_32x32x16_bf16 v[16:31], v[224:227], v[208:211], v[16:31]
  s_nop 0
  v_mfma_f32_32x32x16_bf16 v[16:31], v[228:231], v[212:215], v[16:31]
  s_nop 7
  s_cmp_eq_u32 s52, 5
  s_cbranch_scc1 L_s2_97
  ds_read_b128 v[128:131], v120 offset:17408
  s_mov_b64 exec, s[70:71]
  ds_read_b128 v[224:227], v120 offset:18688
  ds_read_b128 v[228:231], v120 offset:19712
  s_mov_b64 exec, -1
  s_waitcnt lgkmcnt(0)
  v_mfma_f32_32x32x16_bf16 v[144:159], v[128:131], v[116:119], v[160:175]
  s_nop 11
  v_exp_f32 v144, v144
  v_exp_f32 v145, v145
  v_exp_f32 v146, v146
  v_exp_f32 v147, v147
  v_exp_f32 v148, v148
  v_exp_f32 v149, v149
  v_exp_f32 v150, v150
  v_exp_f32 v151, v151
  v_exp_f32 v152, v152
  v_exp_f32 v153, v153
  v_exp_f32 v154, v154
  v_exp_f32 v155, v155
  v_exp_f32 v156, v156
  v_exp_f32 v157, v157
  v_exp_f32 v158, v158
  v_exp_f32 v159, v159
  v_cvt_pk_bf16_f32 v208, v144, v145
  v_cvt_pk_bf16_f32 v209, v146, v147
  v_cvt_pk_bf16_f32 v210, v148, v149
  v_cvt_pk_bf16_f32 v211, v150, v151
  v_cvt_pk_bf16_f32 v212, v152, v153
  v_cvt_pk_bf16_f32 v213, v154, v155
  v_cvt_pk_bf16_f32 v214, v156, v157
  v_cvt_pk_bf16_f32 v215, v158, v159
  v_mfma_f32_32x32x16_bf16 v[16:31], v[224:227], v[208:211], v[16:31]
  s_nop 0
  v_mfma_f32_32x32x16_bf16 v[16:31], v[228:231], v[212:215], v[16:31]
  s_nop 7
  s_cmp_eq_u32 s52, 4
  s_cbranch_scc1 L_s2_97
  ds_read_b128 v[128:131], v120 offset:13312
  s_mov_b64 exec, s[70:71]
  ds_read_b128 v[224:227], v120 offset:14592
  ds_read_b128 v[228:231], v120 offset:15616
  s_mov_b64 exec, -1
  s_waitcnt lgkmcnt(0)
  v_mfma_f32_32x32x16_bf16 v[144:159], v[128:131], v[116:119], v[160:175]
  s_nop 11
  v_exp_f32 v144, v144
  v_exp_f32 v145, v145
  v_exp_f32 v146, v146
  v_exp_f32 v147, v147
  v_exp_f32 v148, v148
  v_exp_f32 v149, v149
  v_exp_f32 v150, v150
  v_exp_f32 v151, v151
  v_exp_f32 v152, v152
  v_exp_f32 v153, v153
  v_exp_f32 v154, v154
  v_exp_f32 v155, v155
  v_exp_f32 v156, v156
  v_exp_f32 v157, v157
  v_exp_f32 v158, v158
  v_exp_f32 v159, v159
  v_cvt_pk_bf16_f32 v208, v144, v145
  v_cvt_pk_bf16_f32 v209, v146, v147
  v_cvt_pk_bf16_f32 v210, v148, v149
  v_cvt_pk_bf16_f32 v211, v150, v151
  v_cvt_pk_bf16_f32 v212, v152, v153
  v_cvt_pk_bf16_f32 v213, v154, v155
  v_cvt_pk_bf16_f32 v214, v156, v157
  v_cvt_pk_bf16_f32 v215, v158, v159
  v_mfma_f32_32x32x16_bf16 v[16:31], v[224:227], v[208:211], v[16:31]
  s_nop 0
  v_mfma_f32_32x32x16_bf16 v[16:31], v[228:231], v[212:215], v[16:31]
  s_nop 7
  s_cmp_eq_u32 s52, 3
  s_cbranch_scc1 L_s2_97
  ds_read_b128 v[128:131], v120 offset:9216
  s_mov_b64 exec, s[70:71]
  ds_read_b128 v[224:227], v120 offset:10496
  ds_read_b128 v[228:231], v120 offset:11520
  s_mov_b64 exec, -1
  s_waitcnt lgkmcnt(0)
  v_mfma_f32_32x32x16_bf16 v[144:159], v[128:131], v[116:119], v[160:175]
  s_nop 11
  v_exp_f32 v144, v144
  v_exp_f32 v145, v145
  v_exp_f32 v146, v146
  v_exp_f32 v147, v147
  v_exp_f32 v148, v148
  v_exp_f32 v149, v149
  v_exp_f32 v150, v150
  v_exp_f32 v151, v151
  v_exp_f32 v152, v152
  v_exp_f32 v153, v153
  v_exp_f32 v154, v154
  v_exp_f32 v155, v155
  v_exp_f32 v156, v156
  v_exp_f32 v157, v157
  v_exp_f32 v158, v158
  v_exp_f32 v159, v159
  v_cvt_pk_bf16_f32 v208, v144, v145
  v_cvt_pk_bf16_f32 v209, v146, v147
  v_cvt_pk_bf16_f32 v210, v148, v149
  v_cvt_pk_bf16_f32 v211, v150, v151
  v_cvt_pk_bf16_f32 v212, v152, v153
  v_cvt_pk_bf16_f32 v213, v154, v155
  v_cvt_pk_bf16_f32 v214, v156, v157
  v_cvt_pk_bf16_f32 v215, v158, v159
  v_mfma_f32_32x32x16_bf16 v[16:31], v[224:227], v[208:211], v[16:31]
  s_nop 0
  v_mfma_f32_32x32x16_bf16 v[16:31], v[228:231], v[212:215], v[16:31]
  s_nop 7
  s_cmp_eq_u32 s52, 2
  s_cbranch_scc1 L_s2_97
  ds_read_b128 v[128:131], v120 offset:5120
  s_mov_b64 exec, s[70:71]
  ds_read_b128 v[224:227], v120 offset:6400
  ds_read_b128 v[228:231], v120 offset:7424
  s_mov_b64 exec, -1
  s_waitcnt lgkmcnt(0)
  v_mfma_f32_32x32x16_bf16 v[144:159], v[128:131], v[116:119], v[160:175]
  s_nop 11
  v_exp_f32 v144, v144
  v_exp_f32 v145, v145
  v_exp_f32 v146, v146
  v_exp_f32 v147, v147
  v_exp_f32 v148, v148
  v_exp_f32 v149, v149
  v_exp_f32 v150, v150
  v_exp_f32 v151, v151
  v_exp_f32 v152, v152
  v_exp_f32 v153, v153
  v_exp_f32 v154, v154
  v_exp_f32 v155, v155
  v_exp_f32 v156, v156
  v_exp_f32 v157, v157
  v_exp_f32 v158, v158
  v_exp_f32 v159, v159
  v_cvt_pk_bf16_f32 v208, v144, v145
  v_cvt_pk_bf16_f32 v209, v146, v147
  v_cvt_pk_bf16_f32 v210, v148, v149
  v_cvt_pk_bf16_f32 v211, v150, v151
  v_cvt_pk_bf16_f32 v212, v152, v153
  v_cvt_pk_bf16_f32 v213, v154, v155
  v_cvt_pk_bf16_f32 v214, v156, v157
  v_cvt_pk_bf16_f32 v215, v158, v159
  v_mfma_f32_32x32x16_bf16 v[16:31], v[224:227], v[208:211], v[16:31]
  s_nop 0
  v_mfma_f32_32x32x16_bf16 v[16:31], v[228:231], v[212:215], v[16:31]
  s_nop 7
  s_cmp_eq_u32 s52, 1
  s_cbranch_scc1 L_s2_97
  v_sub_f32 v32, v192, v122
  v_sub_f32 v33, v193, v122
  v_sub_f32 v34, v194, v122
  v_sub_f32 v35, v195, v122
  v_sub_f32 v36, v196, v122
  v_sub_f32 v37, v197, v122
  v_sub_f32 v38, v198, v122
  v_sub_f32 v39, v199, v122
  v_sub_f32 v40, v200, v122
  v_sub_f32 v41, v201, v122
  v_sub_f32 v42, v202, v122
  v_sub_f32 v43, v203, v122
  v_sub_f32 v44, v204, v122
  v_sub_f32 v45, v205, v122
  v_sub_f32 v46, v206, v122
  v_sub_f32 v47, v207, v122
  ds_read_b128 v[128:131], v120 offset:1024
  s_mov_b64 exec, s[70:71]
  ds_read_b128 v[224:227], v120 offset:2304
  ds_read_b128 v[228:231], v120 offset:3328
  s_mov_b64 exec, -1
  s_waitcnt lgkmcnt(0)
  v_mfma_f32_32x32x16_bf16 v[144:159], v[128:131], v[116:119], v[32:47]
  s_nop 11
  v_exp_f32 v144, v144
  v_exp_f32 v145, v145
  v_exp_f32 v146, v146
  v_exp_f32 v147, v147
  v_exp_f32 v148, v148
  v_exp_f32 v149, v149
  v_exp_f32 v150, v150
  v_exp_f32 v151, v151
  v_exp_f32 v152, v152
  v_exp_f32 v153, v153
  v_exp_f32 v154, v154
  v_exp_f32 v155, v155
  v_exp_f32 v156, v156
  v_exp_f32 v157, v157
  v_exp_f32 v158, v158
  v_exp_f32 v159, v159
  v_cvt_pk_bf16_f32 v208, v144, v145
  v_cvt_pk_bf16_f32 v209, v146, v147
  v_cvt_pk_bf16_f32 v210, v148, v149
  v_cvt_pk_bf16_f32 v211, v150, v151
  v_cvt_pk_bf16_f32 v212, v152, v153
  v_cvt_pk_bf16_f32 v213, v154, v155
  v_cvt_pk_bf16_f32 v214, v156, v157
  v_cvt_pk_bf16_f32 v215, v158, v159
  v_mfma_f32_32x32x16_bf16 v[16:31], v[224:227], v[208:211], v[16:31]
  s_nop 0
  v_mfma_f32_32x32x16_bf16 v[16:31], v[228:231], v[212:215], v[16:31]
  s_nop 7
L_s2_97:
  s_nop 11
  v_rcp_f32 v121, v24
  s_nop 0
  v_mul_f32 v16, v16, v121
  v_mul_f32 v17, v17, v121
  v_mul_f32 v18, v18, v121
  v_mul_f32 v19, v19, v121
  v_mul_f32 v20, v20, v121
  v_mul_f32 v21, v21, v121
  v_mul_f32 v22, v22, v121
  v_mul_f32 v23, v23, v121
  v_cvt_pk_bf16_f32 v52, v16, v17
  v_cvt_pk_bf16_f32 v53, v18, v19
  v_cvt_pk_bf16_f32 v54, v20, v21
  v_cvt_pk_bf16_f32 v55, v22, v23
  s_nop 1
  s_setpc_b64 s[84:85]
L_cpf:
  s_getpc_b64 s[80:81]
L_pc:
  s_sub_u32 s80, s80, L_pc-parallel_sum__sliding_block__mixer_gmlp__prompt_kernel
  s_subb_u32 s81, s81, 0
  s_mov_b32 s82, L_codeend-parallel_sum__sliding_block__mixer_gmlp__prompt_kernel
  s_mov_b32 s83, 0x20000
  s_bfe_u32 s84, s2, 0x20003
  s_lshl_b32 s84, s84, 14
  v_and_b32 v18, 31, v0
  v_lshlrev_b32 v18, 7, v18
  v_lshl_add_u32 v18, v16, 12, v18
  buffer_load_dword v42, v18, s[80:83], s84 offen
  s_branch L_nocpf
L_touch:
  s_mov_b32 s18, 8388608
  s_mov_b32 s19, 0x20000
  v_lshlrev_b32 v24, 12, v17
  s_lshl_b32 s77, s40, 1
  s_and_b32 s78, s43, 1
  s_add_u32 s77, s77, s78
  s_lshl_b32 s77, s77, 18
  s_lshl_b32 s78, s42, 11
  s_add_u32 s77, s77, s78
  v_add_u32 v24, s77, v24
  s_and_b32 s77, s40, 3
  s_lshl_b32 s77, s77, 9
  s_lshr_b32 s78, s43, 1
  s_lshl_b32 s78, s78, 7
  s_add_u32 s77, s77, s78
  buffer_load_dword v42, v24, s[16:19], s77 offen
  s_add_u32 s77, s77, 256
  s_and_b32 s77, s77, 2047
  buffer_load_dword v42, v24, s[16:19], s77 offen
  s_add_u32 s77, s77, 256
  s_and_b32 s77, s77, 2047
  buffer_load_dword v42, v24, s[16:19], s77 offen
  s_add_u32 s77, s77, 256
  s_and_b32 s77, s77, 2047
  buffer_load_dword v42, v24, s[16:19], s77 offen
  s_add_u32 s77, s77, 256
  s_and_b32 s77, s77, 2047
  buffer_load_dword v42, v24, s[16:19], s77 offen
  s_add_u32 s77, s77, 256
  s_and_b32 s77, s77, 2047
  buffer_load_dword v42, v24, s[16:19], s77 offen
  s_add_u32 s77, s77, 256
  s_and_b32 s77, s77, 2047
  buffer_load_dword v42, v24, s[16:19], s77 offen
  s_add_u32 s77, s77, 256
  s_and_b32 s77, s77, 2047
  buffer_load_dword v42, v24, s[16:19], s77 offen
  s_add_u32 s77, s77, 256
  s_and_b32 s77, s77, 2047
  s_branch L_notouch
L_slow_1:
  s_mov_b32 s76, 20000
L_loop_3:
  s_sleep 1
  buffer_load_dword v10, v2, s[36:39], 0 offen sc1
  s_waitcnt vmcnt(0)
  v_cmp_ne_u32 s[74:75], s44, v10
  s_nop 1
  s_cmp_eq_u64 s[74:75], 0
  s_cbranch_scc1 L_back_2
  s_sub_u32 s76, s76, 1
  s_cmp_lg_u32 s76, 0
  s_cbranch_scc1 L_loop_3
  s_branch L_back_2
L_slow_4:
  s_mov_b32 s76, 20000
L_loop_6:
  s_sleep 1
  buffer_load_dwordx4 v[16:19], v14, s[36:39], 0 offen sc1
  buffer_load_dwordx4 v[20:23], v14, s[36:39], 0 offen offset:512 sc1
  buffer_load_dwordx4 v[24:27], v14, s[36:39], 0 offen offset:1024 sc1
  buffer_load_dwordx4 v[28:31], v14, s[36:39], 0 offen offset:1536 sc1
  buffer_load_dwordx4 v[32:35], v14, s[36:39], 0 offen offset:2048 sc1
  buffer_load_dwordx4 v[36:39], v14, s[36:39], 0 offen offset:2560 sc1
  buffer_load_dwordx4 v[40:43], v14, s[36:39], 0 offen offset:3072 sc1
  buffer_load_dwordx4 v[44:47], v14, s[36:39], 0 offen offset:3584 sc1
  s_waitcnt vmcnt(0)
  v_xor_b32 v15, s44, v17
  v_bitop3_b32 v15, v15, v19, s44 bitop3:0xf6
  v_bitop3_b32 v15, v15, v21, s44 bitop3:0xf6
  v_bitop3_b32 v15, v15, v23, s44 bitop3:0xf6
  v_bitop3_b32 v15, v15, v25, s44 bitop3:0xf6
  v_bitop3_b32 v15, v15, v27, s44 bitop3:0xf6
  v_bitop3_b32 v15, v15, v29, s44 bitop3:0xf6
  v_bitop3_b32 v15, v15, v31, s44 bitop3:0xf6
  v_bitop3_b32 v15, v15, v33, s44 bitop3:0xf6
  v_bitop3_b32 v15, v15, v35, s44 bitop3:0xf6
  v_bitop3_b32 v15, v15, v37, s44 bitop3:0xf6
  v_bitop3_b32 v15, v15, v39, s44 bitop3:0xf6
  v_bitop3_b32 v15, v15, v41, s44 bitop3:0xf6
  v_bitop3_b32 v15, v15, v43, s44 bitop3:0xf6
  v_bitop3_b32 v15, v15, v45, s44 bitop3:0xf6
  v_bitop3_b32 v15, v15, v47, s44 bitop3:0xf6
  v_cmp_ne_u32 s[74:75], 0, v15
  s_nop 1
  s_cmp_eq_u64 s[74:75], 0
  s_cbranch_scc1 L_back_5
  s_sub_u32 s76, s76, 1
  s_cmp_lg_u32 s76, 0
  s_cbranch_scc1 L_loop_6
  s_branch L_back_5
L_slow_7:
  s_mov_b32 s76, 20000
L_loop_9:
  s_sleep 1
  buffer_load_dword v10, v2, s[36:39], 0 offen sc1
  s_waitcnt vmcnt(0)
  v_cmp_ne_u32 s[74:75], s44, v10
  s_nop 1
  s_cmp_eq_u64 s[74:75], 0
  s_cbranch_scc1 L_back_8
  s_sub_u32 s76, s76, 1
  s_cmp_lg_u32 s76, 0
  s_cbranch_scc1 L_loop_9
  s_branch L_back_8
L_slow_10:
  s_mov_b32 s76, 20000
L_loop_12:
  s_sleep 1
  buffer_load_dword v123, v124, s[36:39], 0 offen sc1
  s_waitcnt vmcnt(0)
  v_cmp_ne_u32 s[74:75], s44, v123
  s_nop 1
  s_cmp_eq_u64 s[74:75], 0
  s_cbranch_scc1 L_back_11
  s_sub_u32 s76, s76, 1
  s_cmp_lg_u32 s76, 0
  s_cbranch_scc1 L_loop_12
  s_branch L_back_11
L_slow_14:
  s_mov_b32 s76, 20000
L_loop_16:
  s_sleep 1
  buffer_load_dword v30, v19, s[36:39], s87 offen sc1
  buffer_load_dwordx4 v[64:67], v0, s[36:39], s72 offen sc1
  buffer_load_dwordx4 v[68:71], v0, s[36:39], s72 offen offset:1024 sc1
  s_waitcnt vmcnt(0)
  v_bitop3_b32 v16, s44, v64, v65 bitop3:0x96
  v_bitop3_b32 v16, v16, v66, v67 bitop3:0x96
  v_bitop3_b32 v16, v16, v68, v69 bitop3:0x96
  v_bitop3_b32 v16, v16, v70, v71 bitop3:0x96
  v_cmp_ne_u32 s[74:75], v30, v16
  s_nop 1
  s_cmp_eq_u64 s[74:75], 0
  s_cbranch_scc1 L_back_15
  s_sub_u32 s76, s76, 1
  s_cmp_lg_u32 s76, 0
  s_cbranch_scc1 L_loop_16
  s_branch L_back_15
L_slow_17:
  s_mov_b32 s76, 20000
L_loop_19:
  s_sleep 1
  buffer_load_dword v31, v19, s[36:39], s87 offen offset:256 sc1
  buffer_load_dwordx4 v[72:75], v0, s[36:39], s72 offen offset:2048 sc1
  buffer_load_dwordx4 v[76:79], v0, s[36:39], s72 offen offset:3072 sc1
  s_waitcnt vmcnt(0)
  v_bitop3_b32 v17, s44, v72, v73 bitop3:0x96
  v_bitop3_b32 v17, v17, v74, v75 bitop3:0x96
  v_bitop3_b32 v17, v17, v76, v77 bitop3:0x96
  v_bitop3_b32 v17, v17, v78, v79 bitop3:0x96
  v_cmp_ne_u32 s[74:75], v31, v17
  s_nop 1
  s_cmp_eq_u64 s[74:75], 0
  s_cbranch_scc1 L_back_18
  s_sub_u32 s76, s76, 1
  s_cmp_lg_u32 s76, 0
  s_cbranch_scc1 L_loop_19
  s_branch L_back_18
L_slow_20:
  s_mov_b32 s76, 20000
L_loop_22:
  s_sleep 1
  buffer_load_dword v250, v251, s[36:39], 0 offen sc1
  s_waitcnt vmcnt(0)
  v_cmp_ne_u32 s[74:75], s44, v250
  s_nop 1
  s_cmp_eq_u64 s[74:75], 0
  s_cbranch_scc1 L_back_21
  s_sub_u32 s76, s76, 1
  s_cmp_lg_u32 s76, 0
  s_cbranch_scc1 L_loop_22
  s_branch L_back_21
L_slow_23:
  s_mov_b32 s76, 20000
L_loop_25:
  s_sleep 8
  buffer_load_dword v250, v251, s[36:39], 0 offen sc1
  s_waitcnt vmcnt(0)
  v_cmp_ne_u32 s[74:75], s44, v250
  s_nop 1
  s_cmp_eq_u64 s[74:75], 0
  s_cbranch_scc1 L_back_24
  s_sub_u32 s76, s76, 1
  s_cmp_lg_u32 s76, 0
  s_cbranch_scc1 L_loop_25
  s_branch L_back_24
L_slow_26:
  s_mov_b32 s76, 20000
L_loop_28:
  s_sleep 2
  buffer_load_dword v250, v251, s[36:39], 0 offen sc1
  s_waitcnt vmcnt(0)
  v_cmp_ne_u32 s[74:75], s44, v250
  s_nop 1
  s_cmp_eq_u64 s[74:75], 0
  s_cbranch_scc1 L_back_27
  s_sub_u32 s76, s76, 1
  s_cmp_lg_u32 s76, 0
  s_cbranch_scc1 L_loop_28
  s_branch L_back_27
L_slow_29:
  s_mov_b32 s76, 20000
L_loop_31:
  s_sleep 1
  buffer_load_dword v123, v124, s[36:39], 0 offen sc1
  s_waitcnt vmcnt(0)
  v_cmp_ne_u32 s[74:75], s44, v123
  s_nop 1
  s_cmp_eq_u64 s[74:75], 0
  s_cbranch_scc1 L_back_30
  s_sub_u32 s76, s76, 1
  s_cmp_lg_u32 s76, 0
  s_cbranch_scc1 L_loop_31
  s_branch L_back_30
L_cz_32:
  s_nop 7
  v_mov_b32 v32, 0xff800000
  v_mov_b32 v33, 0xff800000
  v_mov_b32 v34, 0xff800000
  v_mov_b32 v35, 0xff800000
  v_mov_b32 v36, 0xff800000
  v_mov_b32 v37, 0xff800000
  v_mov_b32 v38, 0xff800000
  v_mov_b32 v39, 0xff800000
  v_mov_b32 v40, 0xff800000
  v_mov_b32 v41, 0xff800000
  v_mov_b32 v42, 0xff800000
  v_mov_b32 v43, 0xff800000
  v_mov_b32 v44, 0xff800000
  v_mov_b32 v45, 0xff800000
  v_mov_b32 v46, 0xff800000
  v_mov_b32 v47, 0xff800000
  s_nop 1
  s_branch L_czb_33
L_cz_34:
  s_nop 7
  v_mov_b32 v32, 0xff800000
  v_mov_b32 v33, 0xff800000
  v_mov_b32 v34, 0xff800000
  v_mov_b32 v35, 0xff800000
  v_mov_b32 v36, 0xff800000
  v_mov_b32 v37, 0xff800000
  v_mov_b32 v38, 0xff800000
  v_mov_b32 v39, 0xff800000
  v_mov_b32 v40, 0xff800000
  v_mov_b32 v41, 0xff800000
  v_mov_b32 v42, 0xff800000
  v_mov_b32 v43, 0xff800000
  v_mov_b32 v44, 0xff800000
  v_mov_b32 v45, 0xff800000
  v_mov_b32 v46, 0xff800000
  v_mov_b32 v47, 0xff800000
  s_nop 1
  s_branch L_czb_35
L_cz_36:
  s_nop 7
  v_mov_b32 v32, 0xff800000
  v_mov_b32 v33, 0xff800000
  v_mov_b32 v34, 0xff800000
  v_mov_b32 v35, 0xff800000
  v_mov_b32 v36, 0xff800000
  v_mov_b32 v37, 0xff800000
  v_mov_b32 v38, 0xff800000
  v_mov_b32 v39, 0xff800000
  v_mov_b32 v40, 0xff800000
  v_mov_b32 v41, 0xff800000
  v_mov_b32 v42, 0xff800000
  v_mov_b32 v43, 0xff800000
  v_mov_b32 v44, 0xff800000
  v_mov_b32 v45, 0xff800000
  v_mov_b32 v46, 0xff800000
  v_mov_b32 v47, 0xff800000
  s_nop 1
  s_branch L_czb_37
L_cz_38:
  s_nop 7
  v_mov_b32 v32, 0xff800000
  v_mov_b32 v33, 0xff800000
  v_mov_b32 v34, 0xff800000
  v_mov_b32 v35, 0xff800000
  v_mov_b32 v36, 0xff800000
  v_mov_b32 v37, 0xff800000
  v_mov_b32 v38, 0xff800000
  v_mov_b32 v39, 0xff800000
  v_mov_b32 v40, 0xff800000
  v_mov_b32 v41, 0xff800000
  v_mov_b32 v42, 0xff800000
  v_mov_b32 v43, 0xff800000
  v_mov_b32 v44, 0xff800000
  v_mov_b32 v45, 0xff800000
  v_mov_b32 v46, 0xff800000
  v_mov_b32 v47, 0xff800000
  s_nop 1
  s_branch L_czb_39
L_cz_40:
  s_nop 7
  v_mov_b32 v32, 0xff800000
  v_mov_b32 v33, 0xff800000
  v_mov_b32 v34, 0xff800000
  v_mov_b32 v35, 0xff800000
  v_mov_b32 v36, 0xff800000
  v_mov_b32 v37, 0xff800000
  v_mov_b32 v38, 0xff800000
  v_mov_b32 v39, 0xff800000
  v_mov_b32 v40, 0xff800000
  v_mov_b32 v41, 0xff800000
  v_mov_b32 v42, 0xff800000
  v_mov_b32 v43, 0xff800000
  v_mov_b32 v44, 0xff800000
  v_mov_b32 v45, 0xff800000
  v_mov_b32 v46, 0xff800000
  v_mov_b32 v47, 0xff800000
  s_nop 1
  s_branch L_czb_41
L_cz_42:
  s_nop 7
  v_mov_b32 v32, 0xff800000
  v_mov_b32 v33, 0xff800000
  v_mov_b32 v34, 0xff800000
  v_mov_b32 v35, 0xff800000
  v_mov_b32 v36, 0xff800000
  v_mov_b32 v37, 0xff800000
  v_mov_b32 v38, 0xff800000
  v_mov_b32 v39, 0xff800000
  v_mov_b32 v40, 0xff800000
  v_mov_b32 v41, 0xff800000
  v_mov_b32 v42, 0xff800000
  v_mov_b32 v43, 0xff800000
  v_mov_b32 v44, 0xff800000
  v_mov_b32 v45, 0xff800000
  v_mov_b32 v46, 0xff800000
  v_mov_b32 v47, 0xff800000
  s_nop 1
  s_branch L_czb_43
L_cz_44:
  s_nop 7
  v_mov_b32 v32, 0xff800000
  v_mov_b32 v33, 0xff800000
  v_mov_b32 v34, 0xff800000
  v_mov_b32 v35, 0xff800000
  v_mov_b32 v36, 0xff800000
  v_mov_b32 v37, 0xff800000
  v_mov_b32 v38, 0xff800000
  v_mov_b32 v39, 0xff800000
  v_mov_b32 v40, 0xff800000
  v_mov_b32 v41, 0xff800000
  v_mov_b32 v42, 0xff800000
  v_mov_b32 v43, 0xff800000
  v_mov_b32 v44, 0xff800000
  v_mov_b32 v45, 0xff800000
  v_mov_b32 v46, 0xff800000
  v_mov_b32 v47, 0xff800000
  s_nop 1
  s_branch L_czb_45
L_cz_46:
  s_nop 7
  v_mov_b32 v32, 0xff800000
  v_mov_b32 v33, 0xff800000
  v_mov_b32 v34, 0xff800000
  v_mov_b32 v35, 0xff800000
  v_mov_b32 v36, 0xff800000
  v_mov_b32 v37, 0xff800000
  v_mov_b32 v38, 0xff800000
  v_mov_b32 v39, 0xff800000
  v_mov_b32 v40, 0xff800000
  v_mov_b32 v41, 0xff800000
  v_mov_b32 v42, 0xff800000
  v_mov_b32 v43, 0xff800000
  v_mov_b32 v44, 0xff800000
  v_mov_b32 v45, 0xff800000
  v_mov_b32 v46, 0xff800000
  v_mov_b32 v47, 0xff800000
  s_nop 1
  s_branch L_czb_47
L_cz_48:
  s_nop 7
  v_mov_b32 v32, 0xff800000
  v_mov_b32 v33, 0xff800000
  v_mov_b32 v34, 0xff800000
  v_mov_b32 v35, 0xff800000
  v_mov_b32 v36, 0xff800000
  v_mov_b32 v37, 0xff800000
  v_mov_b32 v38, 0xff800000
  v_mov_b32 v39, 0xff800000
  v_mov_b32 v40, 0xff800000
  v_mov_b32 v41, 0xff800000
  v_mov_b32 v42, 0xff800000
  v_mov_b32 v43, 0xff800000
  v_mov_b32 v44, 0xff800000
  v_mov_b32 v45, 0xff800000
  v_mov_b32 v46, 0xff800000
  v_mov_b32 v47, 0xff800000
  s_nop 1
  s_branch L_czb_49
L_cz_50:
  s_nop 7
  v_mov_b32 v32, 0xff800000
  v_mov_b32 v33, 0xff800000
  v_mov_b32 v34, 0xff800000
  v_mov_b32 v35, 0xff800000
  v_mov_b32 v36, 0xff800000
  v_mov_b32 v37, 0xff800000
  v_mov_b32 v38, 0xff800000
  v_mov_b32 v39, 0xff800000
  v_mov_b32 v40, 0xff800000
  v_mov_b32 v41, 0xff800000
  v_mov_b32 v42, 0xff800000
  v_mov_b32 v43, 0xff800000
  v_mov_b32 v44, 0xff800000
  v_mov_b32 v45, 0xff800000
  v_mov_b32 v46, 0xff800000
  v_mov_b32 v47, 0xff800000
  s_nop 1
  s_branch L_czb_51
L_cz_52:
  s_nop 7
  v_mov_b32 v32, 0xff800000
  v_mov_b32 v33, 0xff800000
  v_mov_b32 v34, 0xff800000
  v_mov_b32 v35, 0xff800000
  v_mov_b32 v36, 0xff800000
  v_mov_b32 v37, 0xff800000
  v_mov_b32 v38, 0xff800000
  v_mov_b32 v39, 0xff800000
  v_mov_b32 v40, 0xff800000
  v_mov_b32 v41, 0xff800000
  v_mov_b32 v42, 0xff800000
  v_mov_b32 v43, 0xff800000
  v_mov_b32 v44, 0xff800000
  v_mov_b32 v45, 0xff800000
  v_mov_b32 v46, 0xff800000
  v_mov_b32 v47, 0xff800000
  s_nop 1
  s_branch L_czb_53
L_cz_54:
  s_nop 7
  v_mov_b32 v32, 0xff800000
  v_mov_b32 v33, 0xff800000
  v_mov_b32 v34, 0xff800000
  v_mov_b32 v35, 0xff800000
  v_mov_b32 v36, 0xff800000
  v_mov_b32 v37, 0xff800000
  v_mov_b32 v38, 0xff800000
  v_mov_b32 v39, 0xff800000
  v_mov_b32 v40, 0xff800000
  v_mov_b32 v41, 0xff800000
  v_mov_b32 v42, 0xff800000
  v_mov_b32 v43, 0xff800000
  v_mov_b32 v44, 0xff800000
  v_mov_b32 v45, 0xff800000
  v_mov_b32 v46, 0xff800000
  v_mov_b32 v47, 0xff800000
  s_nop 1
  s_branch L_czb_55
L_cz_56:
  s_nop 7
  v_mov_b32 v32, 0xff800000
  v_mov_b32 v33, 0xff800000
  v_mov_b32 v34, 0xff800000
  v_mov_b32 v35, 0xff800000
  v_mov_b32 v36, 0xff800000
  v_mov_b32 v37, 0xff800000
  v_mov_b32 v38, 0xff800000
  v_mov_b32 v39, 0xff800000
  v_mov_b32 v40, 0xff800000
  v_mov_b32 v41, 0xff800000
  v_mov_b32 v42, 0xff800000
  v_mov_b32 v43, 0xff800000
  v_mov_b32 v44, 0xff800000
  v_mov_b32 v45, 0xff800000
  v_mov_b32 v46, 0xff800000
  v_mov_b32 v47, 0xff800000
  s_nop 1
  s_branch L_czb_57
L_cz_58:
  s_nop 7
  v_mov_b32 v32, 0xff800000
  v_mov_b32 v33, 0xff800000
  v_mov_b32 v34, 0xff800000
  v_mov_b32 v35, 0xff800000
  v_mov_b32 v36, 0xff800000
  v_mov_b32 v37, 0xff800000
  v_mov_b32 v38, 0xff800000
  v_mov_b32 v39, 0xff800000
  v_mov_b32 v40, 0xff800000
  v_mov_b32 v41, 0xff800000
  v_mov_b32 v42, 0xff800000
  v_mov_b32 v43, 0xff800000
  v_mov_b32 v44, 0xff800000
  v_mov_b32 v45, 0xff800000
  v_mov_b32 v46, 0xff800000
  v_mov_b32 v47, 0xff800000
  s_nop 1
  s_branch L_czb_59
L_slow_62:
  s_mov_b32 s76, 20000
L_loop_64:
  s_sleep 8
  buffer_load_dword v250, v251, s[36:39], 0 offen sc1
  s_waitcnt vmcnt(0)
  v_cmp_ne_u32 s[74:75], s44, v250
  s_nop 1
  s_cmp_eq_u64 s[74:75], 0
  s_cbranch_scc1 L_back_63
  s_sub_u32 s76, s76, 1
  s_cmp_lg_u32 s76, 0
  s_cbranch_scc1 L_loop_64
  s_branch L_back_63
L_cz_65:
  s_nop 7
  v_mov_b32 v32, 0xff800000
  v_mov_b32 v33, 0xff800000
  v_mov_b32 v34, 0xff800000
  v_mov_b32 v35, 0xff800000
  v_mov_b32 v36, 0xff800000
  v_mov_b32 v37, 0xff800000
  v_mov_b32 v38, 0xff800000
  v_mov_b32 v39, 0xff800000
  v_mov_b32 v40, 0xff800000
  v_mov_b32 v41, 0xff800000
  v_mov_b32 v42, 0xff800000
  v_mov_b32 v43, 0xff800000
  v_mov_b32 v44, 0xff800000
  v_mov_b32 v45, 0xff800000
  v_mov_b32 v46, 0xff800000
  v_mov_b32 v47, 0xff800000
  s_nop 1
  s_branch L_czb_66
L_cz_67:
  s_nop 7
  v_mov_b32 v32, 0xff800000
  v_mov_b32 v33, 0xff800000
  v_mov_b32 v34, 0xff800000
  v_mov_b32 v35, 0xff800000
  v_mov_b32 v36, 0xff800000
  v_mov_b32 v37, 0xff800000
  v_mov_b32 v38, 0xff800000
  v_mov_b32 v39, 0xff800000
  v_mov_b32 v40, 0xff800000
  v_mov_b32 v41, 0xff800000
  v_mov_b32 v42, 0xff800000
  v_mov_b32 v43, 0xff800000
  v_mov_b32 v44, 0xff800000
  v_mov_b32 v45, 0xff800000
  v_mov_b32 v46, 0xff800000
  v_mov_b32 v47, 0xff800000
  s_nop 1
  s_branch L_czb_68
L_cz_69:
  s_nop 7
  v_mov_b32 v32, 0xff800000
  v_mov_b32 v33, 0xff800000
  v_mov_b32 v34, 0xff800000
  v_mov_b32 v35, 0xff800000
  v_mov_b32 v36, 0xff800000
  v_mov_b32 v37, 0xff800000
  v_mov_b32 v38, 0xff800000
  v_mov_b32 v39, 0xff800000
  v_mov_b32 v40, 0xff800000
  v_mov_b32 v41, 0xff800000
  v_mov_b32 v42, 0xff800000
  v_mov_b32 v43, 0xff800000
  v_mov_b32 v44, 0xff800000
  v_mov_b32 v45, 0xff800000
  v_mov_b32 v46, 0xff800000
  v_mov_b32 v47, 0xff800000
  s_nop 1
  s_branch L_czb_70
L_cz_71:
  s_nop 7
  v_mov_b32 v32, 0xff800000
  v_mov_b32 v33, 0xff800000
  v_mov_b32 v34, 0xff800000
  v_mov_b32 v35, 0xff800000
  v_mov_b32 v36, 0xff800000
  v_mov_b32 v37, 0xff800000
  v_mov_b32 v38, 0xff800000
  v_mov_b32 v39, 0xff800000
  v_mov_b32 v40, 0xff800000
  v_mov_b32 v41, 0xff800000
  v_mov_b32 v42, 0xff800000
  v_mov_b32 v43, 0xff800000
  v_mov_b32 v44, 0xff800000
  v_mov_b32 v45, 0xff800000
  v_mov_b32 v46, 0xff800000
  v_mov_b32 v47, 0xff800000
  s_nop 1
  s_branch L_czb_72
L_cz_73:
  s_nop 7
  v_mov_b32 v32, 0xff800000
  v_mov_b32 v33, 0xff800000
  v_mov_b32 v34, 0xff800000
  v_mov_b32 v35, 0xff800000
  v_mov_b32 v36, 0xff800000
  v_mov_b32 v37, 0xff800000
  v_mov_b32 v38, 0xff800000
  v_mov_b32 v39, 0xff800000
  v_mov_b32 v40, 0xff800000
  v_mov_b32 v41, 0xff800000
  v_mov_b32 v42, 0xff800000
  v_mov_b32 v43, 0xff800000
  v_mov_b32 v44, 0xff800000
  v_mov_b32 v45, 0xff800000
  v_mov_b32 v46, 0xff800000
  v_mov_b32 v47, 0xff800000
  s_nop 1
  s_branch L_czb_74
L_cz_75:
  s_nop 7
  v_mov_b32 v32, 0xff800000
  v_mov_b32 v33, 0xff800000
  v_mov_b32 v34, 0xff800000
  v_mov_b32 v35, 0xff800000
  v_mov_b32 v36, 0xff800000
  v_mov_b32 v37, 0xff800000
  v_mov_b32 v38, 0xff800000
  v_mov_b32 v39, 0xff800000
  v_mov_b32 v40, 0xff800000
  v_mov_b32 v41, 0xff800000
  v_mov_b32 v42, 0xff800000
  v_mov_b32 v43, 0xff800000
  v_mov_b32 v44, 0xff800000
  v_mov_b32 v45, 0xff800000
  v_mov_b32 v46, 0xff800000
  v_mov_b32 v47, 0xff800000
  s_nop 1
  s_branch L_czb_76
L_cz_77:
  s_nop 7
  v_mov_b32 v32, 0xff800000
  v_mov_b32 v33, 0xff800000
  v_mov_b32 v34, 0xff800000
  v_mov_b32 v35, 0xff800000
  v_mov_b32 v36, 0xff800000
  v_mov_b32 v37, 0xff800000
  v_mov_b32 v38, 0xff800000
  v_mov_b32 v39, 0xff800000
  v_mov_b32 v40, 0xff800000
  v_mov_b32 v41, 0xff800000
  v_mov_b32 v42, 0xff800000
  v_mov_b32 v43, 0xff800000
  v_mov_b32 v44, 0xff800000
  v_mov_b32 v45, 0xff800000
  v_mov_b32 v46, 0xff800000
  v_mov_b32 v47, 0xff800000
  s_nop 1
  s_branch L_czb_78
L_cz_79:
  s_nop 7
  v_mov_b32 v32, 0xff800000
  v_mov_b32 v33, 0xff800000
  v_mov_b32 v34, 0xff800000
  v_mov_b32 v35, 0xff800000
  v_mov_b32 v36, 0xff800000
  v_mov_b32 v37, 0xff800000
  v_mov_b32 v38, 0xff800000
  v_mov_b32 v39, 0xff800000
  v_mov_b32 v40, 0xff800000
  v_mov_b32 v41, 0xff800000
  v_mov_b32 v42, 0xff800000
  v_mov_b32 v43, 0xff800000
  v_mov_b32 v44, 0xff800000
  v_mov_b32 v45, 0xff800000
  v_mov_b32 v46, 0xff800000
  v_mov_b32 v47, 0xff800000
  s_nop 1
  s_branch L_czb_80
L_cz_81:
  s_nop 7
  v_mov_b32 v32, 0xff800000
  v_mov_b32 v33, 0xff800000
  v_mov_b32 v34, 0xff800000
  v_mov_b32 v35, 0xff800000
  v_mov_b32 v36, 0xff800000
  v_mov_b32 v37, 0xff800000
  v_mov_b32 v38, 0xff800000
  v_mov_b32 v39, 0xff800000
  v_mov_b32 v40, 0xff800000
  v_mov_b32 v41, 0xff800000
  v_mov_b32 v42, 0xff800000
  v_mov_b32 v43, 0xff800000
  v_mov_b32 v44, 0xff800000
  v_mov_b32 v45, 0xff800000
  v_mov_b32 v46, 0xff800000
  v_mov_b32 v47, 0xff800000
  s_nop 1
  s_branch L_czb_82
L_cz_83:
  s_nop 7
  v_mov_b32 v32, 0xff800000
  v_mov_b32 v33, 0xff800000
  v_mov_b32 v34, 0xff800000
  v_mov_b32 v35, 0xff800000
  v_mov_b32 v36, 0xff800000
  v_mov_b32 v37, 0xff800000
  v_mov_b32 v38, 0xff800000
  v_mov_b32 v39, 0xff800000
  v_mov_b32 v40, 0xff800000
  v_mov_b32 v41, 0xff800000
  v_mov_b32 v42, 0xff800000
  v_mov_b32 v43, 0xff800000
  v_mov_b32 v44, 0xff800000
  v_mov_b32 v45, 0xff800000
  v_mov_b32 v46, 0xff800000
  v_mov_b32 v47, 0xff800000
  s_nop 1
  s_branch L_czb_84
L_cz_85:
  s_nop 7
  v_mov_b32 v32, 0xff800000
  v_mov_b32 v33, 0xff800000
  v_mov_b32 v34, 0xff800000
  v_mov_b32 v35, 0xff800000
  v_mov_b32 v36, 0xff800000
  v_mov_b32 v37, 0xff800000
  v_mov_b32 v38, 0xff800000
  v_mov_b32 v39, 0xff800000
  v_mov_b32 v40, 0xff800000
  v_mov_b32 v41, 0xff800000
  v_mov_b32 v42, 0xff800000
  v_mov_b32 v43, 0xff800000
  v_mov_b32 v44, 0xff800000
  v_mov_b32 v45, 0xff800000
  v_mov_b32 v46, 0xff800000
  v_mov_b32 v47, 0xff800000
  s_nop 1
  s_branch L_czb_86
L_cz_87:
  s_nop 7
  v_mov_b32 v32, 0xff800000
  v_mov_b32 v33, 0xff800000
  v_mov_b32 v34, 0xff800000
  v_mov_b32 v35, 0xff800000
  v_mov_b32 v36, 0xff800000
  v_mov_b32 v37, 0xff800000
  v_mov_b32 v38, 0xff800000
  v_mov_b32 v39, 0xff800000
  v_mov_b32 v40, 0xff800000
  v_mov_b32 v41, 0xff800000
  v_mov_b32 v42, 0xff800000
  v_mov_b32 v43, 0xff800000
  v_mov_b32 v44, 0xff800000
  v_mov_b32 v45, 0xff800000
  v_mov_b32 v46, 0xff800000
  v_mov_b32 v47, 0xff800000
  s_nop 1
  s_branch L_czb_88
L_cz_89:
  s_nop 7
  v_mov_b32 v32, 0xff800000
  v_mov_b32 v33, 0xff800000
  v_mov_b32 v34, 0xff800000
  v_mov_b32 v35, 0xff800000
  v_mov_b32 v36, 0xff800000
  v_mov_b32 v37, 0xff800000
  v_mov_b32 v38, 0xff800000
  v_mov_b32 v39, 0xff800000
  v_mov_b32 v40, 0xff800000
  v_mov_b32 v41, 0xff800000
  v_mov_b32 v42, 0xff800000
  v_mov_b32 v43, 0xff800000
  v_mov_b32 v44, 0xff800000
  v_mov_b32 v45, 0xff800000
  v_mov_b32 v46, 0xff800000
  v_mov_b32 v47, 0xff800000
  s_nop 1
  s_branch L_czb_90
L_cz_91:
  s_nop 7
  v_mov_b32 v32, 0xff800000
  v_mov_b32 v33, 0xff800000
  v_mov_b32 v34, 0xff800000
  v_mov_b32 v35, 0xff800000
  v_mov_b32 v36, 0xff800000
  v_mov_b32 v37, 0xff800000
  v_mov_b32 v38, 0xff800000
  v_mov_b32 v39, 0xff800000
  v_mov_b32 v40, 0xff800000
  v_mov_b32 v41, 0xff800000
  v_mov_b32 v42, 0xff800000
  v_mov_b32 v43, 0xff800000
  v_mov_b32 v44, 0xff800000
  v_mov_b32 v45, 0xff800000
  v_mov_b32 v46, 0xff800000
  v_mov_b32 v47, 0xff800000
  s_nop 1
  s_branch L_czb_92

L_codeend:
  s_endpgm
.section .rodata,"a"
.p2align 6
.amdhsa_kernel parallel_sum__sliding_block__mixer_gmlp__prompt_kernel
  .amdhsa_next_free_vgpr 512
  .amdhsa_next_free_sgpr 102
  .amdhsa_accum_offset 256
  .amdhsa_group_segment_fixed_size 0
  .amdhsa_kernarg_size 88
  .amdhsa_user_sgpr_count 2
  .amdhsa_user_sgpr_kernarg_segment_ptr 1
  .amdhsa_system_sgpr_workgroup_id_x 1
  .amdhsa_float_denorm_mode_32 3
.end_amdhsa_kernel
```
